```python
import torch

def _softmax(x, axis=-1):
    return torch.softmax(x, dim=axis)
def _gelu(x):
    return torch.nn.functional.gelu(x, approximate="tanh")
def _silu(x):
    return torch.nn.functional.silu(x)
def _sigmoid(x):
    return torch.sigmoid(x)
def _layernorm(x, axis=-1, eps=1e-5):
    m = x.mean(dim=axis, keepdim=True)
    v = x.var(dim=axis, keepdim=True, unbiased=False)
    return (x - m) / torch.sqrt(v + eps)
def _scatter_add(tgt, idx, src, axis=0):
    return tgt.clone().index_add_(axis, idx, src)
def _segment_sum(src, seg, n):
    out = torch.zeros((n,) + src.shape[1:], dtype=src.dtype)
    return out.index_add_(0, seg, src)
def _pad(x, pw):
    flat = tuple(v for pair in reversed(pw) for v in pair)
    return torch.nn.functional.pad(x, flat)

kernel_name = 'gated_mix__ssm_conv_s4__grouped_kv_mqa__prompt'

def setup_inputs():

    _w = (lambda a: (lambda t: t.to(torch.bfloat16) if t.is_floating_point() else t)(torch.as_tensor(a)))
    def _A_setup():
        B, L, D, N = 1, 2048, 640, 128
        A_re = -(lambda _x: torch.exp(torch.as_tensor(_x)))((lambda *s: torch.randn(*s, dtype=torch.bfloat16) * 3.2)(D, N))
        A_im = torch.pi * (lambda *s: torch.randn(*s, dtype=torch.bfloat16) * 0.05)(D, N)
        B_re = (lambda *s: torch.randn(*s, dtype=torch.bfloat16) * 0.1)(D, N)
        B_im = (lambda *s: torch.randn(*s, dtype=torch.bfloat16) * 0.1)(D, N)
        C_re = (lambda *s: torch.randn(*s, dtype=torch.bfloat16) * 0.1)(D, N)
        C_im = (lambda *s: torch.randn(*s, dtype=torch.bfloat16) * 0.1)(D, N)
        log_dt = (lambda *s: torch.randn(*s, dtype=torch.bfloat16) * 0.05)(D) * 0.5 - 4.0
        Dskip = (lambda *s: torch.randn(*s, dtype=torch.bfloat16) * 0.05)(D)
        return {
            "u": _w((lambda *s: torch.randn(*s, dtype=torch.bfloat16) * 0.05)(B, L, D)),
            "A_re": _w(A_re),
            "A_im": _w(A_im),
            "B_re": _w(B_re),
            "B_im": _w(B_im),
            "C_re": _w(C_re),
            "C_im": _w(C_im),
            "log_dt": _w(log_dt),
            "Dskip": _w(Dskip),
        }
    _A_in = _A_setup()

    def _B_setup():
        B, S, D, H = 1, 2048, 640, 32
        Dh = D // H
        return {
            "x": _w((lambda *s: torch.randn(*s, dtype=torch.bfloat16) * 0.05)(B, S, D)),
            "wq": _w((lambda *s: torch.randn(*s, dtype=torch.bfloat16) * 0.8)(D, H * Dh)),
            "wk": _w((lambda *s: torch.randn(*s, dtype=torch.bfloat16) * 0.8)(D, Dh)),
            "wv": _w((lambda *s: torch.randn(*s, dtype=torch.bfloat16) * 0.05)(D, Dh)),
            "wo": _w((lambda *s: torch.randn(*s, dtype=torch.bfloat16) * 0.05)(H * Dh, D)),
        }
    _B_in = _B_setup()

    return {
        "A_u": _A_in["u"],
        "A_A_re": _A_in["A_re"],
        "A_A_im": _A_in["A_im"],
        "A_B_re": _A_in["B_re"],
        "A_B_im": _A_in["B_im"],
        "A_C_re": _A_in["C_re"],
        "A_C_im": _A_in["C_im"],
        "A_log_dt": _A_in["log_dt"],
        "A_Dskip": _A_in["Dskip"],
        "B_x": _B_in["x"],
        "B_wq": _B_in["wq"],
        "B_wk": _B_in["wk"],
        "B_wv": _B_in["wv"],
        "B_wo": _B_in["wo"],
        "gate_w": _w((lambda *s: torch.randn(*s, dtype=torch.bfloat16) * 0.05)(640) * 16.0),
    }

def reference(A_u, A_A_re, A_A_im, A_B_re, A_B_im, A_C_re, A_C_im, A_log_dt, A_Dskip, B_x, B_wq, B_wk, B_wv, B_wo, gate_w):
    def _A_ref(u, A_re, A_im, B_re, B_im, C_re, C_im, log_dt, Dskip):
        Bsz, L, D = u.shape
        dt = torch.exp(log_dt)[:, None]
        A = A_re + 1j * A_im
        Bc = B_re + 1j * B_im
        Cc = C_re + 1j * C_im
        logdA = dt * A
        dB = dt * Bc
        l = (lambda x, dt: x.to(dt))(torch.arange(L), A_re.dtype)
        P = torch.exp(logdA[:, :, None] * l[None, None, :])
        K = torch.einsum("dn,dnl,dn->dl", Cc, P, dB).real
        L2 = 2 * L
        Kp = _pad(K, ((0, 0), (0, L)))
        up = (lambda x, *d: x.permute(*d))(u, 0, 2, 1)
        up = _pad(up, ((0, 0), (0, 0), (0, L)))
        Kf = (lambda x, axes=(-2,-1): torch.fft.rfft2(x.float(), dim=axes))(Kp[:, None, :], axes=(-2, -1))
        Uf = (lambda x, axes=(-2,-1): torch.fft.rfft2(x.float(), dim=axes))(up[:, :, None, :], axes=(-2, -1))
        Yf = Uf * Kf[None, :, :, :]
        y = (lambda x, s, axes=(-2,-1): torch.fft.irfft2(x, s=s, dim=axes).to(torch.bfloat16))(Yf, (1, L2), axes=(-2, -1))[:, :, 0, :L]
        y = (lambda x, *d: x.permute(*d))(y, 0, 2, 1) + u * Dskip[None, None, :]
        return y

    def _B_ref(x, wq, wk, wv, wo):
        B, S, D = x.shape
        H = 32
        Dh = D // H
        q = (lambda x, *d: x.permute(*d))((x @ wq).reshape(B, S, H, Dh), 0, 2, 1, 3)
        k = x @ wk
        v = x @ wv
        scores = torch.einsum("bhqd,bkd->bhqk", q, k) * (Dh ** -0.5)
        p = _softmax(scores, axis=-1)
        o = torch.einsum("bhqk,bkd->bhqd", p, v)
        return (lambda x, *d: x.permute(*d))(o, 0, 2, 1, 3).reshape(B, S, H * Dh) @ wo

    x = A_u
    g = _sigmoid((x * gate_w).sum(-1, keepdims=True))
    a = _A_ref(x, A_A_re, A_A_im, A_B_re, A_B_im, A_C_re, A_C_im, A_log_dt, A_Dskip)
    b = _B_ref(x, B_wq, B_wk, B_wv, B_wo)
    return g * a + (1 - g) * b
```

```asm
; @launch grid=(256,1,1) block=(512,1,1) lds=163680
.amdgcn_target "amdgcn-amd-amdhsa--gfx950"
.text
.globl gated_mix__ssm_conv_s4__grouped_kv_mqa__prompt_kernel
.p2align 8
.type gated_mix__ssm_conv_s4__grouped_kv_mqa__prompt_kernel,@function
gated_mix__ssm_conv_s4__grouped_kv_mqa__prompt_kernel:
    s_cmp_ge_u32 s2, 256
    s_cbranch_scc1 L_end
    s_load_dwordx16 s[4:19], s[0:1], 0
    s_load_dwordx16 s[20:35], s[0:1], 64
    s_load_dwordx4 s[36:39], s[0:1], 128
    s_getpc_b64 s[86:87]
L_pfbase:
    v_lshrrev_b32 v221, 3, v0
    v_and_b32 v222, 7, v0
    s_lshr_b32 s74, s2, 3
    s_lshl_b32 s74, s74, 6
    v_add3_u32 v221, v221, v222, s74
    v_lshlrev_b32 v221, 6, v221
    v_min_u32 v221, L_end-L_pfbase, v221
    s_mov_b64 exec, 0xff
    global_load_dword v222, v221, s[86:87]
    s_mov_b64 exec, -1
    v_and_b32 v1, 63, v0
    v_lshrrev_b32 v12, 6, v0
    s_and_b32 s65, s2, 7
    v_readfirstlane_b32 s64, v12
    s_lshr_b32 s74, s2, 6
    s_lshl_b32 s74, s74, 3
    s_add_u32 s65, s65, s74
    s_lshr_b32 s66, s2, 3
    s_and_b32 s66, s66, 7
    s_and_b32 s67, s64, 3
    s_lshr_b32 s68, s64, 2
    s_lshr_b32 s80, s66, 1
    s_sub_u32 s69, s67, s80
    s_and_b32 s69, s69, 3
    v_lshrrev_b32 v2, 4, v1
    v_and_b32 v3, 15, v1
    v_lshlrev_b32 v9, 4, v1
    v_and_b32 v10, 31, v1
    v_lshrrev_b32 v11, 5, v1
    v_mov_b32 v12, 163648
    v_mov_b32 v14, 0
    v_mov_b32 v15, 0
    ds_write_b64 v12, v[14:15]
    ds_write_b64 v12, v[14:15] offset:8
    ds_write_b64 v12, v[14:15] offset:16
    ds_write_b64 v12, v[14:15] offset:24
    s_mul_i32 s96, s66, 160
    s_cmp_lt_u32 s64, 3
    s_cbranch_scc1 L_pre_kg
    v_add_u32 v12, 0, v1
    v_mul_u32_u24 v13, 6554, v12
    v_lshrrev_b32 v13, 16, v13
    v_mul_u32_u24 v14, 10, v13
    v_sub_u32 v12, v12, v14
    v_lshlrev_b32 v12, 4, v12
    v_and_b32 v4, 0x13, v13
    v_bfe_u32 v14, v13, 2, 1
    v_lshl_or_b32 v4, v14, 3, v4
    v_bfe_u32 v14, v13, 3, 1
    v_lshl_or_b32 v4, v14, 2, v4
    v_mul_u32_u24 v4, 1280, v4
    v_add_u32 v4, v4, v12
    v_add_u32 v12, 64, v1
    v_mul_u32_u24 v13, 6554, v12
    v_lshrrev_b32 v13, 16, v13
    v_mul_u32_u24 v14, 10, v13
    v_sub_u32 v12, v12, v14
    v_lshlrev_b32 v12, 4, v12
    v_and_b32 v5, 0x13, v13
    v_bfe_u32 v14, v13, 2, 1
    v_lshl_or_b32 v5, v14, 3, v5
    v_bfe_u32 v14, v13, 3, 1
    v_lshl_or_b32 v5, v14, 2, v5
    v_mul_u32_u24 v5, 1280, v5
    v_add_u32 v5, v5, v12
    v_add_u32 v12, 128, v1
    v_mul_u32_u24 v13, 6554, v12
    v_lshrrev_b32 v13, 16, v13
    v_mul_u32_u24 v14, 10, v13
    v_sub_u32 v12, v12, v14
    v_lshlrev_b32 v12, 4, v12
    v_and_b32 v6, 0x13, v13
    v_bfe_u32 v14, v13, 2, 1
    v_lshl_or_b32 v6, v14, 3, v6
    v_bfe_u32 v14, v13, 3, 1
    v_lshl_or_b32 v6, v14, 2, v6
    v_mul_u32_u24 v6, 1280, v6
    v_add_u32 v6, v6, v12
    v_add_u32 v12, 192, v1
    v_mul_u32_u24 v13, 6554, v12
    v_lshrrev_b32 v13, 16, v13
    v_mul_u32_u24 v14, 10, v13
    v_sub_u32 v12, v12, v14
    v_lshlrev_b32 v12, 4, v12
    v_and_b32 v7, 0x13, v13
    v_bfe_u32 v14, v13, 2, 1
    v_lshl_or_b32 v7, v14, 3, v7
    v_bfe_u32 v14, v13, 3, 1
    v_lshl_or_b32 v7, v14, 2, v7
    v_mul_u32_u24 v7, 1280, v7
    v_add_u32 v7, v7, v12
    v_add_u32 v12, 256, v1
    v_mul_u32_u24 v13, 6554, v12
    v_lshrrev_b32 v13, 16, v13
    v_mul_u32_u24 v14, 10, v13
    v_sub_u32 v12, v12, v14
    v_lshlrev_b32 v12, 4, v12
    v_and_b32 v8, 0x13, v13
    v_bfe_u32 v14, v13, 2, 1
    v_lshl_or_b32 v8, v14, 3, v8
    v_bfe_u32 v14, v13, 3, 1
    v_lshl_or_b32 v8, v14, 2, v8
    v_mul_u32_u24 v8, 1280, v8
    v_add_u32 v8, v8, v12
    v_subrev_u32 v5, 1024, v5
    v_subrev_u32 v6, 2048, v6
    v_subrev_u32 v7, 3072, v7
    s_cmp_eq_u32 s64, 3
    s_cbranch_scc1 L_pre_ld
    s_lshl_b32 s74, s65, 6
    s_lshl_b32 s75, s67, 4
    s_add_u32 s74, s74, s75
    s_mul_i32 s78, s74, 1280
    s_mul_i32 s79, s67, 20480
    v_lshrrev_b32 v12, 3, v1
    v_add_u32 v14, 4, v12
    v_bfe_u32 v14, v14, 3, 1
    v_lshrrev_b32 v13, 1, v12
    v_xor_b32 v13, v13, v14
    v_and_b32 v14, 7, v1
    v_xor_b32 v13, v13, v14
    v_mul_u32_u24 v12, 1280, v12
    v_lshl_add_u32 v204, v13, 4, v12
    v_lshrrev_b32 v12, 3, v1
    v_add_u32 v12, 8, v12
    v_add_u32 v14, 4, v12
    v_bfe_u32 v14, v14, 3, 1
    v_lshrrev_b32 v13, 1, v12
    v_xor_b32 v13, v13, v14
    v_and_b32 v14, 7, v1
    v_xor_b32 v13, v13, v14
    v_mul_u32_u24 v12, 1280, v12
    v_lshl_add_u32 v122, v13, 4, v12
    v_subrev_u32 v122, 1024, v122
    v_add_u32 v14, 4, v3
    v_bfe_u32 v14, v14, 3, 1
    v_lshrrev_b32 v13, 1, v3
    v_xor_b32 v13, v13, v14
    v_xor_b32 v13, v13, v2
    v_lshlrev_b32 v13, 4, v13
    v_lshl_add_u32 v13, v3, 7, v13
    v_add_u32 v120, s79, v13
    v_xor_b32 v121, 64, v120
    v_lshlrev_b32 v219, 6, v3
    v_lshl_add_u32 v219, v2, 4, v219
    s_waitcnt lgkmcnt(0)
    s_mov_b32 s40, s4
    s_mov_b32 s41, s5
    s_mov_b32 s42, 2621440
    s_mov_b32 s43, 0x20000
    s_mov_b32 s52, s38
    s_mov_b32 s53, s39
    s_mov_b32 s54, 18874368
    s_mov_b32 s55, 0x20000
    s_mov_b32 s60, s32
    s_mov_b32 s61, s33
    s_mov_b32 s62, 1280
    s_mov_b32 s63, 0x20000
    s_setprio 3
    s_cmp_eq_u32 s69, 0
    s_cbranch_scc1 L_pre_kv
    s_cmp_eq_u32 s69, 3
    s_cbranch_scc1 L_pre_fill
    s_barrier
    s_add_u32 m0, s79, 0
    s_add_u32 s75, s78, 0
    buffer_load_dwordx4 v204, s[40:43], s75 offen lds
    buffer_load_dwordx4 v122, s[40:43], s75 offen offset:1024 lds
    s_add_u32 m0, s79, 2048
    s_add_u32 s75, s78, 128
    buffer_load_dwordx4 v204, s[40:43], s75 offen lds
    buffer_load_dwordx4 v122, s[40:43], s75 offen offset:1024 lds
    s_add_u32 m0, s79, 4096
    s_add_u32 s75, s78, 256
    buffer_load_dwordx4 v204, s[40:43], s75 offen lds
    buffer_load_dwordx4 v122, s[40:43], s75 offen offset:1024 lds
    s_add_u32 m0, s79, 6144
    s_add_u32 s75, s78, 384
    buffer_load_dwordx4 v204, s[40:43], s75 offen lds
    buffer_load_dwordx4 v122, s[40:43], s75 offen offset:1024 lds
    s_add_u32 m0, s79, 8192
    s_add_u32 s75, s78, 512
    buffer_load_dwordx4 v204, s[40:43], s75 offen lds
    buffer_load_dwordx4 v122, s[40:43], s75 offen offset:1024 lds
    s_add_u32 m0, s79, 10240
    s_add_u32 s75, s78, 640
    buffer_load_dwordx4 v204, s[40:43], s75 offen lds
    buffer_load_dwordx4 v122, s[40:43], s75 offen offset:1024 lds
    s_add_u32 m0, s79, 12288
    s_add_u32 s75, s78, 768
    buffer_load_dwordx4 v204, s[40:43], s75 offen lds
    buffer_load_dwordx4 v122, s[40:43], s75 offen offset:1024 lds
    s_add_u32 m0, s79, 14336
    s_add_u32 s75, s78, 896
    buffer_load_dwordx4 v204, s[40:43], s75 offen lds
    buffer_load_dwordx4 v122, s[40:43], s75 offen offset:1024 lds
    s_add_u32 m0, s79, 16384
    s_add_u32 s75, s78, 1024
    buffer_load_dwordx4 v204, s[40:43], s75 offen lds
    buffer_load_dwordx4 v122, s[40:43], s75 offen offset:1024 lds
    s_add_u32 m0, s79, 18432
    s_add_u32 s75, s78, 1152
    buffer_load_dwordx4 v204, s[40:43], s75 offen lds
    buffer_load_dwordx4 v122, s[40:43], s75 offen offset:1024 lds
    v_mov_b32 v12, 163664
    v_mov_b32 v13, 1
    s_mov_b64 exec, 1
    ds_add_u32 v12, v13
    s_mov_b64 exec, -1
    s_mov_b32 exec_lo, 0x000f000f
    s_mov_b32 exec_hi, 0x000f000f
    buffer_load_dwordx4 v[100:103], v219, s[60:63], 0 offen offset:0
    buffer_load_dwordx4 v[104:107], v219, s[60:63], 0 offen offset:256
    buffer_load_dwordx4 v[108:111], v219, s[60:63], 0 offen offset:512
    buffer_load_dwordx4 v[112:115], v219, s[60:63], 0 offen offset:768
    buffer_load_dwordx4 v[116:119], v219, s[60:63], 0 offen offset:1024
    s_mov_b64 exec, -1
    s_mov_b32 s56, s36
    s_mov_b32 s57, s37
    s_mov_b32 s58, 256
    s_mov_b32 s59, 0x20000
    v_bfe_u32 v123, v1, 1, 1
    v_bfe_u32 v124, v1, 2, 2
    v_lshl_add_u32 v123, v123, 3, v124
    v_mul_u32_u24 v124, 20480, v2
    v_and_b32 v125, 1, v1
    v_lshl_add_u32 v124, v125, 3, v124
    v_add_u32 v125, 4, v123
    v_bfe_u32 v125, v125, 3, 1
    v_lshrrev_b32 v126, 1, v123
    v_xor_b32 v126, v126, v125
    v_lshlrev_b32 v126, 4, v126
    v_lshl_add_u32 v128, v123, 7, v124
    v_add_u32 v123, 4, v123
    v_add_u32 v125, 4, v123
    v_bfe_u32 v125, v125, 3, 1
    v_lshrrev_b32 v127, 1, v123
    v_xor_b32 v127, v127, v125
    v_lshlrev_b32 v127, 4, v127
    v_lshl_add_u32 v129, v123, 7, v124
    v_and_b32 v123, 7, v3
    v_lshlrev_b32 v123, 12, v123
    v_lshrrev_b32 v124, 3, v3
    v_lshl_add_u32 v124, v2, 1, v124
    v_lshl_add_u32 v123, v124, 4, v123
    s_sub_u32 s76, s69, 1
    s_mul_i32 s76, s76, 5
    s_mul_i32 s77, s66, 10
    s_add_u32 s77, s77, s76
    s_mul_i32 s74, s66, 80
    s_lshl_b32 s76, s76, 3
    s_add_u32 s76, s76, s74
    s_lshl_b32 s76, s76, 12
    s_lshl_b32 s74, s65, 7
    s_add_u32 s76, s76, s74
    s_add_u32 s76, s76, 6291456
    s_waitcnt vmcnt(5)
    v_mov_b32 v12, 163656
    v_mov_b32 v13, 1
    s_mov_b64 exec, 1
    ds_add_u32 v12, v13
    s_mov_b64 exec, -1
    ds_read_b128 v[20:23], v120 offset:0
    ds_read_b128 v[24:27], v121 offset:0
    ds_read_b128 v[28:31], v120 offset:2048
    ds_read_b128 v[32:35], v121 offset:2048
    ds_read_b128 v[36:39], v120 offset:4096
    ds_read_b128 v[40:43], v121 offset:4096
    ds_read_b128 v[44:47], v120 offset:6144
    ds_read_b128 v[48:51], v121 offset:6144
    ds_read_b128 v[52:55], v120 offset:8192
    ds_read_b128 v[56:59], v121 offset:8192
    ds_read_b128 v[60:63], v120 offset:10240
    ds_read_b128 v[64:67], v121 offset:10240
    ds_read_b128 v[68:71], v120 offset:12288
    ds_read_b128 v[72:75], v121 offset:12288
    s_waitcnt lgkmcnt(4)
    ds_read_b128 v[76:79], v120 offset:14336
    ds_read_b128 v[80:83], v121 offset:14336
    ds_read_b128 v[84:87], v120 offset:16384
    ds_read_b128 v[88:91], v121 offset:16384
    ds_read_b128 v[92:95], v120 offset:18432
    ds_read_b128 v[96:99], v121 offset:18432
    v_mov_b32 v12, 163656
    s_mov_b32 s99, 0
L_xl_1:
    ds_read_b32 v13, v12
    s_waitcnt lgkmcnt(0)
    v_readfirstlane_b32 s74, v13
    s_nop 0
    s_cmp_ge_u32 s74, 4
    s_cbranch_scc1 L_xld_2
    s_add_u32 s99, s99, 1
    s_cmp_lt_u32 s99, 2097152
    s_cbranch_scc1 L_xl_1
L_xld_2:
    s_add_u32 s74, s77, 0
    s_and_b32 s75, s74, 7
    s_lshl_b32 s75, s75, 4
    s_lshr_b32 s74, s74, 3
    s_lshl_b32 s74, s74, 11
    v_xor_b32 v130, s75, v126
    v_add3_u32 v130, v130, v128, s74
    ds_read_b64_tr_b16 v[136:137], v130 offset:0
    v_xor_b32 v131, s75, v127
    v_add3_u32 v131, v131, v129, s74
    ds_read_b64_tr_b16 v[138:139], v131 offset:0
    s_add_u32 s74, s77, 1
    s_and_b32 s75, s74, 7
    s_lshl_b32 s75, s75, 4
    s_lshr_b32 s74, s74, 3
    s_lshl_b32 s74, s74, 11
    v_xor_b32 v130, s75, v126
    v_add3_u32 v130, v130, v128, s74
    ds_read_b64_tr_b16 v[140:141], v130 offset:0
    v_xor_b32 v131, s75, v127
    v_add3_u32 v131, v131, v129, s74
    ds_read_b64_tr_b16 v[142:143], v131 offset:0
    s_add_u32 s74, s77, 2
    s_and_b32 s75, s74, 7
    s_lshl_b32 s75, s75, 4
    s_lshr_b32 s74, s74, 3
    s_lshl_b32 s74, s74, 11
    v_xor_b32 v130, s75, v126
    v_add3_u32 v130, v130, v128, s74
    ds_read_b64_tr_b16 v[144:145], v130 offset:0
    v_xor_b32 v131, s75, v127
    v_add3_u32 v131, v131, v129, s74
    ds_read_b64_tr_b16 v[146:147], v131 offset:0
    s_add_u32 s74, s77, 3
    s_and_b32 s75, s74, 7
    s_lshl_b32 s75, s75, 4
    s_lshr_b32 s74, s74, 3
    s_lshl_b32 s74, s74, 11
    v_xor_b32 v130, s75, v126
    v_add3_u32 v130, v130, v128, s74
    ds_read_b64_tr_b16 v[148:149], v130 offset:0
    v_xor_b32 v131, s75, v127
    v_add3_u32 v131, v131, v129, s74
    ds_read_b64_tr_b16 v[150:151], v131 offset:0
    s_add_u32 s74, s77, 4
    s_and_b32 s75, s74, 7
    s_lshl_b32 s75, s75, 4
    s_lshr_b32 s74, s74, 3
    s_lshl_b32 s74, s74, 11
    v_xor_b32 v130, s75, v126
    v_add3_u32 v130, v130, v128, s74
    ds_read_b64_tr_b16 v[152:153], v130 offset:0
    v_xor_b32 v131, s75, v127
    v_add3_u32 v131, v131, v129, s74
    ds_read_b64_tr_b16 v[154:155], v131 offset:0
    s_waitcnt lgkmcnt(0)
    v_mov_b32 v12, 163660
    v_mov_b32 v13, 1
    s_mov_b64 exec, 1
    ds_add_u32 v12, v13
    s_mov_b64 exec, -1
    s_add_u32 s75, s76, 0
    buffer_store_dwordx4 v[136:139], v123, s[52:55], s75 offen sc1
    s_add_u32 s75, s76, 32768
    buffer_store_dwordx4 v[140:143], v123, s[52:55], s75 offen sc1
    s_add_u32 s75, s76, 65536
    buffer_store_dwordx4 v[144:147], v123, s[52:55], s75 offen sc1
    s_add_u32 s75, s76, 98304
    buffer_store_dwordx4 v[148:151], v123, s[52:55], s75 offen sc1
    s_add_u32 s75, s76, 131072
    buffer_store_dwordx4 v[152:155], v123, s[52:55], s75 offen sc1
    s_waitcnt vmcnt(5)
    s_branch L_role_fin2
L_pre_fill:
    s_barrier
    s_add_u32 m0, s79, 0
    s_add_u32 s75, s78, 0
    buffer_load_dwordx4 v204, s[40:43], s75 offen lds
    buffer_load_dwordx4 v122, s[40:43], s75 offen offset:1024 lds
    s_add_u32 m0, s79, 2048
    s_add_u32 s75, s78, 128
    buffer_load_dwordx4 v204, s[40:43], s75 offen lds
    buffer_load_dwordx4 v122, s[40:43], s75 offen offset:1024 lds
    s_add_u32 m0, s79, 4096
    s_add_u32 s75, s78, 256
    buffer_load_dwordx4 v204, s[40:43], s75 offen lds
    buffer_load_dwordx4 v122, s[40:43], s75 offen offset:1024 lds
    s_add_u32 m0, s79, 6144
    s_add_u32 s75, s78, 384
    buffer_load_dwordx4 v204, s[40:43], s75 offen lds
    buffer_load_dwordx4 v122, s[40:43], s75 offen offset:1024 lds
    s_add_u32 m0, s79, 8192
    s_add_u32 s75, s78, 512
    buffer_load_dwordx4 v204, s[40:43], s75 offen lds
    buffer_load_dwordx4 v122, s[40:43], s75 offen offset:1024 lds
    s_add_u32 m0, s79, 10240
    s_add_u32 s75, s78, 640
    buffer_load_dwordx4 v204, s[40:43], s75 offen lds
    buffer_load_dwordx4 v122, s[40:43], s75 offen offset:1024 lds
    s_add_u32 m0, s79, 12288
    s_add_u32 s75, s78, 768
    buffer_load_dwordx4 v204, s[40:43], s75 offen lds
    buffer_load_dwordx4 v122, s[40:43], s75 offen offset:1024 lds
    s_add_u32 m0, s79, 14336
    s_add_u32 s75, s78, 896
    buffer_load_dwordx4 v204, s[40:43], s75 offen lds
    buffer_load_dwordx4 v122, s[40:43], s75 offen offset:1024 lds
    s_add_u32 m0, s79, 16384
    s_add_u32 s75, s78, 1024
    buffer_load_dwordx4 v204, s[40:43], s75 offen lds
    buffer_load_dwordx4 v122, s[40:43], s75 offen offset:1024 lds
    s_add_u32 m0, s79, 18432
    s_add_u32 s75, s78, 1152
    buffer_load_dwordx4 v204, s[40:43], s75 offen lds
    buffer_load_dwordx4 v122, s[40:43], s75 offen offset:1024 lds
    v_mov_b32 v12, 163664
    v_mov_b32 v13, 1
    s_mov_b64 exec, 1
    ds_add_u32 v12, v13
    s_mov_b64 exec, -1
    s_mov_b32 exec_lo, 0x000f000f
    s_mov_b32 exec_hi, 0x000f000f
    buffer_load_dwordx4 v[100:103], v219, s[60:63], 0 offen offset:0
    buffer_load_dwordx4 v[104:107], v219, s[60:63], 0 offen offset:256
    buffer_load_dwordx4 v[108:111], v219, s[60:63], 0 offen offset:512
    buffer_load_dwordx4 v[112:115], v219, s[60:63], 0 offen offset:768
    buffer_load_dwordx4 v[116:119], v219, s[60:63], 0 offen offset:1024
    s_mov_b64 exec, -1
    s_mov_b32 s56, s36
    s_mov_b32 s57, s37
    s_mov_b32 s58, 256
    s_mov_b32 s59, 0x20000
    s_waitcnt vmcnt(5)
    v_mov_b32 v12, 163656
    v_mov_b32 v13, 1
    s_mov_b64 exec, 1
    ds_add_u32 v12, v13
    s_mov_b64 exec, -1
    ds_read_b128 v[20:23], v120 offset:0
    ds_read_b128 v[24:27], v121 offset:0
    ds_read_b128 v[28:31], v120 offset:2048
    ds_read_b128 v[32:35], v121 offset:2048
    ds_read_b128 v[36:39], v120 offset:4096
    ds_read_b128 v[40:43], v121 offset:4096
    ds_read_b128 v[44:47], v120 offset:6144
    ds_read_b128 v[48:51], v121 offset:6144
    ds_read_b128 v[52:55], v120 offset:8192
    ds_read_b128 v[56:59], v121 offset:8192
    ds_read_b128 v[60:63], v120 offset:10240
    ds_read_b128 v[64:67], v121 offset:10240
    ds_read_b128 v[68:71], v120 offset:12288
    ds_read_b128 v[72:75], v121 offset:12288
    s_waitcnt lgkmcnt(4)
    ds_read_b128 v[76:79], v120 offset:14336
    ds_read_b128 v[80:83], v121 offset:14336
    ds_read_b128 v[84:87], v120 offset:16384
    ds_read_b128 v[88:91], v121 offset:16384
    ds_read_b128 v[92:95], v120 offset:18432
    ds_read_b128 v[96:99], v121 offset:18432
    s_waitcnt lgkmcnt(0)
    v_mov_b32 v12, 163660
    v_mov_b32 v13, 1
    s_mov_b64 exec, 1
    ds_add_u32 v12, v13
    s_mov_b64 exec, -1
    s_waitcnt vmcnt(0)
    s_branch L_role_fin2
L_pre_kv:
    s_bitcmp1_b32 s66, 0
    s_cselect_b32 s48, s28, s26
    s_cselect_b32 s49, s29, s27
    s_mov_b32 s50, 25600
    s_mov_b32 s51, 0x20000
    s_mov_b32 m0, 102400
    s_mov_b32 s75, 0
    buffer_load_dwordx4 v9, s[48:51], s75 offen offset:0 lds
    s_mov_b32 m0, 102400
    s_mov_b32 s75, 0
    buffer_load_dwordx4 v9, s[48:51], s75 offen offset:1024 lds
    s_add_u32 m0, s79, 0
    s_add_u32 s75, s78, 0
    buffer_load_dwordx4 v204, s[40:43], s75 offen lds
    s_add_u32 m0, s79, 0
    s_add_u32 s75, s78, 0
    buffer_load_dwordx4 v122, s[40:43], s75 offen offset:1024 lds
    s_mov_b32 m0, 102400
    s_mov_b32 s75, 0
    buffer_load_dwordx4 v9, s[48:51], s75 offen offset:2048 lds
    s_mov_b32 m0, 102400
    s_mov_b32 s75, 0
    buffer_load_dwordx4 v9, s[48:51], s75 offen offset:3072 lds
    s_add_u32 m0, s79, 2048
    s_add_u32 s75, s78, 128
    buffer_load_dwordx4 v204, s[40:43], s75 offen lds
    s_add_u32 m0, s79, 2048
    s_add_u32 s75, s78, 128
    buffer_load_dwordx4 v122, s[40:43], s75 offen offset:1024 lds
    s_mov_b32 m0, 106496
    s_mov_b32 s75, 4096
    buffer_load_dwordx4 v9, s[48:51], s75 offen offset:0 lds
    s_mov_b32 m0, 106496
    s_mov_b32 s75, 4096
    buffer_load_dwordx4 v9, s[48:51], s75 offen offset:1024 lds
    s_mov_b32 m0, 106496
    s_mov_b32 s75, 4096
    buffer_load_dwordx4 v9, s[48:51], s75 offen offset:2048 lds
    s_add_u32 m0, s79, 4096
    s_add_u32 s75, s78, 256
    buffer_load_dwordx4 v204, s[40:43], s75 offen lds
    s_add_u32 m0, s79, 4096
    s_add_u32 s75, s78, 256
    buffer_load_dwordx4 v122, s[40:43], s75 offen offset:1024 lds
    s_mov_b32 m0, 106496
    s_mov_b32 s75, 4096
    buffer_load_dwordx4 v9, s[48:51], s75 offen offset:3072 lds
    s_and_b32 s74, s2, 0x84
    s_cmp_lg_u32 s74, 0
    s_cbranch_scc1 L_nozero
    s_lshr_b32 s74, s2, 6
    s_lshl_b32 s74, s74, 3
    s_add_u32 s74, s74, s66
    s_lshl_b32 s74, s74, 2
    s_and_b32 s75, s2, 3
    s_add_u32 s74, s74, s75
    s_lshl_b32 s74, s74, 4
    s_add_u32 s74, s74, 14057472
    v_mov_b32 v13, 0
    v_lshlrev_b32 v14, 10, v1
    s_mov_b32 exec_lo, 15
    s_mov_b32 exec_hi, 0
    buffer_store_dword v13, v14, s[52:55], s74 offen sc1
    s_mov_b64 exec, -1
    s_cmp_lg_u32 s2, 0
    s_cbranch_scc1 L_nozero
    s_mov_b64 exec, 0xffff
    v_lshlrev_b32 v14, 7, v1
    s_mov_b32 s74, 14049280
    buffer_store_dword v13, v14, s[52:55], s74 offen sc1
    s_mov_b64 exec, -1
L_nozero:
    s_mov_b32 m0, 110592
    s_mov_b32 s75, 8192
    buffer_load_dwordx4 v9, s[48:51], s75 offen offset:0 lds
    s_add_u32 m0, s79, 6144
    s_add_u32 s75, s78, 384
    buffer_load_dwordx4 v204, s[40:43], s75 offen lds
    s_add_u32 m0, s79, 6144
    s_add_u32 s75, s78, 384
    buffer_load_dwordx4 v122, s[40:43], s75 offen offset:1024 lds
    s_mov_b32 m0, 110592
    s_mov_b32 s75, 8192
    buffer_load_dwordx4 v9, s[48:51], s75 offen offset:1024 lds
    s_mov_b32 m0, 110592
    s_mov_b32 s75, 8192
    buffer_load_dwordx4 v9, s[48:51], s75 offen offset:2048 lds
    s_mov_b32 m0, 110592
    s_mov_b32 s75, 8192
    buffer_load_dwordx4 v9, s[48:51], s75 offen offset:3072 lds
    s_add_u32 m0, s79, 8192
    s_add_u32 s75, s78, 512
    buffer_load_dwordx4 v204, s[40:43], s75 offen lds
    s_add_u32 m0, s79, 8192
    s_add_u32 s75, s78, 512
    buffer_load_dwordx4 v122, s[40:43], s75 offen offset:1024 lds
    s_mov_b32 m0, 114688
    s_mov_b32 s75, 12288
    buffer_load_dwordx4 v9, s[48:51], s75 offen offset:0 lds
    s_mov_b32 m0, 114688
    s_mov_b32 s75, 12288
    buffer_load_dwordx4 v9, s[48:51], s75 offen offset:1024 lds
    s_add_u32 m0, s79, 10240
    s_add_u32 s75, s78, 640
    buffer_load_dwordx4 v204, s[40:43], s75 offen lds
    s_add_u32 m0, s79, 10240
    s_add_u32 s75, s78, 640
    buffer_load_dwordx4 v122, s[40:43], s75 offen offset:1024 lds
    s_mov_b32 m0, 114688
    s_mov_b32 s75, 12288
    buffer_load_dwordx4 v9, s[48:51], s75 offen offset:2048 lds
    s_mov_b32 m0, 114688
    s_mov_b32 s75, 12288
    buffer_load_dwordx4 v9, s[48:51], s75 offen offset:3072 lds
    s_mov_b32 m0, 118784
    s_mov_b32 s75, 16384
    buffer_load_dwordx4 v9, s[48:51], s75 offen offset:0 lds
    s_add_u32 m0, s79, 12288
    s_add_u32 s75, s78, 768
    buffer_load_dwordx4 v204, s[40:43], s75 offen lds
    s_add_u32 m0, s79, 12288
    s_add_u32 s75, s78, 768
    buffer_load_dwordx4 v122, s[40:43], s75 offen offset:1024 lds
    s_mov_b32 m0, 118784
    s_mov_b32 s75, 16384
    buffer_load_dwordx4 v9, s[48:51], s75 offen offset:1024 lds
    s_mov_b32 m0, 118784
    s_mov_b32 s75, 16384
    buffer_load_dwordx4 v9, s[48:51], s75 offen offset:2048 lds
    s_add_u32 m0, s79, 14336
    s_add_u32 s75, s78, 896
    buffer_load_dwordx4 v204, s[40:43], s75 offen lds
    s_add_u32 m0, s79, 14336
    s_add_u32 s75, s78, 896
    buffer_load_dwordx4 v122, s[40:43], s75 offen offset:1024 lds
    s_mov_b32 m0, 118784
    s_mov_b32 s75, 16384
    buffer_load_dwordx4 v9, s[48:51], s75 offen offset:3072 lds
    s_mov_b32 m0, 122880
    s_mov_b32 s75, 20480
    buffer_load_dwordx4 v9, s[48:51], s75 offen offset:0 lds
    s_mov_b32 m0, 122880
    s_mov_b32 s75, 20480
    buffer_load_dwordx4 v9, s[48:51], s75 offen offset:1024 lds
    s_add_u32 m0, s79, 16384
    s_add_u32 s75, s78, 1024
    buffer_load_dwordx4 v204, s[40:43], s75 offen lds
    s_add_u32 m0, s79, 16384
    s_add_u32 s75, s78, 1024
    buffer_load_dwordx4 v122, s[40:43], s75 offen offset:1024 lds
    s_mov_b32 m0, 122880
    s_mov_b32 s75, 20480
    buffer_load_dwordx4 v9, s[48:51], s75 offen offset:2048 lds
    s_mov_b32 m0, 122880
    s_mov_b32 s75, 20480
    buffer_load_dwordx4 v9, s[48:51], s75 offen offset:3072 lds
    s_add_u32 m0, s79, 18432
    s_add_u32 s75, s78, 1152
    buffer_load_dwordx4 v204, s[40:43], s75 offen lds
    s_add_u32 m0, s79, 18432
    s_add_u32 s75, s78, 1152
    buffer_load_dwordx4 v122, s[40:43], s75 offen offset:1024 lds
    s_mov_b32 m0, 126976
    s_mov_b32 s75, 24576
    buffer_load_dwordx4 v9, s[48:51], s75 offen offset:0 lds
    s_barrier
    s_mov_b32 exec_lo, 0x000f000f
    s_mov_b32 exec_hi, 0x000f000f
    buffer_load_dwordx4 v[100:103], v219, s[60:63], 0 offen offset:0
    buffer_load_dwordx4 v[104:107], v219, s[60:63], 0 offen offset:256
    buffer_load_dwordx4 v[108:111], v219, s[60:63], 0 offen offset:512
    buffer_load_dwordx4 v[112:115], v219, s[60:63], 0 offen offset:768
    buffer_load_dwordx4 v[116:119], v219, s[60:63], 0 offen offset:1024
    s_mov_b64 exec, -1
    s_getreg_b32 s74, hwreg(HW_REG_XCC_ID)
    s_add_u32 s74, s74, 1
    v_mov_b32 v13, s74
    s_lshl_b32 s74, s2, 2
    s_add_u32 s74, s74, 14045184
    v_mov_b32 v12, 0
    s_mov_b64 exec, 1
    buffer_store_dword v13, v12, s[52:55], s74 offen sc1
    s_mov_b64 exec, -1
    s_mov_b32 s56, s36
    s_mov_b32 s57, s37
    s_mov_b32 s58, 256
    s_mov_b32 s59, 0x20000
    v_bfe_u32 v12, v1, 2, 2
    v_lshl_add_u32 v12, v2, 3, v12
    v_mul_u32_u24 v12, 40, v12
    v_and_b32 v13, 3, v1
    v_lshl_add_u32 v12, v13, 3, v12
    v_add_u32 v207, 102400, v12
    s_lshl_b32 s76, s65, 1
    s_lshr_b32 s75, s80, 1
    s_add_u32 s76, s76, s75
    s_mul_i32 s76, s76, 2688
    s_add_u32 s76, s76, 13631488
    s_and_b32 s75, s80, 1
    s_waitcnt vmcnt(47)
    s_bitcmp1_b32 s66, 0
    s_cbranch_scc1 L_r_kvv
    ds_read_b128 v[20:23], v120 offset:0
    ds_read_b64_tr_b16 v[224:225], v207 offset:0
    ds_read_b64_tr_b16 v[226:227], v207 offset:160
    ds_read_b64_tr_b16 v[228:229], v207 offset:32
    ds_read_b64_tr_b16 v[230:231], v207 offset:192
    s_waitcnt vmcnt(46)
    ds_read_b128 v[24:27], v121 offset:0
    ds_read_b64_tr_b16 v[232:233], v207 offset:1280
    ds_read_b64_tr_b16 v[234:235], v207 offset:1440
    ds_read_b64_tr_b16 v[236:237], v207 offset:1312
    ds_read_b64_tr_b16 v[238:239], v207 offset:1472
    s_waitcnt vmcnt(43)
    ds_read_b128 v[28:31], v120 offset:2048
    ds_read_b64_tr_b16 v[240:241], v207 offset:2560
    ds_read_b64_tr_b16 v[242:243], v207 offset:2720
    ds_read_b64_tr_b16 v[244:245], v207 offset:2592
    ds_read_b64_tr_b16 v[246:247], v207 offset:2752
    s_waitcnt lgkmcnt(10)
    v_mfma_f32_16x16x32_bf16 v[196:199], v[224:227], v[20:23], 0
    v_mfma_f32_16x16x32_bf16 v[200:203], v[228:231], v[20:23], 0
    s_waitcnt vmcnt(42)
    ds_read_b128 v[32:35], v121 offset:2048
    ds_read_b64_tr_b16 v[248:249], v207 offset:3840
    ds_read_b64_tr_b16 v[250:251], v207 offset:4000
    ds_read_b64_tr_b16 v[252:253], v207 offset:3872
    ds_read_b64_tr_b16 v[254:255], v207 offset:4032
    s_waitcnt lgkmcnt(10)
    v_mfma_f32_16x16x32_bf16 v[196:199], v[232:235], v[24:27], v[196:199]
    v_mfma_f32_16x16x32_bf16 v[200:203], v[236:239], v[24:27], v[200:203]
    s_waitcnt vmcnt(38)
    ds_read_b128 v[36:39], v120 offset:4096
    ds_read_b64_tr_b16 v[224:225], v207 offset:5120
    ds_read_b64_tr_b16 v[226:227], v207 offset:5280
    ds_read_b64_tr_b16 v[228:229], v207 offset:5152
    ds_read_b64_tr_b16 v[230:231], v207 offset:5312
    s_waitcnt lgkmcnt(10)
    v_mfma_f32_16x16x32_bf16 v[196:199], v[240:243], v[28:31], v[196:199]
    v_mfma_f32_16x16x32_bf16 v[200:203], v[244:247], v[28:31], v[200:203]
    s_waitcnt vmcnt(37)
    ds_read_b128 v[40:43], v121 offset:4096
    ds_read_b64_tr_b16 v[232:233], v207 offset:6400
    ds_read_b64_tr_b16 v[234:235], v207 offset:6560
    ds_read_b64_tr_b16 v[236:237], v207 offset:6432
    ds_read_b64_tr_b16 v[238:239], v207 offset:6592
    s_waitcnt lgkmcnt(10)
    v_mfma_f32_16x16x32_bf16 v[196:199], v[248:251], v[32:35], v[196:199]
    v_mfma_f32_16x16x32_bf16 v[200:203], v[252:255], v[32:35], v[200:203]
    s_waitcnt vmcnt(34)
    ds_read_b128 v[44:47], v120 offset:6144
    ds_read_b64_tr_b16 v[240:241], v207 offset:7680
    ds_read_b64_tr_b16 v[242:243], v207 offset:7840
    ds_read_b64_tr_b16 v[244:245], v207 offset:7712
    ds_read_b64_tr_b16 v[246:247], v207 offset:7872
    s_waitcnt lgkmcnt(10)
    v_mfma_f32_16x16x32_bf16 v[196:199], v[224:227], v[36:39], v[196:199]
    v_mfma_f32_16x16x32_bf16 v[200:203], v[228:231], v[36:39], v[200:203]
    s_waitcnt vmcnt(33)
    ds_read_b128 v[48:51], v121 offset:6144
    ds_read_b64_tr_b16 v[248:249], v207 offset:8960
    ds_read_b64_tr_b16 v[250:251], v207 offset:9120
    ds_read_b64_tr_b16 v[252:253], v207 offset:8992
    ds_read_b64_tr_b16 v[254:255], v207 offset:9152
    s_waitcnt lgkmcnt(10)
    v_mfma_f32_16x16x32_bf16 v[196:199], v[232:235], v[40:43], v[196:199]
    v_mfma_f32_16x16x32_bf16 v[200:203], v[236:239], v[40:43], v[200:203]
    s_waitcnt vmcnt(29)
    s_and_b32 s74, s2, 0x84
    s_cmp_lg_u32 s74, 0
    s_cbranch_scc1 L_za_3
    v_mov_b32 v213, 0
    v_mov_b32 v214, 1
    s_mov_b64 exec, 1
    buffer_atomic_add v214, v213, s[56:59], 0 offen sc1
    s_mov_b64 exec, -1
L_za_3:
    ds_read_b128 v[52:55], v120 offset:8192
    ds_read_b64_tr_b16 v[224:225], v207 offset:10240
    ds_read_b64_tr_b16 v[226:227], v207 offset:10400
    ds_read_b64_tr_b16 v[228:229], v207 offset:10272
    ds_read_b64_tr_b16 v[230:231], v207 offset:10432
    s_waitcnt lgkmcnt(10)
    v_mfma_f32_16x16x32_bf16 v[196:199], v[240:243], v[44:47], v[196:199]
    v_mfma_f32_16x16x32_bf16 v[200:203], v[244:247], v[44:47], v[200:203]
    s_waitcnt vmcnt(28)
    ds_read_b128 v[56:59], v121 offset:8192
    ds_read_b64_tr_b16 v[232:233], v207 offset:11520
    ds_read_b64_tr_b16 v[234:235], v207 offset:11680
    ds_read_b64_tr_b16 v[236:237], v207 offset:11552
    ds_read_b64_tr_b16 v[238:239], v207 offset:11712
    s_waitcnt lgkmcnt(10)
    v_mfma_f32_16x16x32_bf16 v[196:199], v[248:251], v[48:51], v[196:199]
    v_mfma_f32_16x16x32_bf16 v[200:203], v[252:255], v[48:51], v[200:203]
    s_waitcnt vmcnt(25)
    ds_read_b128 v[60:63], v120 offset:10240
    ds_read_b64_tr_b16 v[240:241], v207 offset:12800
    ds_read_b64_tr_b16 v[242:243], v207 offset:12960
    ds_read_b64_tr_b16 v[244:245], v207 offset:12832
    ds_read_b64_tr_b16 v[246:247], v207 offset:12992
    s_waitcnt lgkmcnt(10)
    v_mfma_f32_16x16x32_bf16 v[196:199], v[224:227], v[52:55], v[196:199]
    v_mfma_f32_16x16x32_bf16 v[200:203], v[228:231], v[52:55], v[200:203]
    s_waitcnt vmcnt(24)
    ds_read_b128 v[64:67], v121 offset:10240
    ds_read_b64_tr_b16 v[248:249], v207 offset:14080
    ds_read_b64_tr_b16 v[250:251], v207 offset:14240
    ds_read_b64_tr_b16 v[252:253], v207 offset:14112
    ds_read_b64_tr_b16 v[254:255], v207 offset:14272
    s_waitcnt lgkmcnt(10)
    v_mfma_f32_16x16x32_bf16 v[196:199], v[232:235], v[56:59], v[196:199]
    v_mfma_f32_16x16x32_bf16 v[200:203], v[236:239], v[56:59], v[200:203]
    s_waitcnt vmcnt(20)
    ds_read_b128 v[68:71], v120 offset:12288
    ds_read_b64_tr_b16 v[224:225], v207 offset:15360
    ds_read_b64_tr_b16 v[226:227], v207 offset:15520
    ds_read_b64_tr_b16 v[228:229], v207 offset:15392
    ds_read_b64_tr_b16 v[230:231], v207 offset:15552
    s_waitcnt lgkmcnt(10)
    v_mfma_f32_16x16x32_bf16 v[196:199], v[240:243], v[60:63], v[196:199]
    v_mfma_f32_16x16x32_bf16 v[200:203], v[244:247], v[60:63], v[200:203]
    s_waitcnt vmcnt(19)
    ds_read_b128 v[72:75], v121 offset:12288
    ds_read_b64_tr_b16 v[232:233], v207 offset:16640
    ds_read_b64_tr_b16 v[234:235], v207 offset:16800
    ds_read_b64_tr_b16 v[236:237], v207 offset:16672
    ds_read_b64_tr_b16 v[238:239], v207 offset:16832
    s_waitcnt lgkmcnt(10)
    v_mfma_f32_16x16x32_bf16 v[196:199], v[248:251], v[64:67], v[196:199]
    v_mfma_f32_16x16x32_bf16 v[200:203], v[252:255], v[64:67], v[200:203]
    s_waitcnt vmcnt(16)
    ds_read_b128 v[76:79], v120 offset:14336
    ds_read_b64_tr_b16 v[240:241], v207 offset:17920
    ds_read_b64_tr_b16 v[242:243], v207 offset:18080
    ds_read_b64_tr_b16 v[244:245], v207 offset:17952
    ds_read_b64_tr_b16 v[246:247], v207 offset:18112
    s_waitcnt lgkmcnt(10)
    v_mfma_f32_16x16x32_bf16 v[196:199], v[224:227], v[68:71], v[196:199]
    v_mfma_f32_16x16x32_bf16 v[200:203], v[228:231], v[68:71], v[200:203]
    s_waitcnt vmcnt(15)
    ds_read_b128 v[80:83], v121 offset:14336
    ds_read_b64_tr_b16 v[248:249], v207 offset:19200
    ds_read_b64_tr_b16 v[250:251], v207 offset:19360
    ds_read_b64_tr_b16 v[252:253], v207 offset:19232
    ds_read_b64_tr_b16 v[254:255], v207 offset:19392
    s_waitcnt lgkmcnt(10)
    v_mfma_f32_16x16x32_bf16 v[196:199], v[232:235], v[72:75], v[196:199]
    v_mfma_f32_16x16x32_bf16 v[200:203], v[236:239], v[72:75], v[200:203]
    s_waitcnt vmcnt(11)
    ds_read_b128 v[84:87], v120 offset:16384
    ds_read_b64_tr_b16 v[224:225], v207 offset:20480
    ds_read_b64_tr_b16 v[226:227], v207 offset:20640
    ds_read_b64_tr_b16 v[228:229], v207 offset:20512
    ds_read_b64_tr_b16 v[230:231], v207 offset:20672
    s_waitcnt lgkmcnt(10)
    v_mfma_f32_16x16x32_bf16 v[196:199], v[240:243], v[76:79], v[196:199]
    v_mfma_f32_16x16x32_bf16 v[200:203], v[244:247], v[76:79], v[200:203]
    s_waitcnt vmcnt(10)
    ds_read_b128 v[88:91], v121 offset:16384
    ds_read_b64_tr_b16 v[232:233], v207 offset:21760
    ds_read_b64_tr_b16 v[234:235], v207 offset:21920
    ds_read_b64_tr_b16 v[236:237], v207 offset:21792
    ds_read_b64_tr_b16 v[238:239], v207 offset:21952
    s_waitcnt lgkmcnt(10)
    v_mfma_f32_16x16x32_bf16 v[196:199], v[248:251], v[80:83], v[196:199]
    v_mfma_f32_16x16x32_bf16 v[200:203], v[252:255], v[80:83], v[200:203]
    s_waitcnt vmcnt(7)
    ds_read_b128 v[92:95], v120 offset:18432
    ds_read_b64_tr_b16 v[240:241], v207 offset:23040
    ds_read_b64_tr_b16 v[242:243], v207 offset:23200
    ds_read_b64_tr_b16 v[244:245], v207 offset:23072
    ds_read_b64_tr_b16 v[246:247], v207 offset:23232
    s_waitcnt lgkmcnt(10)
    v_mfma_f32_16x16x32_bf16 v[196:199], v[224:227], v[84:87], v[196:199]
    v_mfma_f32_16x16x32_bf16 v[200:203], v[228:231], v[84:87], v[200:203]
    s_waitcnt vmcnt(6)
    v_mov_b32 v12, 163656
    v_mov_b32 v13, 1
    s_mov_b64 exec, 1
    ds_add_u32 v12, v13
    s_mov_b64 exec, -1
    ds_read_b128 v[96:99], v121 offset:18432
    ds_read_b64_tr_b16 v[248:249], v207 offset:24320
    ds_read_b64_tr_b16 v[250:251], v207 offset:24480
    ds_read_b64_tr_b16 v[252:253], v207 offset:24352
    ds_read_b64_tr_b16 v[254:255], v207 offset:24512
    s_waitcnt lgkmcnt(10)
    v_mfma_f32_16x16x32_bf16 v[196:199], v[232:235], v[88:91], v[196:199]
    v_mfma_f32_16x16x32_bf16 v[200:203], v[236:239], v[88:91], v[200:203]
    s_waitcnt lgkmcnt(5)
    v_mfma_f32_16x16x32_bf16 v[196:199], v[240:243], v[92:95], v[196:199]
    v_mfma_f32_16x16x32_bf16 v[200:203], v[244:247], v[92:95], v[200:203]
    s_waitcnt lgkmcnt(0)
    v_mov_b32 v12, 163660
    v_mov_b32 v13, 1
    s_mov_b64 exec, 1
    ds_add_u32 v12, v13
    s_mov_b64 exec, -1
    v_mov_b32 v12, 163648
    v_mov_b32 v13, 1
    s_mov_b64 exec, 1
    ds_add_u32 v12, v13
    s_mov_b64 exec, -1
    v_mfma_f32_16x16x32_bf16 v[196:199], v[248:251], v[96:99], v[196:199]
    v_mfma_f32_16x16x32_bf16 v[200:203], v[252:255], v[96:99], v[200:203]
    s_nop 6
    v_cvt_pk_bf16_f32 v136, v196, v197
    v_cvt_pk_bf16_f32 v137, v198, v199
    v_cvt_pk_bf16_f32 v138, v200, v201
    v_cvt_pk_bf16_f32 v139, v202, v203
    s_lshl_b32 s75, s75, 4
    v_add_u32 v213, s75, v3
    v_lshrrev_b32 v214, 1, v2
    v_lshl_add_u32 v214, v214, 5, v213
    v_lshlrev_b32 v214, 4, v214
    v_and_b32 v212, 1, v2
    v_lshl_add_u32 v214, v212, 3, v214
    buffer_store_dwordx2 v[136:137], v214, s[52:55], s76 offen sc1
    v_cmp_eq_u32 vcc, 0, v2
    v_lshlrev_b32 v213, 3, v213
    v_add_u32 v213, 1024, v213
    v_mov_b32 v212, 1280
    v_cndmask_b32 v213, v212, v213, vcc
    v_mov_b32 v212, 0x3f803f80
    v_cndmask_b32 v138, v212, v138, vcc
    v_mov_b32 v212, 0x00003f80
    v_cndmask_b32 v139, v212, v139, vcc
    buffer_store_dwordx2 v[138:139], v213, s[52:55], s76 offen sc1
    v_mul_f32 v211, v196, v196
    v_fmac_f32 v211, v197, v197
    v_fmac_f32 v211, v198, v198
    v_fmac_f32 v211, v199, v199
    v_mul_f32 v212, v200, v200
    v_fmac_f32 v212, v201, v201
    v_fmac_f32 v212, v202, v202
    v_fmac_f32 v212, v203, v203
    v_cndmask_b32 v212, 0, v212, vcc
    v_add_f32 v211, v211, v212
    v_mov_b32 v212, v211
    s_nop 1
    v_permlane16_swap_b32 v211, v212
    v_add_f32 v211, v211, v212
    v_mov_b32 v212, v211
    s_nop 1
    v_permlane32_swap_b32 v211, v212
    v_add_f32 v211, v211, v212
    s_nop 1
    v_max_f32_dpp v211, v211, v211 quad_perm:[1,0,3,2] row_mask:0xf bank_mask:0xf
    s_nop 1
    v_max_f32_dpp v211, v211, v211 quad_perm:[2,3,0,1] row_mask:0xf bank_mask:0xf
    s_nop 1
    v_max_f32_dpp v211, v211, v211 row_half_mirror row_mask:0xf bank_mask:0xf
    s_nop 1
    v_max_f32_dpp v211, v211, v211 row_mirror row_mask:0xf bank_mask:0xf
    s_lshl_b32 s75, s65, 2
    s_add_u32 s75, s75, s80
    s_lshl_b32 s75, s75, 2
    s_add_u32 s75, s75, 13893632
    v_mov_b32 v212, 0
    s_mov_b64 exec, 1
    buffer_store_dword v211, v212, s[52:55], s75 offen sc1
    s_mov_b64 exec, -1
    s_branch L_r_kvfin
L_r_kvv:
    ds_read_b128 v[20:23], v120 offset:0
    ds_read_b64_tr_b16 v[224:225], v207 offset:0
    ds_read_b64_tr_b16 v[226:227], v207 offset:160
    ds_read_b64_tr_b16 v[228:229], v207 offset:32
    ds_read_b64_tr_b16 v[230:231], v207 offset:192
    s_waitcnt vmcnt(46)
    ds_read_b128 v[24:27], v121 offset:0
    ds_read_b64_tr_b16 v[232:233], v207 offset:1280
    ds_read_b64_tr_b16 v[234:235], v207 offset:1440
    ds_read_b64_tr_b16 v[236:237], v207 offset:1312
    ds_read_b64_tr_b16 v[238:239], v207 offset:1472
    s_waitcnt vmcnt(43)
    ds_read_b128 v[28:31], v120 offset:2048
    ds_read_b64_tr_b16 v[240:241], v207 offset:2560
    ds_read_b64_tr_b16 v[242:243], v207 offset:2720
    ds_read_b64_tr_b16 v[244:245], v207 offset:2592
    ds_read_b64_tr_b16 v[246:247], v207 offset:2752
    s_waitcnt lgkmcnt(10)
    v_mfma_f32_16x16x32_bf16 v[196:199], v[20:23], v[224:227], 0
    v_mfma_f32_16x16x32_bf16 v[200:203], v[20:23], v[228:231], 0
    s_waitcnt vmcnt(42)
    ds_read_b128 v[32:35], v121 offset:2048
    ds_read_b64_tr_b16 v[248:249], v207 offset:3840
    ds_read_b64_tr_b16 v[250:251], v207 offset:4000
    ds_read_b64_tr_b16 v[252:253], v207 offset:3872
    ds_read_b64_tr_b16 v[254:255], v207 offset:4032
    s_waitcnt lgkmcnt(10)
    v_mfma_f32_16x16x32_bf16 v[196:199], v[24:27], v[232:235], v[196:199]
    v_mfma_f32_16x16x32_bf16 v[200:203], v[24:27], v[236:239], v[200:203]
    s_waitcnt vmcnt(38)
    ds_read_b128 v[36:39], v120 offset:4096
    ds_read_b64_tr_b16 v[224:225], v207 offset:5120
    ds_read_b64_tr_b16 v[226:227], v207 offset:5280
    ds_read_b64_tr_b16 v[228:229], v207 offset:5152
    ds_read_b64_tr_b16 v[230:231], v207 offset:5312
    s_waitcnt lgkmcnt(10)
    v_mfma_f32_16x16x32_bf16 v[196:199], v[28:31], v[240:243], v[196:199]
    v_mfma_f32_16x16x32_bf16 v[200:203], v[28:31], v[244:247], v[200:203]
    s_waitcnt vmcnt(37)
    ds_read_b128 v[40:43], v121 offset:4096
    ds_read_b64_tr_b16 v[232:233], v207 offset:6400
    ds_read_b64_tr_b16 v[234:235], v207 offset:6560
    ds_read_b64_tr_b16 v[236:237], v207 offset:6432
    ds_read_b64_tr_b16 v[238:239], v207 offset:6592
    s_waitcnt lgkmcnt(10)
    v_mfma_f32_16x16x32_bf16 v[196:199], v[32:35], v[248:251], v[196:199]
    v_mfma_f32_16x16x32_bf16 v[200:203], v[32:35], v[252:255], v[200:203]
    s_waitcnt vmcnt(34)
    ds_read_b128 v[44:47], v120 offset:6144
    ds_read_b64_tr_b16 v[240:241], v207 offset:7680
    ds_read_b64_tr_b16 v[242:243], v207 offset:7840
    ds_read_b64_tr_b16 v[244:245], v207 offset:7712
    ds_read_b64_tr_b16 v[246:247], v207 offset:7872
    s_waitcnt lgkmcnt(10)
    v_mfma_f32_16x16x32_bf16 v[196:199], v[36:39], v[224:227], v[196:199]
    v_mfma_f32_16x16x32_bf16 v[200:203], v[36:39], v[228:231], v[200:203]
    s_waitcnt vmcnt(33)
    ds_read_b128 v[48:51], v121 offset:6144
    ds_read_b64_tr_b16 v[248:249], v207 offset:8960
    ds_read_b64_tr_b16 v[250:251], v207 offset:9120
    ds_read_b64_tr_b16 v[252:253], v207 offset:8992
    ds_read_b64_tr_b16 v[254:255], v207 offset:9152
    s_waitcnt lgkmcnt(10)
    v_mfma_f32_16x16x32_bf16 v[196:199], v[40:43], v[232:235], v[196:199]
    v_mfma_f32_16x16x32_bf16 v[200:203], v[40:43], v[236:239], v[200:203]
    s_waitcnt vmcnt(29)
    s_and_b32 s74, s2, 0x84
    s_cmp_lg_u32 s74, 0
    s_cbranch_scc1 L_za_4
    v_mov_b32 v213, 0
    v_mov_b32 v214, 1
    s_mov_b64 exec, 1
    buffer_atomic_add v214, v213, s[56:59], 0 offen sc1
    s_mov_b64 exec, -1
L_za_4:
    ds_read_b128 v[52:55], v120 offset:8192
    ds_read_b64_tr_b16 v[224:225], v207 offset:10240
    ds_read_b64_tr_b16 v[226:227], v207 offset:10400
    ds_read_b64_tr_b16 v[228:229], v207 offset:10272
    ds_read_b64_tr_b16 v[230:231], v207 offset:10432
    s_waitcnt lgkmcnt(10)
    v_mfma_f32_16x16x32_bf16 v[196:199], v[44:47], v[240:243], v[196:199]
    v_mfma_f32_16x16x32_bf16 v[200:203], v[44:47], v[244:247], v[200:203]
    s_waitcnt vmcnt(28)
    ds_read_b128 v[56:59], v121 offset:8192
    ds_read_b64_tr_b16 v[232:233], v207 offset:11520
    ds_read_b64_tr_b16 v[234:235], v207 offset:11680
    ds_read_b64_tr_b16 v[236:237], v207 offset:11552
    ds_read_b64_tr_b16 v[238:239], v207 offset:11712
    s_waitcnt lgkmcnt(10)
    v_mfma_f32_16x16x32_bf16 v[196:199], v[48:51], v[248:251], v[196:199]
    v_mfma_f32_16x16x32_bf16 v[200:203], v[48:51], v[252:255], v[200:203]
    s_waitcnt vmcnt(25)
    ds_read_b128 v[60:63], v120 offset:10240
    ds_read_b64_tr_b16 v[240:241], v207 offset:12800
    ds_read_b64_tr_b16 v[242:243], v207 offset:12960
    ds_read_b64_tr_b16 v[244:245], v207 offset:12832
    ds_read_b64_tr_b16 v[246:247], v207 offset:12992
    s_waitcnt lgkmcnt(10)
    v_mfma_f32_16x16x32_bf16 v[196:199], v[52:55], v[224:227], v[196:199]
    v_mfma_f32_16x16x32_bf16 v[200:203], v[52:55], v[228:231], v[200:203]
    s_waitcnt vmcnt(24)
    ds_read_b128 v[64:67], v121 offset:10240
    ds_read_b64_tr_b16 v[248:249], v207 offset:14080
    ds_read_b64_tr_b16 v[250:251], v207 offset:14240
    ds_read_b64_tr_b16 v[252:253], v207 offset:14112
    ds_read_b64_tr_b16 v[254:255], v207 offset:14272
    s_waitcnt lgkmcnt(10)
    v_mfma_f32_16x16x32_bf16 v[196:199], v[56:59], v[232:235], v[196:199]
    v_mfma_f32_16x16x32_bf16 v[200:203], v[56:59], v[236:239], v[200:203]
    s_waitcnt vmcnt(20)
    ds_read_b128 v[68:71], v120 offset:12288
    ds_read_b64_tr_b16 v[224:225], v207 offset:15360
    ds_read_b64_tr_b16 v[226:227], v207 offset:15520
    ds_read_b64_tr_b16 v[228:229], v207 offset:15392
    ds_read_b64_tr_b16 v[230:231], v207 offset:15552
    s_waitcnt lgkmcnt(10)
    v_mfma_f32_16x16x32_bf16 v[196:199], v[60:63], v[240:243], v[196:199]
    v_mfma_f32_16x16x32_bf16 v[200:203], v[60:63], v[244:247], v[200:203]
    s_waitcnt vmcnt(19)
    ds_read_b128 v[72:75], v121 offset:12288
    ds_read_b64_tr_b16 v[232:233], v207 offset:16640
    ds_read_b64_tr_b16 v[234:235], v207 offset:16800
    ds_read_b64_tr_b16 v[236:237], v207 offset:16672
    ds_read_b64_tr_b16 v[238:239], v207 offset:16832
    s_waitcnt lgkmcnt(10)
    v_mfma_f32_16x16x32_bf16 v[196:199], v[64:67], v[248:251], v[196:199]
    v_mfma_f32_16x16x32_bf16 v[200:203], v[64:67], v[252:255], v[200:203]
    s_waitcnt vmcnt(16)
    ds_read_b128 v[76:79], v120 offset:14336
    ds_read_b64_tr_b16 v[240:241], v207 offset:17920
    ds_read_b64_tr_b16 v[242:243], v207 offset:18080
    ds_read_b64_tr_b16 v[244:245], v207 offset:17952
    ds_read_b64_tr_b16 v[246:247], v207 offset:18112
    s_waitcnt lgkmcnt(10)
    v_mfma_f32_16x16x32_bf16 v[196:199], v[68:71], v[224:227], v[196:199]
    v_mfma_f32_16x16x32_bf16 v[200:203], v[68:71], v[228:231], v[200:203]
    s_waitcnt vmcnt(15)
    ds_read_b128 v[80:83], v121 offset:14336
    ds_read_b64_tr_b16 v[248:249], v207 offset:19200
    ds_read_b64_tr_b16 v[250:251], v207 offset:19360
    ds_read_b64_tr_b16 v[252:253], v207 offset:19232
    ds_read_b64_tr_b16 v[254:255], v207 offset:19392
    s_waitcnt lgkmcnt(10)
    v_mfma_f32_16x16x32_bf16 v[196:199], v[72:75], v[232:235], v[196:199]
    v_mfma_f32_16x16x32_bf16 v[200:203], v[72:75], v[236:239], v[200:203]
    s_waitcnt vmcnt(11)
    ds_read_b128 v[84:87], v120 offset:16384
    ds_read_b64_tr_b16 v[224:225], v207 offset:20480
    ds_read_b64_tr_b16 v[226:227], v207 offset:20640
    ds_read_b64_tr_b16 v[228:229], v207 offset:20512
    ds_read_b64_tr_b16 v[230:231], v207 offset:20672
    s_waitcnt lgkmcnt(10)
    v_mfma_f32_16x16x32_bf16 v[196:199], v[76:79], v[240:243], v[196:199]
    v_mfma_f32_16x16x32_bf16 v[200:203], v[76:79], v[244:247], v[200:203]
    s_waitcnt vmcnt(10)
    ds_read_b128 v[88:91], v121 offset:16384
    ds_read_b64_tr_b16 v[232:233], v207 offset:21760
    ds_read_b64_tr_b16 v[234:235], v207 offset:21920
    ds_read_b64_tr_b16 v[236:237], v207 offset:21792
    ds_read_b64_tr_b16 v[238:239], v207 offset:21952
    s_waitcnt lgkmcnt(10)
    v_mfma_f32_16x16x32_bf16 v[196:199], v[80:83], v[248:251], v[196:199]
    v_mfma_f32_16x16x32_bf16 v[200:203], v[80:83], v[252:255], v[200:203]
    s_waitcnt vmcnt(7)
    ds_read_b128 v[92:95], v120 offset:18432
    ds_read_b64_tr_b16 v[240:241], v207 offset:23040
    ds_read_b64_tr_b16 v[242:243], v207 offset:23200
    ds_read_b64_tr_b16 v[244:245], v207 offset:23072
    ds_read_b64_tr_b16 v[246:247], v207 offset:23232
    s_waitcnt lgkmcnt(10)
    v_mfma_f32_16x16x32_bf16 v[196:199], v[84:87], v[224:227], v[196:199]
    v_mfma_f32_16x16x32_bf16 v[200:203], v[84:87], v[228:231], v[200:203]
    s_waitcnt vmcnt(6)
    v_mov_b32 v12, 163656
    v_mov_b32 v13, 1
    s_mov_b64 exec, 1
    ds_add_u32 v12, v13
    s_mov_b64 exec, -1
    ds_read_b128 v[96:99], v121 offset:18432
    ds_read_b64_tr_b16 v[248:249], v207 offset:24320
    ds_read_b64_tr_b16 v[250:251], v207 offset:24480
    ds_read_b64_tr_b16 v[252:253], v207 offset:24352
    ds_read_b64_tr_b16 v[254:255], v207 offset:24512
    s_waitcnt lgkmcnt(10)
    v_mfma_f32_16x16x32_bf16 v[196:199], v[88:91], v[232:235], v[196:199]
    v_mfma_f32_16x16x32_bf16 v[200:203], v[88:91], v[236:239], v[200:203]
    s_waitcnt lgkmcnt(5)
    v_mfma_f32_16x16x32_bf16 v[196:199], v[92:95], v[240:243], v[196:199]
    v_mfma_f32_16x16x32_bf16 v[200:203], v[92:95], v[244:247], v[200:203]
    s_waitcnt lgkmcnt(0)
    v_mov_b32 v12, 163660
    v_mov_b32 v13, 1
    s_mov_b64 exec, 1
    ds_add_u32 v12, v13
    s_mov_b64 exec, -1
    v_mov_b32 v12, 163648
    v_mov_b32 v13, 1
    s_mov_b64 exec, 1
    ds_add_u32 v12, v13
    s_mov_b64 exec, -1
    v_mfma_f32_16x16x32_bf16 v[196:199], v[96:99], v[248:251], v[196:199]
    v_mfma_f32_16x16x32_bf16 v[200:203], v[96:99], v[252:255], v[200:203]
    s_nop 6
    v_cvt_pk_bf16_f32 v136, v196, v197
    v_cvt_pk_bf16_f32 v137, v198, v199
    v_cvt_pk_bf16_f32 v138, v200, v201
    v_cvt_pk_bf16_f32 v139, v202, v203
    s_mul_i32 s75, s75, 672
    s_add_u32 s76, s76, s75
    s_add_u32 s76, s76, 1344
    v_and_b32 v211, 1, v2
    v_mul_u32_u24 v211, 336, v211
    v_lshrrev_b32 v212, 1, v2
    v_lshl_add_u32 v211, v212, 3, v211
    v_lshl_add_u32 v212, v3, 4, v211
    buffer_store_dwordx2 v[136:137], v212, s[52:55], s76 offen sc1
    v_min_u32 v213, 4, v3
    v_add_u32 v213, 16, v213
    v_lshl_add_u32 v212, v213, 4, v211
    v_cmp_gt_u32 vcc, 4, v3
    v_mov_b32 v213, 0x3f803f80
    s_nop 0
    v_cndmask_b32 v138, v213, v138, vcc
    v_cndmask_b32 v139, v213, v139, vcc
    buffer_store_dwordx2 v[138:139], v212, s[52:55], s76 offen sc1
L_r_kvfin:
    s_waitcnt vmcnt(3)
L_role_fin2:
    s_setprio 1
    s_and_b32 s70, s65, 1
    s_lshr_b32 s74, s65, 1
    s_mul_i32 s74, s74, 5
    s_mul_i32 s75, s66, 80
    s_add_u32 s74, s74, s75
    s_mul_i32 s75, s70, 3
    s_add_u32 s71, s74, s75
    s_add_u32 s72, s71, 1
    s_add_u32 s73, s74, 2
    s_mul_i32 s88, s64, 3
    s_min_u32 s88, s88, 18
    s_lshl_b32 s88, s88, 10
    s_lshr_b32 s98, s64, 2
    s_lshl_b32 s74, s98, 5
    v_add_u32 v255, s74, v10
    v_mul_u32_u24 v255, 160, v255
    s_mul_i32 s74, s67, 40
    s_add_u32 s74, s74, 128064
    v_add_u32 v255, s74, v255
    v_lshl_add_u32 v254, v11, 4, v255
    s_lshl_b32 s74, s64, 6
    v_add_u32 v12, s74, v1
    v_mul_u32_u24 v13, 13108, v12
    v_lshrrev_b32 v13, 16, v13
    v_mul_u32_u24 v14, 5, v13
    v_sub_u32 v12, v12, v14
    v_min_u32 v12, 3, v12
    v_lshlrev_b32 v12, 4, v12
    v_lshl_add_u32 v244, v13, 6, v12
    v_lshlrev_b32 v12, 3, v10
    v_add_u32 v12, 1024, v12
    v_mov_b32 v13, 1280
    v_cmp_eq_u32 vcc, 0, v11
    s_nop 1
    v_cndmask_b32 v12, v13, v12, vcc
    v_lshlrev_b32 v13, 4, v10
    v_mul_u32_u24 v14, 336, v11
    v_add3_u32 v13, v13, v14, 0
    v_add_u32 v245, 102400, v9
    v_add_u32 v248, 102400, v12
    v_add_u32 v251, 103744, v13
    v_add_u32 v246, 138304, v9
    v_add_u32 v249, 138304, v12
    v_add_u32 v252, 139648, v13
    v_add_u32 v247, 0, v9
    v_add_u32 v250, 0, v12
    v_add_u32 v253, 1344, v13
    s_mov_b32 s90, 0x001fffff
    s_mov_b32 s91, 0x001fffff
    s_mul_i32 s81, s64, 11
    s_lshr_b32 s81, s81, 5
    s_mul_i32 s74, s81, 3
    s_sub_u32 s82, s64, s74
    s_sub_u32 s74, s64, 5
    s_mul_i32 s74, s74, s70
    s_cmp_ge_u32 s64, 6
    s_cselect_b32 s82, s74, s82
    s_cmp_eq_u32 s81, 0
    s_cselect_b32 s83, s71, s73
    s_cmp_eq_u32 s81, 1
    s_cselect_b32 s83, s72, s83
    s_xor_b32 s74, s70, 1
    s_cmp_eq_u32 s64, 7
    s_cselect_b32 s84, s74, 0
    s_mov_b32 s94, -1
    s_mov_b32 s95, 0
    s_mov_b32 s89, 0
    s_mov_b32 s44, s30
    s_mov_b32 s45, s31
    s_mov_b32 s46, 819200
    s_mov_b32 s47, 0x20000
    s_mov_b32 s60, s20
    s_mov_b32 s61, s21
    s_mov_b32 s62, 1280
    s_mov_b32 s63, 0x20000
    v_bfe_u32 v12, v1, 2, 3
    v_lshrrev_b32 v13, 5, v1
    v_lshl_or_b32 v12, v13, 4, v12
    v_mul_u32_u24 v12, 160, v12
    v_and_b32 v13, 3, v1
    v_lshl_add_u32 v205, v13, 3, v12
    v_add_u32 v206, 81920, v205
    v_mov_b32 v209, 163652
    s_lshl_b32 s74, s67, 4
    v_add_u32 v210, s74, v3
    v_lshlrev_b32 v212, 2, v210
    v_add_u32 v212, 123904, v212
    v_mul_u32_u24 v210, 160, v210
    v_lshl_add_u32 v210, v2, 3, v210
    v_add_u32 v210, 128064, v210
    v_mfma_f32_16x16x32_bf16 v[120:123], v[100:103], v[20:23], 0
    v_mfma_f32_16x16x32_bf16 v[124:127], v[100:103], v[24:27], 0
    v_mfma_f32_16x16x32_bf16 v[128:131], v[100:103], v[28:31], 0
    v_mfma_f32_16x16x32_bf16 v[132:135], v[100:103], v[32:35], 0
    v_mfma_f32_16x16x32_bf16 v[120:123], v[104:107], v[36:39], v[120:123]
    v_mfma_f32_16x16x32_bf16 v[124:127], v[104:107], v[40:43], v[124:127]
    v_mfma_f32_16x16x32_bf16 v[128:131], v[104:107], v[44:47], v[128:131]
    v_mfma_f32_16x16x32_bf16 v[132:135], v[104:107], v[48:51], v[132:135]
    v_mfma_f32_16x16x32_bf16 v[120:123], v[108:111], v[52:55], v[120:123]
    v_mfma_f32_16x16x32_bf16 v[124:127], v[108:111], v[56:59], v[124:127]
    v_mfma_f32_16x16x32_bf16 v[128:131], v[108:111], v[60:63], v[128:131]
    v_mfma_f32_16x16x32_bf16 v[132:135], v[108:111], v[64:67], v[132:135]
    v_mfma_f32_16x16x32_bf16 v[120:123], v[112:115], v[68:71], v[120:123]
    v_mfma_f32_16x16x32_bf16 v[124:127], v[112:115], v[72:75], v[124:127]
    v_mfma_f32_16x16x32_bf16 v[128:131], v[112:115], v[76:79], v[128:131]
    v_mfma_f32_16x16x32_bf16 v[132:135], v[112:115], v[80:83], v[132:135]
    v_mfma_f32_16x16x32_bf16 v[120:123], v[116:119], v[84:87], v[120:123]
    v_mfma_f32_16x16x32_bf16 v[124:127], v[116:119], v[88:91], v[124:127]
    v_mfma_f32_16x16x32_bf16 v[128:131], v[116:119], v[92:95], v[128:131]
    v_mfma_f32_16x16x32_bf16 v[132:135], v[116:119], v[96:99], v[132:135]
    s_cmp_lg_u32 s69, 0
    s_cbranch_scc1 L_kf_5
    s_and_b32 s75, s2, 0x84
    s_cmp_lg_u32 s75, 0
    s_cbranch_scc1 L_kf_5
    s_waitcnt vmcnt(0)
    s_lshr_b32 s74, s2, 6
    s_lshl_b32 s74, s74, 3
    s_add_u32 s74, s74, s66
    s_lshl_b32 s74, s74, 2
    s_and_b32 s75, s2, 3
    s_add_u32 s74, s74, s75
    s_lshl_b32 s74, s74, 4
    s_add_u32 s74, s74, 14057472
    v_mov_b32 v214, 1
    v_lshlrev_b32 v213, 10, v1
    s_mov_b32 exec_lo, 15
    s_mov_b32 exec_hi, 0
    buffer_store_dword v214, v213, s[52:55], s74 offen sc1
    s_mov_b64 exec, -1
L_kf_5:
    s_nop 7
    v_add_f32 v121, v120, v125
    v_add_f32 v122, v130, v135
    v_add_f32 v121, v121, v122
    v_cvt_pk_bf16_f32 v121, v121, v121
    v_lshlrev_b32 v121, 16, v121
    v_mul_f32 v121, 0xbfb8aa3b, v121
    v_exp_f32 v121, v121
    s_nop 0
    v_add_f32 v121, 1.0, v121
    v_rcp_f32 v121, v121
    s_nop 0
    v_cvt_pk_bf16_f32 v121, v121, v121
    v_lshlrev_b32 v121, 16, v121
    v_mov_b32 v126, 0x3ea52b5c
    v_mov_b32 v128, 163668
    v_mov_b32 v209, 163652
    s_mov_b32 s99, 0
L_qw0_6:
    ds_read_b32 v208, v209
    s_waitcnt lgkmcnt(0)
    v_readfirstlane_b32 s74, v208
    s_nop 0
    s_cmp_ge_u32 s74, 2
    s_cbranch_scc1 L_qw0d_7
    s_add_u32 s99, s99, 1
    s_cmp_lt_u32 s99, 2097152
    s_cbranch_scc1 L_qw0_6
L_qw0d_7:
    s_lshr_b32 s74, s2, 6
    s_cmp_eq_u32 s74, 1
    s_cbranch_scc1 L_qg1
    s_cmp_eq_u32 s74, 2
    s_cbranch_scc1 L_qg2
    s_cmp_eq_u32 s74, 3
    s_cbranch_scc1 L_qg3
    s_cmp_lg_u32 s69, 3
    s_cbranch_scc1 L_zi_8
    v_mov_b32 v213, 0
    buffer_load_dword v214, v213, s[56:59], 0 offen sc1
L_zi_8:
    ds_read_b64_tr_b16 v[136:137], v206 offset:0
    ds_read_b64_tr_b16 v[138:139], v206 offset:1280
    ds_read_b64_tr_b16 v[140:141], v206 offset:32
    ds_read_b64_tr_b16 v[142:143], v206 offset:1312
    ds_read_b64_tr_b16 v[144:145], v206 offset:64
    ds_read_b64_tr_b16 v[146:147], v206 offset:1344
    ds_read_b64_tr_b16 v[148:149], v206 offset:96
    ds_read_b64_tr_b16 v[150:151], v206 offset:1376
    ds_read_b64_tr_b16 v[152:153], v206 offset:128
    ds_read_b64_tr_b16 v[154:155], v206 offset:1408
    ds_read_b32 v208, v209
    s_waitcnt lgkmcnt(7)
    v_mfma_f32_16x16x32_bf16 v[176:179], v[136:139], v[20:23], 0
    ds_read_b64_tr_b16 v[156:157], v206 offset:5120
    ds_read_b64_tr_b16 v[158:159], v206 offset:6400
    v_mfma_f32_16x16x32_bf16 v[180:183], v[140:143], v[20:23], 0
    ds_read_b64_tr_b16 v[160:161], v206 offset:5152
    ds_read_b64_tr_b16 v[162:163], v206 offset:6432
    s_waitcnt lgkmcnt(5)
    v_mfma_f32_16x16x32_bf16 v[184:187], v[144:147], v[20:23], 0
    ds_read_b64_tr_b16 v[164:165], v206 offset:5184
    ds_read_b64_tr_b16 v[166:167], v206 offset:6464
    v_mfma_f32_16x16x32_bf16 v[188:191], v[148:151], v[20:23], 0
    ds_read_b64_tr_b16 v[168:169], v206 offset:5216
    ds_read_b64_tr_b16 v[170:171], v206 offset:6496
    s_waitcnt lgkmcnt(8)
    v_cmp_gt_u32 vcc, 3, v208
    v_mfma_f32_16x16x32_bf16 v[192:195], v[152:155], v[20:23], 0
    ds_read_b64_tr_b16 v[172:173], v206 offset:5248
    ds_read_b64_tr_b16 v[174:175], v206 offset:6528
    s_cbranch_vccnz L_qw_9
L_qwr_10:
    ds_read_b32 v208, v209
    s_waitcnt lgkmcnt(7)
    v_mfma_f32_16x16x32_bf16 v[176:179], v[156:159], v[24:27], v[176:179]
    ds_read_b64_tr_b16 v[136:137], v206 offset:10240
    ds_read_b64_tr_b16 v[138:139], v206 offset:11520
    v_mfma_f32_16x16x32_bf16 v[180:183], v[160:163], v[24:27], v[180:183]
    ds_read_b64_tr_b16 v[140:141], v206 offset:10272
    ds_read_b64_tr_b16 v[142:143], v206 offset:11552
    s_waitcnt lgkmcnt(5)
    v_mfma_f32_16x16x32_bf16 v[184:187], v[164:167], v[24:27], v[184:187]
    ds_read_b64_tr_b16 v[144:145], v206 offset:10304
    ds_read_b64_tr_b16 v[146:147], v206 offset:11584
    v_mfma_f32_16x16x32_bf16 v[188:191], v[168:171], v[24:27], v[188:191]
    ds_read_b64_tr_b16 v[148:149], v206 offset:10336
    ds_read_b64_tr_b16 v[150:151], v206 offset:11616
    s_waitcnt lgkmcnt(8)
    v_cmp_gt_u32 vcc, 4, v208
    v_mfma_f32_16x16x32_bf16 v[192:195], v[172:175], v[24:27], v[192:195]
    ds_read_b64_tr_b16 v[152:153], v206 offset:10368
    ds_read_b64_tr_b16 v[154:155], v206 offset:11648
    s_cbranch_vccnz L_qw_11
L_qwr_12:
    ds_read_b32 v208, v209
    s_waitcnt lgkmcnt(7)
    v_mfma_f32_16x16x32_bf16 v[176:179], v[136:139], v[28:31], v[176:179]
    ds_read_b64_tr_b16 v[156:157], v206 offset:15360
    ds_read_b64_tr_b16 v[158:159], v206 offset:16640
    v_mfma_f32_16x16x32_bf16 v[180:183], v[140:143], v[28:31], v[180:183]
    ds_read_b64_tr_b16 v[160:161], v206 offset:15392
    ds_read_b64_tr_b16 v[162:163], v206 offset:16672
    s_waitcnt lgkmcnt(5)
    v_mfma_f32_16x16x32_bf16 v[184:187], v[144:147], v[28:31], v[184:187]
    ds_read_b64_tr_b16 v[164:165], v206 offset:15424
    ds_read_b64_tr_b16 v[166:167], v206 offset:16704
    v_mfma_f32_16x16x32_bf16 v[188:191], v[148:151], v[28:31], v[188:191]
    ds_read_b64_tr_b16 v[168:169], v206 offset:15456
    ds_read_b64_tr_b16 v[170:171], v206 offset:16736
    s_waitcnt lgkmcnt(8)
    v_cmp_gt_u32 vcc, 5, v208
    v_mfma_f32_16x16x32_bf16 v[192:195], v[152:155], v[28:31], v[192:195]
    ds_read_b64_tr_b16 v[172:173], v206 offset:15488
    ds_read_b64_tr_b16 v[174:175], v206 offset:16768
    s_cbranch_vccnz L_qw_13
L_qwr_14:
    ds_read_b32 v208, v209
    s_waitcnt lgkmcnt(7)
    v_mfma_f32_16x16x32_bf16 v[176:179], v[156:159], v[32:35], v[176:179]
    ds_read_b64_tr_b16 v[136:137], v206 offset:46144
    ds_read_b64_tr_b16 v[138:139], v206 offset:47424
    v_mfma_f32_16x16x32_bf16 v[180:183], v[160:163], v[32:35], v[180:183]
    ds_read_b64_tr_b16 v[140:141], v206 offset:46176
    ds_read_b64_tr_b16 v[142:143], v206 offset:47456
    s_waitcnt lgkmcnt(5)
    v_mfma_f32_16x16x32_bf16 v[184:187], v[164:167], v[32:35], v[184:187]
    ds_read_b64_tr_b16 v[144:145], v206 offset:46208
    ds_read_b64_tr_b16 v[146:147], v206 offset:47488
    v_mfma_f32_16x16x32_bf16 v[188:191], v[168:171], v[32:35], v[188:191]
    ds_read_b64_tr_b16 v[148:149], v206 offset:46240
    ds_read_b64_tr_b16 v[150:151], v206 offset:47520
    s_waitcnt lgkmcnt(8)
    v_cmp_gt_u32 vcc, 6, v208
    v_mfma_f32_16x16x32_bf16 v[192:195], v[172:175], v[32:35], v[192:195]
    ds_read_b64_tr_b16 v[152:153], v206 offset:46272
    ds_read_b64_tr_b16 v[154:155], v206 offset:47552
    s_cmp_lg_u32 s69, 3
    s_cbranch_scc1 L_ze_15
    s_waitcnt vmcnt(0)
    v_readfirstlane_b32 s74, v214
    s_nop 0
    s_cmp_ge_u32 s74, 64
    s_cselect_b32 s74, 1, 0
    v_mov_b32 v214, s74
    v_mov_b32 v213, 163672
    s_mov_b64 exec, 1
    ds_write_b32 v213, v214
    s_mov_b64 exec, -1
L_ze_15:
    s_cbranch_vccnz L_qw_16
L_qwr_17:
    ds_read_b32 v208, v209
    s_waitcnt lgkmcnt(7)
    v_mfma_f32_16x16x32_bf16 v[176:179], v[136:139], v[36:39], v[176:179]
    ds_read_b64_tr_b16 v[156:157], v206 offset:51264
    ds_read_b64_tr_b16 v[158:159], v206 offset:52544
    v_mfma_f32_16x16x32_bf16 v[180:183], v[140:143], v[36:39], v[180:183]
    ds_read_b64_tr_b16 v[160:161], v206 offset:51296
    ds_read_b64_tr_b16 v[162:163], v206 offset:52576
    s_waitcnt lgkmcnt(5)
    v_mfma_f32_16x16x32_bf16 v[184:187], v[144:147], v[36:39], v[184:187]
    ds_read_b64_tr_b16 v[164:165], v206 offset:51328
    ds_read_b64_tr_b16 v[166:167], v206 offset:52608
    v_mfma_f32_16x16x32_bf16 v[188:191], v[148:151], v[36:39], v[188:191]
    ds_read_b64_tr_b16 v[168:169], v206 offset:51360
    ds_read_b64_tr_b16 v[170:171], v206 offset:52640
    s_waitcnt lgkmcnt(8)
    v_cmp_gt_u32 vcc, 8, v208
    v_mfma_f32_16x16x32_bf16 v[192:195], v[152:155], v[36:39], v[192:195]
    ds_read_b64_tr_b16 v[172:173], v206 offset:51392
    ds_read_b64_tr_b16 v[174:175], v206 offset:52672
    s_cbranch_vccnz L_qw_18
L_qwr_19:
    s_waitcnt lgkmcnt(6)
    v_mfma_f32_16x16x32_bf16 v[176:179], v[156:159], v[40:43], v[176:179]
    ds_read_b64_tr_b16 v[136:137], v206 offset:20480
    ds_read_b64_tr_b16 v[138:139], v206 offset:21760
    v_mfma_f32_16x16x32_bf16 v[180:183], v[160:163], v[40:43], v[180:183]
    ds_read_b64_tr_b16 v[140:141], v206 offset:20512
    ds_read_b64_tr_b16 v[142:143], v206 offset:21792
    s_waitcnt lgkmcnt(4)
    v_mfma_f32_16x16x32_bf16 v[184:187], v[164:167], v[40:43], v[184:187]
    ds_read_b64_tr_b16 v[144:145], v206 offset:20544
    ds_read_b64_tr_b16 v[146:147], v206 offset:21824
    v_mfma_f32_16x16x32_bf16 v[188:191], v[168:171], v[40:43], v[188:191]
    ds_read_b64_tr_b16 v[148:149], v206 offset:20576
    ds_read_b64_tr_b16 v[150:151], v206 offset:21856
    v_mfma_f32_16x16x32_bf16 v[192:195], v[172:175], v[40:43], v[192:195]
    ds_read_b64_tr_b16 v[152:153], v206 offset:20608
    ds_read_b64_tr_b16 v[154:155], v206 offset:21888
    ds_read_b32 v208, v209
    s_waitcnt lgkmcnt(7)
    v_mfma_f32_16x16x32_bf16 v[176:179], v[136:139], v[44:47], v[176:179]
    ds_read_b64_tr_b16 v[156:157], v206 offset:25600
    ds_read_b64_tr_b16 v[158:159], v206 offset:26880
    v_mfma_f32_16x16x32_bf16 v[180:183], v[140:143], v[44:47], v[180:183]
    ds_read_b64_tr_b16 v[160:161], v206 offset:25632
    ds_read_b64_tr_b16 v[162:163], v206 offset:26912
    s_waitcnt lgkmcnt(5)
    v_mfma_f32_16x16x32_bf16 v[184:187], v[144:147], v[44:47], v[184:187]
    ds_read_b64_tr_b16 v[164:165], v206 offset:25664
    ds_read_b64_tr_b16 v[166:167], v206 offset:26944
    v_mfma_f32_16x16x32_bf16 v[188:191], v[148:151], v[44:47], v[188:191]
    ds_read_b64_tr_b16 v[168:169], v206 offset:25696
    ds_read_b64_tr_b16 v[170:171], v206 offset:26976
    s_waitcnt lgkmcnt(8)
    v_cmp_gt_u32 vcc, 10, v208
    v_mfma_f32_16x16x32_bf16 v[192:195], v[152:155], v[44:47], v[192:195]
    ds_read_b64_tr_b16 v[172:173], v206 offset:25728
    ds_read_b64_tr_b16 v[174:175], v206 offset:27008
    s_cbranch_vccnz L_qw_20
L_qwr_21:
    s_waitcnt lgkmcnt(6)
    v_mfma_f32_16x16x32_bf16 v[176:179], v[156:159], v[48:51], v[176:179]
    ds_read_b64_tr_b16 v[136:137], v206 offset:30720
    ds_read_b64_tr_b16 v[138:139], v206 offset:32000
    v_mfma_f32_16x16x32_bf16 v[180:183], v[160:163], v[48:51], v[180:183]
    ds_read_b64_tr_b16 v[140:141], v206 offset:30752
    ds_read_b64_tr_b16 v[142:143], v206 offset:32032
    s_waitcnt lgkmcnt(4)
    v_mfma_f32_16x16x32_bf16 v[184:187], v[164:167], v[48:51], v[184:187]
    ds_read_b64_tr_b16 v[144:145], v206 offset:30784
    ds_read_b64_tr_b16 v[146:147], v206 offset:32064
    v_mfma_f32_16x16x32_bf16 v[188:191], v[168:171], v[48:51], v[188:191]
    ds_read_b64_tr_b16 v[148:149], v206 offset:30816
    ds_read_b64_tr_b16 v[150:151], v206 offset:32096
    v_mfma_f32_16x16x32_bf16 v[192:195], v[172:175], v[48:51], v[192:195]
    ds_read_b64_tr_b16 v[152:153], v206 offset:30848
    ds_read_b64_tr_b16 v[154:155], v206 offset:32128
    ds_read_b32 v208, v209
    s_cmp_eq_u32 s69, 3
    s_cbranch_scc1 L_sd_22
    s_waitcnt vmcnt(0)
    v_mov_b32 v213, 163676
    v_mov_b32 v214, 1
    s_mov_b64 exec, 1
    ds_add_u32 v213, v214
    s_mov_b64 exec, -1
L_sd_22:
    s_waitcnt lgkmcnt(7)
    v_mfma_f32_16x16x32_bf16 v[176:179], v[136:139], v[52:55], v[176:179]
    ds_read_b64_tr_b16 v[156:157], v206 offset:35840
    ds_read_b64_tr_b16 v[158:159], v206 offset:37120
    v_mfma_f32_16x16x32_bf16 v[180:183], v[140:143], v[52:55], v[180:183]
    ds_read_b64_tr_b16 v[160:161], v206 offset:35872
    ds_read_b64_tr_b16 v[162:163], v206 offset:37152
    s_waitcnt lgkmcnt(5)
    v_mfma_f32_16x16x32_bf16 v[184:187], v[144:147], v[52:55], v[184:187]
    ds_read_b64_tr_b16 v[164:165], v206 offset:35904
    ds_read_b64_tr_b16 v[166:167], v206 offset:37184
    v_mfma_f32_16x16x32_bf16 v[188:191], v[148:151], v[52:55], v[188:191]
    ds_read_b64_tr_b16 v[168:169], v206 offset:35936
    ds_read_b64_tr_b16 v[170:171], v206 offset:37216
    s_waitcnt lgkmcnt(8)
    v_cmp_gt_u32 vcc, 11, v208
    v_mfma_f32_16x16x32_bf16 v[192:195], v[152:155], v[52:55], v[192:195]
    ds_read_b64_tr_b16 v[172:173], v206 offset:35968
    ds_read_b64_tr_b16 v[174:175], v206 offset:37248
    s_cbranch_vccnz L_qw_23
L_qwr_24:
    ds_read_b32 v208, v209
    s_waitcnt lgkmcnt(7)
    v_mfma_f32_16x16x32_bf16 v[176:179], v[156:159], v[56:59], v[176:179]
    ds_read_b64_tr_b16 v[136:137], v206 offset:40960
    ds_read_b64_tr_b16 v[138:139], v206 offset:42240
    v_mfma_f32_16x16x32_bf16 v[180:183], v[160:163], v[56:59], v[180:183]
    ds_read_b64_tr_b16 v[140:141], v206 offset:40992
    ds_read_b64_tr_b16 v[142:143], v206 offset:42272
    s_waitcnt lgkmcnt(5)
    v_mfma_f32_16x16x32_bf16 v[184:187], v[164:167], v[56:59], v[184:187]
    ds_read_b64_tr_b16 v[144:145], v206 offset:41024
    ds_read_b64_tr_b16 v[146:147], v206 offset:42304
    v_mfma_f32_16x16x32_bf16 v[188:191], v[168:171], v[56:59], v[188:191]
    ds_read_b64_tr_b16 v[148:149], v206 offset:41056
    ds_read_b64_tr_b16 v[150:151], v206 offset:42336
    s_waitcnt lgkmcnt(8)
    v_cmp_gt_u32 vcc, 13, v208
    v_mfma_f32_16x16x32_bf16 v[192:195], v[172:175], v[56:59], v[192:195]
    ds_read_b64_tr_b16 v[152:153], v206 offset:41088
    ds_read_b64_tr_b16 v[154:155], v206 offset:42368
    s_cbranch_vccnz L_qw_25
L_qwr_26:
    s_waitcnt lgkmcnt(6)
    v_mfma_f32_16x16x32_bf16 v[176:179], v[136:139], v[60:63], v[176:179]
    ds_read_b64_tr_b16 v[156:157], v205 offset:0
    ds_read_b64_tr_b16 v[158:159], v205 offset:1280
    v_mfma_f32_16x16x32_bf16 v[180:183], v[140:143], v[60:63], v[180:183]
    ds_read_b64_tr_b16 v[160:161], v205 offset:32
    ds_read_b64_tr_b16 v[162:163], v205 offset:1312
    s_waitcnt lgkmcnt(4)
    v_mfma_f32_16x16x32_bf16 v[184:187], v[144:147], v[60:63], v[184:187]
    ds_read_b64_tr_b16 v[164:165], v205 offset:64
    ds_read_b64_tr_b16 v[166:167], v205 offset:1344
    v_mfma_f32_16x16x32_bf16 v[188:191], v[148:151], v[60:63], v[188:191]
    ds_read_b64_tr_b16 v[168:169], v205 offset:96
    ds_read_b64_tr_b16 v[170:171], v205 offset:1376
    v_mfma_f32_16x16x32_bf16 v[192:195], v[152:155], v[60:63], v[192:195]
    ds_read_b64_tr_b16 v[172:173], v205 offset:128
    ds_read_b64_tr_b16 v[174:175], v205 offset:1408
    ds_read_b32 v208, v209
    v_mov_b32 v12, 163668
    v_mov_b32 v13, 1
    s_mov_b64 exec, 1
    ds_add_u32 v12, v13
    s_mov_b64 exec, -1
    s_waitcnt lgkmcnt(8)
    v_mfma_f32_16x16x32_bf16 v[176:179], v[156:159], v[64:67], v[176:179]
    ds_read_b64_tr_b16 v[136:137], v205 offset:5120
    ds_read_b64_tr_b16 v[138:139], v205 offset:6400
    v_mfma_f32_16x16x32_bf16 v[180:183], v[160:163], v[64:67], v[180:183]
    ds_read_b64_tr_b16 v[140:141], v205 offset:5152
    ds_read_b64_tr_b16 v[142:143], v205 offset:6432
    s_waitcnt lgkmcnt(6)
    v_mfma_f32_16x16x32_bf16 v[184:187], v[164:167], v[64:67], v[184:187]
    ds_read_b64_tr_b16 v[144:145], v205 offset:5184
    ds_read_b64_tr_b16 v[146:147], v205 offset:6464
    v_mfma_f32_16x16x32_bf16 v[188:191], v[168:171], v[64:67], v[188:191]
    ds_read_b64_tr_b16 v[148:149], v205 offset:5216
    ds_read_b64_tr_b16 v[150:151], v205 offset:6496
    s_waitcnt lgkmcnt(9)
    v_cmp_gt_u32 vcc, 15, v208
    v_mfma_f32_16x16x32_bf16 v[192:195], v[172:175], v[64:67], v[192:195]
    ds_read_b64_tr_b16 v[152:153], v205 offset:5248
    ds_read_b64_tr_b16 v[154:155], v205 offset:6528
    s_cbranch_vccnz L_qw_27
L_qwr_28:
    s_waitcnt lgkmcnt(6)
    v_mfma_f32_16x16x32_bf16 v[176:179], v[136:139], v[68:71], v[176:179]
    ds_read_b64_tr_b16 v[156:157], v205 offset:10240
    ds_read_b64_tr_b16 v[158:159], v205 offset:11520
    v_mfma_f32_16x16x32_bf16 v[180:183], v[140:143], v[68:71], v[180:183]
    ds_read_b64_tr_b16 v[160:161], v205 offset:10272
    ds_read_b64_tr_b16 v[162:163], v205 offset:11552
    s_waitcnt lgkmcnt(4)
    v_mfma_f32_16x16x32_bf16 v[184:187], v[144:147], v[68:71], v[184:187]
    ds_read_b64_tr_b16 v[164:165], v205 offset:10304
    ds_read_b64_tr_b16 v[166:167], v205 offset:11584
    v_mfma_f32_16x16x32_bf16 v[188:191], v[148:151], v[68:71], v[188:191]
    ds_read_b64_tr_b16 v[168:169], v205 offset:10336
    ds_read_b64_tr_b16 v[170:171], v205 offset:11616
    v_mfma_f32_16x16x32_bf16 v[192:195], v[152:155], v[68:71], v[192:195]
    ds_read_b64_tr_b16 v[172:173], v205 offset:10368
    ds_read_b64_tr_b16 v[174:175], v205 offset:11648
    ds_read_b32 v208, v209
    s_waitcnt lgkmcnt(7)
    v_mfma_f32_16x16x32_bf16 v[176:179], v[156:159], v[72:75], v[176:179]
    ds_read_b64_tr_b16 v[136:137], v205 offset:15360
    ds_read_b64_tr_b16 v[138:139], v205 offset:16640
    v_mfma_f32_16x16x32_bf16 v[180:183], v[160:163], v[72:75], v[180:183]
    ds_read_b64_tr_b16 v[140:141], v205 offset:15392
    ds_read_b64_tr_b16 v[142:143], v205 offset:16672
    s_waitcnt lgkmcnt(5)
    v_mfma_f32_16x16x32_bf16 v[184:187], v[164:167], v[72:75], v[184:187]
    ds_read_b64_tr_b16 v[144:145], v205 offset:15424
    ds_read_b64_tr_b16 v[146:147], v205 offset:16704
    v_mfma_f32_16x16x32_bf16 v[188:191], v[168:171], v[72:75], v[188:191]
    ds_read_b64_tr_b16 v[148:149], v205 offset:15456
    ds_read_b64_tr_b16 v[150:151], v205 offset:16736
    s_waitcnt lgkmcnt(8)
    v_cmp_gt_u32 vcc, 17, v208
    v_mfma_f32_16x16x32_bf16 v[192:195], v[172:175], v[72:75], v[192:195]
    ds_read_b64_tr_b16 v[152:153], v205 offset:15488
    ds_read_b64_tr_b16 v[154:155], v205 offset:16768
    s_cbranch_vccnz L_qw_29
L_qwr_30:
    s_waitcnt lgkmcnt(6)
    v_mfma_f32_16x16x32_bf16 v[176:179], v[136:139], v[76:79], v[176:179]
    ds_read_b64_tr_b16 v[156:157], v205 offset:20480
    ds_read_b64_tr_b16 v[158:159], v205 offset:21760
    v_mfma_f32_16x16x32_bf16 v[180:183], v[140:143], v[76:79], v[180:183]
    ds_read_b64_tr_b16 v[160:161], v205 offset:20512
    ds_read_b64_tr_b16 v[162:163], v205 offset:21792
    s_waitcnt lgkmcnt(4)
    v_mfma_f32_16x16x32_bf16 v[184:187], v[144:147], v[76:79], v[184:187]
    ds_read_b64_tr_b16 v[164:165], v205 offset:20544
    ds_read_b64_tr_b16 v[166:167], v205 offset:21824
    v_mfma_f32_16x16x32_bf16 v[188:191], v[148:151], v[76:79], v[188:191]
    ds_read_b64_tr_b16 v[168:169], v205 offset:20576
    ds_read_b64_tr_b16 v[170:171], v205 offset:21856
    v_mfma_f32_16x16x32_bf16 v[192:195], v[152:155], v[76:79], v[192:195]
    ds_read_b64_tr_b16 v[172:173], v205 offset:20608
    ds_read_b64_tr_b16 v[174:175], v205 offset:21888
    ds_read_b32 v208, v209
    s_waitcnt lgkmcnt(7)
    v_mfma_f32_16x16x32_bf16 v[176:179], v[156:159], v[80:83], v[176:179]
    ds_read_b64_tr_b16 v[136:137], v205 offset:25600
    ds_read_b64_tr_b16 v[138:139], v205 offset:26880
    v_mfma_f32_16x16x32_bf16 v[180:183], v[160:163], v[80:83], v[180:183]
    ds_read_b64_tr_b16 v[140:141], v205 offset:25632
    ds_read_b64_tr_b16 v[142:143], v205 offset:26912
    s_waitcnt lgkmcnt(5)
    v_mfma_f32_16x16x32_bf16 v[184:187], v[164:167], v[80:83], v[184:187]
    ds_read_b64_tr_b16 v[144:145], v205 offset:25664
    ds_read_b64_tr_b16 v[146:147], v205 offset:26944
    v_mfma_f32_16x16x32_bf16 v[188:191], v[168:171], v[80:83], v[188:191]
    ds_read_b64_tr_b16 v[148:149], v205 offset:25696
    ds_read_b64_tr_b16 v[150:151], v205 offset:26976
    s_waitcnt lgkmcnt(8)
    v_cmp_gt_u32 vcc, 18, v208
    v_mfma_f32_16x16x32_bf16 v[192:195], v[172:175], v[80:83], v[192:195]
    ds_read_b64_tr_b16 v[152:153], v205 offset:25728
    ds_read_b64_tr_b16 v[154:155], v205 offset:27008
    s_cbranch_vccnz L_qw_31
L_qwr_32:
    ds_read_b32 v208, v209
    s_waitcnt lgkmcnt(7)
    v_mfma_f32_16x16x32_bf16 v[176:179], v[136:139], v[84:87], v[176:179]
    ds_read_b64_tr_b16 v[156:157], v205 offset:30720
    ds_read_b64_tr_b16 v[158:159], v205 offset:32000
    v_mfma_f32_16x16x32_bf16 v[180:183], v[140:143], v[84:87], v[180:183]
    ds_read_b64_tr_b16 v[160:161], v205 offset:30752
    ds_read_b64_tr_b16 v[162:163], v205 offset:32032
    s_waitcnt lgkmcnt(5)
    v_mfma_f32_16x16x32_bf16 v[184:187], v[144:147], v[84:87], v[184:187]
    ds_read_b64_tr_b16 v[164:165], v205 offset:30784
    ds_read_b64_tr_b16 v[166:167], v205 offset:32064
    v_mfma_f32_16x16x32_bf16 v[188:191], v[148:151], v[84:87], v[188:191]
    ds_read_b64_tr_b16 v[168:169], v205 offset:30816
    ds_read_b64_tr_b16 v[170:171], v205 offset:32096
    s_waitcnt lgkmcnt(8)
    v_cmp_gt_u32 vcc, 19, v208
    v_mfma_f32_16x16x32_bf16 v[192:195], v[152:155], v[84:87], v[192:195]
    ds_read_b64_tr_b16 v[172:173], v205 offset:30848
    ds_read_b64_tr_b16 v[174:175], v205 offset:32128
    s_cbranch_vccnz L_qw_33
L_qwr_34:
    ds_read_b32 v208, v209
    s_waitcnt lgkmcnt(7)
    v_mfma_f32_16x16x32_bf16 v[176:179], v[156:159], v[88:91], v[176:179]
    ds_read_b64_tr_b16 v[136:137], v205 offset:35840
    ds_read_b64_tr_b16 v[138:139], v205 offset:37120
    v_mfma_f32_16x16x32_bf16 v[180:183], v[160:163], v[88:91], v[180:183]
    ds_read_b64_tr_b16 v[140:141], v205 offset:35872
    ds_read_b64_tr_b16 v[142:143], v205 offset:37152
    s_waitcnt lgkmcnt(5)
    v_mfma_f32_16x16x32_bf16 v[184:187], v[164:167], v[88:91], v[184:187]
    ds_read_b64_tr_b16 v[144:145], v205 offset:35904
    ds_read_b64_tr_b16 v[146:147], v205 offset:37184
    v_mfma_f32_16x16x32_bf16 v[188:191], v[168:171], v[88:91], v[188:191]
    ds_read_b64_tr_b16 v[148:149], v205 offset:35936
    ds_read_b64_tr_b16 v[150:151], v205 offset:37216
    s_waitcnt lgkmcnt(8)
    v_cmp_gt_u32 vcc, 20, v208
    v_mfma_f32_16x16x32_bf16 v[192:195], v[172:175], v[88:91], v[192:195]
    ds_read_b64_tr_b16 v[152:153], v205 offset:35968
    ds_read_b64_tr_b16 v[154:155], v205 offset:37248
    s_cbranch_vccnz L_qw_35
L_qwr_36:
    ds_read_b32 v123, v128
    s_waitcnt lgkmcnt(7)
    v_mfma_f32_16x16x32_bf16 v[176:179], v[136:139], v[92:95], v[176:179]
    ds_read_b64_tr_b16 v[156:157], v205 offset:40960
    ds_read_b64_tr_b16 v[158:159], v205 offset:42240
    v_mfma_f32_16x16x32_bf16 v[180:183], v[140:143], v[92:95], v[180:183]
    ds_read_b64_tr_b16 v[160:161], v205 offset:40992
    ds_read_b64_tr_b16 v[162:163], v205 offset:42272
    s_waitcnt lgkmcnt(5)
    v_mfma_f32_16x16x32_bf16 v[184:187], v[144:147], v[92:95], v[184:187]
    ds_read_b64_tr_b16 v[164:165], v205 offset:41024
    ds_read_b64_tr_b16 v[166:167], v205 offset:42304
    v_mfma_f32_16x16x32_bf16 v[188:191], v[148:151], v[92:95], v[188:191]
    ds_read_b64_tr_b16 v[168:169], v205 offset:41056
    ds_read_b64_tr_b16 v[170:171], v205 offset:42336
    v_mfma_f32_16x16x32_bf16 v[192:195], v[152:155], v[92:95], v[192:195]
    ds_read_b64_tr_b16 v[172:173], v205 offset:41088
    ds_read_b64_tr_b16 v[174:175], v205 offset:42368
    s_waitcnt lgkmcnt(6)
    v_mfma_f32_16x16x32_bf16 v[176:179], v[156:159], v[96:99], v[176:179]
    v_mfma_f32_16x16x32_bf16 v[180:183], v[160:163], v[96:99], v[180:183]
    s_waitcnt lgkmcnt(0)
    v_mfma_f32_16x16x32_bf16 v[184:187], v[164:167], v[96:99], v[184:187]
    v_mfma_f32_16x16x32_bf16 v[188:191], v[168:171], v[96:99], v[188:191]
    v_cmp_gt_u32 vcc, 4, v123
    v_mfma_f32_16x16x32_bf16 v[192:195], v[172:175], v[96:99], v[192:195]
    s_branch L_qgd
L_qg1:
    s_cmp_lg_u32 s69, 3
    s_cbranch_scc1 L_zi_37
    v_mov_b32 v213, 0
    buffer_load_dword v214, v213, s[56:59], 0 offen sc1
L_zi_37:
    ds_read_b64_tr_b16 v[136:137], v206 offset:0
    ds_read_b64_tr_b16 v[138:139], v206 offset:1280
    ds_read_b64_tr_b16 v[140:141], v206 offset:32
    ds_read_b64_tr_b16 v[142:143], v206 offset:1312
    ds_read_b64_tr_b16 v[144:145], v206 offset:64
    ds_read_b64_tr_b16 v[146:147], v206 offset:1344
    ds_read_b64_tr_b16 v[148:149], v206 offset:96
    ds_read_b64_tr_b16 v[150:151], v206 offset:1376
    ds_read_b64_tr_b16 v[152:153], v206 offset:128
    ds_read_b64_tr_b16 v[154:155], v206 offset:1408
    ds_read_b32 v208, v209
    s_waitcnt lgkmcnt(7)
    v_mfma_f32_16x16x32_bf16 v[176:179], v[136:139], v[40:43], 0
    ds_read_b64_tr_b16 v[156:157], v206 offset:5120
    ds_read_b64_tr_b16 v[158:159], v206 offset:6400
    v_mfma_f32_16x16x32_bf16 v[180:183], v[140:143], v[40:43], 0
    ds_read_b64_tr_b16 v[160:161], v206 offset:5152
    ds_read_b64_tr_b16 v[162:163], v206 offset:6432
    s_waitcnt lgkmcnt(5)
    v_mfma_f32_16x16x32_bf16 v[184:187], v[144:147], v[40:43], 0
    ds_read_b64_tr_b16 v[164:165], v206 offset:5184
    ds_read_b64_tr_b16 v[166:167], v206 offset:6464
    v_mfma_f32_16x16x32_bf16 v[188:191], v[148:151], v[40:43], 0
    ds_read_b64_tr_b16 v[168:169], v206 offset:5216
    ds_read_b64_tr_b16 v[170:171], v206 offset:6496
    s_waitcnt lgkmcnt(8)
    v_cmp_gt_u32 vcc, 3, v208
    v_mfma_f32_16x16x32_bf16 v[192:195], v[152:155], v[40:43], 0
    ds_read_b64_tr_b16 v[172:173], v206 offset:5248
    ds_read_b64_tr_b16 v[174:175], v206 offset:6528
    s_cbranch_vccnz L_qw_38
L_qwr_39:
    ds_read_b32 v208, v209
    s_waitcnt lgkmcnt(7)
    v_mfma_f32_16x16x32_bf16 v[176:179], v[156:159], v[44:47], v[176:179]
    ds_read_b64_tr_b16 v[136:137], v206 offset:10240
    ds_read_b64_tr_b16 v[138:139], v206 offset:11520
    v_mfma_f32_16x16x32_bf16 v[180:183], v[160:163], v[44:47], v[180:183]
    ds_read_b64_tr_b16 v[140:141], v206 offset:10272
    ds_read_b64_tr_b16 v[142:143], v206 offset:11552
    s_waitcnt lgkmcnt(5)
    v_mfma_f32_16x16x32_bf16 v[184:187], v[164:167], v[44:47], v[184:187]
    ds_read_b64_tr_b16 v[144:145], v206 offset:10304
    ds_read_b64_tr_b16 v[146:147], v206 offset:11584
    v_mfma_f32_16x16x32_bf16 v[188:191], v[168:171], v[44:47], v[188:191]
    ds_read_b64_tr_b16 v[148:149], v206 offset:10336
    ds_read_b64_tr_b16 v[150:151], v206 offset:11616
    s_waitcnt lgkmcnt(8)
    v_cmp_gt_u32 vcc, 4, v208
    v_mfma_f32_16x16x32_bf16 v[192:195], v[172:175], v[44:47], v[192:195]
    ds_read_b64_tr_b16 v[152:153], v206 offset:10368
    ds_read_b64_tr_b16 v[154:155], v206 offset:11648
    s_cbranch_vccnz L_qw_40
L_qwr_41:
    ds_read_b32 v208, v209
    s_waitcnt lgkmcnt(7)
    v_mfma_f32_16x16x32_bf16 v[176:179], v[136:139], v[48:51], v[176:179]
    ds_read_b64_tr_b16 v[156:157], v206 offset:15360
    ds_read_b64_tr_b16 v[158:159], v206 offset:16640
    v_mfma_f32_16x16x32_bf16 v[180:183], v[140:143], v[48:51], v[180:183]
    ds_read_b64_tr_b16 v[160:161], v206 offset:15392
    ds_read_b64_tr_b16 v[162:163], v206 offset:16672
    s_waitcnt lgkmcnt(5)
    v_mfma_f32_16x16x32_bf16 v[184:187], v[144:147], v[48:51], v[184:187]
    ds_read_b64_tr_b16 v[164:165], v206 offset:15424
    ds_read_b64_tr_b16 v[166:167], v206 offset:16704
    v_mfma_f32_16x16x32_bf16 v[188:191], v[148:151], v[48:51], v[188:191]
    ds_read_b64_tr_b16 v[168:169], v206 offset:15456
    ds_read_b64_tr_b16 v[170:171], v206 offset:16736
    s_waitcnt lgkmcnt(8)
    v_cmp_gt_u32 vcc, 5, v208
    v_mfma_f32_16x16x32_bf16 v[192:195], v[152:155], v[48:51], v[192:195]
    ds_read_b64_tr_b16 v[172:173], v206 offset:15488
    ds_read_b64_tr_b16 v[174:175], v206 offset:16768
    s_cbranch_vccnz L_qw_42
L_qwr_43:
    ds_read_b32 v208, v209
    s_waitcnt lgkmcnt(7)
    v_mfma_f32_16x16x32_bf16 v[176:179], v[156:159], v[52:55], v[176:179]
    ds_read_b64_tr_b16 v[136:137], v206 offset:46144
    ds_read_b64_tr_b16 v[138:139], v206 offset:47424
    v_mfma_f32_16x16x32_bf16 v[180:183], v[160:163], v[52:55], v[180:183]
    ds_read_b64_tr_b16 v[140:141], v206 offset:46176
    ds_read_b64_tr_b16 v[142:143], v206 offset:47456
    s_waitcnt lgkmcnt(5)
    v_mfma_f32_16x16x32_bf16 v[184:187], v[164:167], v[52:55], v[184:187]
    ds_read_b64_tr_b16 v[144:145], v206 offset:46208
    ds_read_b64_tr_b16 v[146:147], v206 offset:47488
    v_mfma_f32_16x16x32_bf16 v[188:191], v[168:171], v[52:55], v[188:191]
    ds_read_b64_tr_b16 v[148:149], v206 offset:46240
    ds_read_b64_tr_b16 v[150:151], v206 offset:47520
    s_waitcnt lgkmcnt(8)
    v_cmp_gt_u32 vcc, 6, v208
    v_mfma_f32_16x16x32_bf16 v[192:195], v[172:175], v[52:55], v[192:195]
    ds_read_b64_tr_b16 v[152:153], v206 offset:46272
    ds_read_b64_tr_b16 v[154:155], v206 offset:47552
    s_cmp_lg_u32 s69, 3
    s_cbranch_scc1 L_ze_44
    s_waitcnt vmcnt(0)
    v_readfirstlane_b32 s74, v214
    s_nop 0
    s_cmp_ge_u32 s74, 64
    s_cselect_b32 s74, 1, 0
    v_mov_b32 v214, s74
    v_mov_b32 v213, 163672
    s_mov_b64 exec, 1
    ds_write_b32 v213, v214
    s_mov_b64 exec, -1
L_ze_44:
    s_cbranch_vccnz L_qw_45
L_qwr_46:
    ds_read_b32 v208, v209
    s_waitcnt lgkmcnt(7)
    v_mfma_f32_16x16x32_bf16 v[176:179], v[136:139], v[56:59], v[176:179]
    ds_read_b64_tr_b16 v[156:157], v206 offset:51264
    ds_read_b64_tr_b16 v[158:159], v206 offset:52544
    v_mfma_f32_16x16x32_bf16 v[180:183], v[140:143], v[56:59], v[180:183]
    ds_read_b64_tr_b16 v[160:161], v206 offset:51296
    ds_read_b64_tr_b16 v[162:163], v206 offset:52576
    s_waitcnt lgkmcnt(5)
    v_mfma_f32_16x16x32_bf16 v[184:187], v[144:147], v[56:59], v[184:187]
    ds_read_b64_tr_b16 v[164:165], v206 offset:51328
    ds_read_b64_tr_b16 v[166:167], v206 offset:52608
    v_mfma_f32_16x16x32_bf16 v[188:191], v[148:151], v[56:59], v[188:191]
    ds_read_b64_tr_b16 v[168:169], v206 offset:51360
    ds_read_b64_tr_b16 v[170:171], v206 offset:52640
    s_waitcnt lgkmcnt(8)
    v_cmp_gt_u32 vcc, 8, v208
    v_mfma_f32_16x16x32_bf16 v[192:195], v[152:155], v[56:59], v[192:195]
    ds_read_b64_tr_b16 v[172:173], v206 offset:51392
    ds_read_b64_tr_b16 v[174:175], v206 offset:52672
    s_cbranch_vccnz L_qw_47
L_qwr_48:
    s_waitcnt lgkmcnt(6)
    v_mfma_f32_16x16x32_bf16 v[176:179], v[156:159], v[60:63], v[176:179]
    ds_read_b64_tr_b16 v[136:137], v206 offset:20480
    ds_read_b64_tr_b16 v[138:139], v206 offset:21760
    v_mfma_f32_16x16x32_bf16 v[180:183], v[160:163], v[60:63], v[180:183]
    ds_read_b64_tr_b16 v[140:141], v206 offset:20512
    ds_read_b64_tr_b16 v[142:143], v206 offset:21792
    s_waitcnt lgkmcnt(4)
    v_mfma_f32_16x16x32_bf16 v[184:187], v[164:167], v[60:63], v[184:187]
    ds_read_b64_tr_b16 v[144:145], v206 offset:20544
    ds_read_b64_tr_b16 v[146:147], v206 offset:21824
    v_mfma_f32_16x16x32_bf16 v[188:191], v[168:171], v[60:63], v[188:191]
    ds_read_b64_tr_b16 v[148:149], v206 offset:20576
    ds_read_b64_tr_b16 v[150:151], v206 offset:21856
    v_mfma_f32_16x16x32_bf16 v[192:195], v[172:175], v[60:63], v[192:195]
    ds_read_b64_tr_b16 v[152:153], v206 offset:20608
    ds_read_b64_tr_b16 v[154:155], v206 offset:21888
    ds_read_b32 v208, v209
    s_waitcnt lgkmcnt(7)
    v_mfma_f32_16x16x32_bf16 v[176:179], v[136:139], v[64:67], v[176:179]
    ds_read_b64_tr_b16 v[156:157], v206 offset:25600
    ds_read_b64_tr_b16 v[158:159], v206 offset:26880
    v_mfma_f32_16x16x32_bf16 v[180:183], v[140:143], v[64:67], v[180:183]
    ds_read_b64_tr_b16 v[160:161], v206 offset:25632
    ds_read_b64_tr_b16 v[162:163], v206 offset:26912
    s_waitcnt lgkmcnt(5)
    v_mfma_f32_16x16x32_bf16 v[184:187], v[144:147], v[64:67], v[184:187]
    ds_read_b64_tr_b16 v[164:165], v206 offset:25664
    ds_read_b64_tr_b16 v[166:167], v206 offset:26944
    v_mfma_f32_16x16x32_bf16 v[188:191], v[148:151], v[64:67], v[188:191]
    ds_read_b64_tr_b16 v[168:169], v206 offset:25696
    ds_read_b64_tr_b16 v[170:171], v206 offset:26976
    s_waitcnt lgkmcnt(8)
    v_cmp_gt_u32 vcc, 10, v208
    v_mfma_f32_16x16x32_bf16 v[192:195], v[152:155], v[64:67], v[192:195]
    ds_read_b64_tr_b16 v[172:173], v206 offset:25728
    ds_read_b64_tr_b16 v[174:175], v206 offset:27008
    s_cbranch_vccnz L_qw_49
L_qwr_50:
    s_waitcnt lgkmcnt(6)
    v_mfma_f32_16x16x32_bf16 v[176:179], v[156:159], v[68:71], v[176:179]
    ds_read_b64_tr_b16 v[136:137], v206 offset:30720
    ds_read_b64_tr_b16 v[138:139], v206 offset:32000
    v_mfma_f32_16x16x32_bf16 v[180:183], v[160:163], v[68:71], v[180:183]
    ds_read_b64_tr_b16 v[140:141], v206 offset:30752
    ds_read_b64_tr_b16 v[142:143], v206 offset:32032
    s_waitcnt lgkmcnt(4)
    v_mfma_f32_16x16x32_bf16 v[184:187], v[164:167], v[68:71], v[184:187]
    ds_read_b64_tr_b16 v[144:145], v206 offset:30784
    ds_read_b64_tr_b16 v[146:147], v206 offset:32064
    v_mfma_f32_16x16x32_bf16 v[188:191], v[168:171], v[68:71], v[188:191]
    ds_read_b64_tr_b16 v[148:149], v206 offset:30816
    ds_read_b64_tr_b16 v[150:151], v206 offset:32096
    v_mfma_f32_16x16x32_bf16 v[192:195], v[172:175], v[68:71], v[192:195]
    ds_read_b64_tr_b16 v[152:153], v206 offset:30848
    ds_read_b64_tr_b16 v[154:155], v206 offset:32128
    ds_read_b32 v208, v209
    s_cmp_eq_u32 s69, 3
    s_cbranch_scc1 L_sd_51
    s_waitcnt vmcnt(0)
    v_mov_b32 v213, 163676
    v_mov_b32 v214, 1
    s_mov_b64 exec, 1
    ds_add_u32 v213, v214
    s_mov_b64 exec, -1
L_sd_51:
    s_waitcnt lgkmcnt(7)
    v_mfma_f32_16x16x32_bf16 v[176:179], v[136:139], v[72:75], v[176:179]
    ds_read_b64_tr_b16 v[156:157], v206 offset:35840
    ds_read_b64_tr_b16 v[158:159], v206 offset:37120
    v_mfma_f32_16x16x32_bf16 v[180:183], v[140:143], v[72:75], v[180:183]
    ds_read_b64_tr_b16 v[160:161], v206 offset:35872
    ds_read_b64_tr_b16 v[162:163], v206 offset:37152
    s_waitcnt lgkmcnt(5)
    v_mfma_f32_16x16x32_bf16 v[184:187], v[144:147], v[72:75], v[184:187]
    ds_read_b64_tr_b16 v[164:165], v206 offset:35904
    ds_read_b64_tr_b16 v[166:167], v206 offset:37184
    v_mfma_f32_16x16x32_bf16 v[188:191], v[148:151], v[72:75], v[188:191]
    ds_read_b64_tr_b16 v[168:169], v206 offset:35936
    ds_read_b64_tr_b16 v[170:171], v206 offset:37216
    s_waitcnt lgkmcnt(8)
    v_cmp_gt_u32 vcc, 11, v208
    v_mfma_f32_16x16x32_bf16 v[192:195], v[152:155], v[72:75], v[192:195]
    ds_read_b64_tr_b16 v[172:173], v206 offset:35968
    ds_read_b64_tr_b16 v[174:175], v206 offset:37248
    s_cbranch_vccnz L_qw_52
L_qwr_53:
    ds_read_b32 v208, v209
    s_waitcnt lgkmcnt(7)
    v_mfma_f32_16x16x32_bf16 v[176:179], v[156:159], v[76:79], v[176:179]
    ds_read_b64_tr_b16 v[136:137], v206 offset:40960
    ds_read_b64_tr_b16 v[138:139], v206 offset:42240
    v_mfma_f32_16x16x32_bf16 v[180:183], v[160:163], v[76:79], v[180:183]
    ds_read_b64_tr_b16 v[140:141], v206 offset:40992
    ds_read_b64_tr_b16 v[142:143], v206 offset:42272
    s_waitcnt lgkmcnt(5)
    v_mfma_f32_16x16x32_bf16 v[184:187], v[164:167], v[76:79], v[184:187]
    ds_read_b64_tr_b16 v[144:145], v206 offset:41024
    ds_read_b64_tr_b16 v[146:147], v206 offset:42304
    v_mfma_f32_16x16x32_bf16 v[188:191], v[168:171], v[76:79], v[188:191]
    ds_read_b64_tr_b16 v[148:149], v206 offset:41056
    ds_read_b64_tr_b16 v[150:151], v206 offset:42336
    s_waitcnt lgkmcnt(8)
    v_cmp_gt_u32 vcc, 13, v208
    v_mfma_f32_16x16x32_bf16 v[192:195], v[172:175], v[76:79], v[192:195]
    ds_read_b64_tr_b16 v[152:153], v206 offset:41088
    ds_read_b64_tr_b16 v[154:155], v206 offset:42368
    s_cbranch_vccnz L_qw_54
L_qwr_55:
    s_waitcnt lgkmcnt(6)
    v_mfma_f32_16x16x32_bf16 v[176:179], v[136:139], v[80:83], v[176:179]
    ds_read_b64_tr_b16 v[156:157], v205 offset:0
    ds_read_b64_tr_b16 v[158:159], v205 offset:1280
    v_mfma_f32_16x16x32_bf16 v[180:183], v[140:143], v[80:83], v[180:183]
    ds_read_b64_tr_b16 v[160:161], v205 offset:32
    ds_read_b64_tr_b16 v[162:163], v205 offset:1312
    s_waitcnt lgkmcnt(4)
    v_mfma_f32_16x16x32_bf16 v[184:187], v[144:147], v[80:83], v[184:187]
    ds_read_b64_tr_b16 v[164:165], v205 offset:64
    ds_read_b64_tr_b16 v[166:167], v205 offset:1344
    v_mfma_f32_16x16x32_bf16 v[188:191], v[148:151], v[80:83], v[188:191]
    ds_read_b64_tr_b16 v[168:169], v205 offset:96
    ds_read_b64_tr_b16 v[170:171], v205 offset:1376
    v_mfma_f32_16x16x32_bf16 v[192:195], v[152:155], v[80:83], v[192:195]
    ds_read_b64_tr_b16 v[172:173], v205 offset:128
    ds_read_b64_tr_b16 v[174:175], v205 offset:1408
    ds_read_b32 v208, v209
    v_mov_b32 v12, 163668
    v_mov_b32 v13, 1
    s_mov_b64 exec, 1
    ds_add_u32 v12, v13
    s_mov_b64 exec, -1
    s_waitcnt lgkmcnt(8)
    v_mfma_f32_16x16x32_bf16 v[176:179], v[156:159], v[84:87], v[176:179]
    ds_read_b64_tr_b16 v[136:137], v205 offset:5120
    ds_read_b64_tr_b16 v[138:139], v205 offset:6400
    v_mfma_f32_16x16x32_bf16 v[180:183], v[160:163], v[84:87], v[180:183]
    ds_read_b64_tr_b16 v[140:141], v205 offset:5152
    ds_read_b64_tr_b16 v[142:143], v205 offset:6432
    s_waitcnt lgkmcnt(6)
    v_mfma_f32_16x16x32_bf16 v[184:187], v[164:167], v[84:87], v[184:187]
    ds_read_b64_tr_b16 v[144:145], v205 offset:5184
    ds_read_b64_tr_b16 v[146:147], v205 offset:6464
    v_mfma_f32_16x16x32_bf16 v[188:191], v[168:171], v[84:87], v[188:191]
    ds_read_b64_tr_b16 v[148:149], v205 offset:5216
    ds_read_b64_tr_b16 v[150:151], v205 offset:6496
    s_waitcnt lgkmcnt(9)
    v_cmp_gt_u32 vcc, 15, v208
    v_mfma_f32_16x16x32_bf16 v[192:195], v[172:175], v[84:87], v[192:195]
    ds_read_b64_tr_b16 v[152:153], v205 offset:5248
    ds_read_b64_tr_b16 v[154:155], v205 offset:6528
    s_cbranch_vccnz L_qw_56
L_qwr_57:
    s_waitcnt lgkmcnt(6)
    v_mfma_f32_16x16x32_bf16 v[176:179], v[136:139], v[88:91], v[176:179]
    ds_read_b64_tr_b16 v[156:157], v205 offset:10240
    ds_read_b64_tr_b16 v[158:159], v205 offset:11520
    v_mfma_f32_16x16x32_bf16 v[180:183], v[140:143], v[88:91], v[180:183]
    ds_read_b64_tr_b16 v[160:161], v205 offset:10272
    ds_read_b64_tr_b16 v[162:163], v205 offset:11552
    s_waitcnt lgkmcnt(4)
    v_mfma_f32_16x16x32_bf16 v[184:187], v[144:147], v[88:91], v[184:187]
    ds_read_b64_tr_b16 v[164:165], v205 offset:10304
    ds_read_b64_tr_b16 v[166:167], v205 offset:11584
    v_mfma_f32_16x16x32_bf16 v[188:191], v[148:151], v[88:91], v[188:191]
    ds_read_b64_tr_b16 v[168:169], v205 offset:10336
    ds_read_b64_tr_b16 v[170:171], v205 offset:11616
    v_mfma_f32_16x16x32_bf16 v[192:195], v[152:155], v[88:91], v[192:195]
    ds_read_b64_tr_b16 v[172:173], v205 offset:10368
    ds_read_b64_tr_b16 v[174:175], v205 offset:11648
    ds_read_b32 v208, v209
    s_waitcnt lgkmcnt(7)
    v_mfma_f32_16x16x32_bf16 v[176:179], v[156:159], v[92:95], v[176:179]
    ds_read_b64_tr_b16 v[136:137], v205 offset:15360
    ds_read_b64_tr_b16 v[138:139], v205 offset:16640
    v_mfma_f32_16x16x32_bf16 v[180:183], v[160:163], v[92:95], v[180:183]
    ds_read_b64_tr_b16 v[140:141], v205 offset:15392
    ds_read_b64_tr_b16 v[142:143], v205 offset:16672
    s_waitcnt lgkmcnt(5)
    v_mfma_f32_16x16x32_bf16 v[184:187], v[164:167], v[92:95], v[184:187]
    ds_read_b64_tr_b16 v[144:145], v205 offset:15424
    ds_read_b64_tr_b16 v[146:147], v205 offset:16704
    v_mfma_f32_16x16x32_bf16 v[188:191], v[168:171], v[92:95], v[188:191]
    ds_read_b64_tr_b16 v[148:149], v205 offset:15456
    ds_read_b64_tr_b16 v[150:151], v205 offset:16736
    s_waitcnt lgkmcnt(8)
    v_cmp_gt_u32 vcc, 17, v208
    v_mfma_f32_16x16x32_bf16 v[192:195], v[172:175], v[92:95], v[192:195]
    ds_read_b64_tr_b16 v[152:153], v205 offset:15488
    ds_read_b64_tr_b16 v[154:155], v205 offset:16768
    s_cbranch_vccnz L_qw_58
L_qwr_59:
    s_waitcnt lgkmcnt(6)
    v_mfma_f32_16x16x32_bf16 v[176:179], v[136:139], v[96:99], v[176:179]
    ds_read_b64_tr_b16 v[156:157], v205 offset:20480
    ds_read_b64_tr_b16 v[158:159], v205 offset:21760
    v_mfma_f32_16x16x32_bf16 v[180:183], v[140:143], v[96:99], v[180:183]
    ds_read_b64_tr_b16 v[160:161], v205 offset:20512
    ds_read_b64_tr_b16 v[162:163], v205 offset:21792
    s_waitcnt lgkmcnt(4)
    v_mfma_f32_16x16x32_bf16 v[184:187], v[144:147], v[96:99], v[184:187]
    ds_read_b64_tr_b16 v[164:165], v205 offset:20544
    ds_read_b64_tr_b16 v[166:167], v205 offset:21824
    v_mfma_f32_16x16x32_bf16 v[188:191], v[148:151], v[96:99], v[188:191]
    ds_read_b64_tr_b16 v[168:169], v205 offset:20576
    ds_read_b64_tr_b16 v[170:171], v205 offset:21856
    v_mfma_f32_16x16x32_bf16 v[192:195], v[152:155], v[96:99], v[192:195]
    ds_read_b64_tr_b16 v[172:173], v205 offset:20608
    ds_read_b64_tr_b16 v[174:175], v205 offset:21888
    ds_read_b32 v208, v209
    s_waitcnt lgkmcnt(7)
    v_mfma_f32_16x16x32_bf16 v[176:179], v[156:159], v[20:23], v[176:179]
    ds_read_b64_tr_b16 v[136:137], v205 offset:25600
    ds_read_b64_tr_b16 v[138:139], v205 offset:26880
    v_mfma_f32_16x16x32_bf16 v[180:183], v[160:163], v[20:23], v[180:183]
    ds_read_b64_tr_b16 v[140:141], v205 offset:25632
    ds_read_b64_tr_b16 v[142:143], v205 offset:26912
    s_waitcnt lgkmcnt(5)
    v_mfma_f32_16x16x32_bf16 v[184:187], v[164:167], v[20:23], v[184:187]
    ds_read_b64_tr_b16 v[144:145], v205 offset:25664
    ds_read_b64_tr_b16 v[146:147], v205 offset:26944
    v_mfma_f32_16x16x32_bf16 v[188:191], v[168:171], v[20:23], v[188:191]
    ds_read_b64_tr_b16 v[148:149], v205 offset:25696
    ds_read_b64_tr_b16 v[150:151], v205 offset:26976
    s_waitcnt lgkmcnt(8)
    v_cmp_gt_u32 vcc, 18, v208
    v_mfma_f32_16x16x32_bf16 v[192:195], v[172:175], v[20:23], v[192:195]
    ds_read_b64_tr_b16 v[152:153], v205 offset:25728
    ds_read_b64_tr_b16 v[154:155], v205 offset:27008
    s_cbranch_vccnz L_qw_60
L_qwr_61:
    ds_read_b32 v208, v209
    s_waitcnt lgkmcnt(7)
    v_mfma_f32_16x16x32_bf16 v[176:179], v[136:139], v[24:27], v[176:179]
    ds_read_b64_tr_b16 v[156:157], v205 offset:30720
    ds_read_b64_tr_b16 v[158:159], v205 offset:32000
    v_mfma_f32_16x16x32_bf16 v[180:183], v[140:143], v[24:27], v[180:183]
    ds_read_b64_tr_b16 v[160:161], v205 offset:30752
    ds_read_b64_tr_b16 v[162:163], v205 offset:32032
    s_waitcnt lgkmcnt(5)
    v_mfma_f32_16x16x32_bf16 v[184:187], v[144:147], v[24:27], v[184:187]
    ds_read_b64_tr_b16 v[164:165], v205 offset:30784
    ds_read_b64_tr_b16 v[166:167], v205 offset:32064
    v_mfma_f32_16x16x32_bf16 v[188:191], v[148:151], v[24:27], v[188:191]
    ds_read_b64_tr_b16 v[168:169], v205 offset:30816
    ds_read_b64_tr_b16 v[170:171], v205 offset:32096
    s_waitcnt lgkmcnt(8)
    v_cmp_gt_u32 vcc, 19, v208
    v_mfma_f32_16x16x32_bf16 v[192:195], v[152:155], v[24:27], v[192:195]
    ds_read_b64_tr_b16 v[172:173], v205 offset:30848
    ds_read_b64_tr_b16 v[174:175], v205 offset:32128
    s_cbranch_vccnz L_qw_62
L_qwr_63:
    ds_read_b32 v208, v209
    s_waitcnt lgkmcnt(7)
    v_mfma_f32_16x16x32_bf16 v[176:179], v[156:159], v[28:31], v[176:179]
    ds_read_b64_tr_b16 v[136:137], v205 offset:35840
    ds_read_b64_tr_b16 v[138:139], v205 offset:37120
    v_mfma_f32_16x16x32_bf16 v[180:183], v[160:163], v[28:31], v[180:183]
    ds_read_b64_tr_b16 v[140:141], v205 offset:35872
    ds_read_b64_tr_b16 v[142:143], v205 offset:37152
    s_waitcnt lgkmcnt(5)
    v_mfma_f32_16x16x32_bf16 v[184:187], v[164:167], v[28:31], v[184:187]
    ds_read_b64_tr_b16 v[144:145], v205 offset:35904
    ds_read_b64_tr_b16 v[146:147], v205 offset:37184
    v_mfma_f32_16x16x32_bf16 v[188:191], v[168:171], v[28:31], v[188:191]
    ds_read_b64_tr_b16 v[148:149], v205 offset:35936
    ds_read_b64_tr_b16 v[150:151], v205 offset:37216
    s_waitcnt lgkmcnt(8)
    v_cmp_gt_u32 vcc, 20, v208
    v_mfma_f32_16x16x32_bf16 v[192:195], v[172:175], v[28:31], v[192:195]
    ds_read_b64_tr_b16 v[152:153], v205 offset:35968
    ds_read_b64_tr_b16 v[154:155], v205 offset:37248
    s_cbranch_vccnz L_qw_64
L_qwr_65:
    ds_read_b32 v123, v128
    s_waitcnt lgkmcnt(7)
    v_mfma_f32_16x16x32_bf16 v[176:179], v[136:139], v[32:35], v[176:179]
    ds_read_b64_tr_b16 v[156:157], v205 offset:40960
    ds_read_b64_tr_b16 v[158:159], v205 offset:42240
    v_mfma_f32_16x16x32_bf16 v[180:183], v[140:143], v[32:35], v[180:183]
    ds_read_b64_tr_b16 v[160:161], v205 offset:40992
    ds_read_b64_tr_b16 v[162:163], v205 offset:42272
    s_waitcnt lgkmcnt(5)
    v_mfma_f32_16x16x32_bf16 v[184:187], v[144:147], v[32:35], v[184:187]
    ds_read_b64_tr_b16 v[164:165], v205 offset:41024
    ds_read_b64_tr_b16 v[166:167], v205 offset:42304
    v_mfma_f32_16x16x32_bf16 v[188:191], v[148:151], v[32:35], v[188:191]
    ds_read_b64_tr_b16 v[168:169], v205 offset:41056
    ds_read_b64_tr_b16 v[170:171], v205 offset:42336
    v_mfma_f32_16x16x32_bf16 v[192:195], v[152:155], v[32:35], v[192:195]
    ds_read_b64_tr_b16 v[172:173], v205 offset:41088
    ds_read_b64_tr_b16 v[174:175], v205 offset:42368
    s_waitcnt lgkmcnt(6)
    v_mfma_f32_16x16x32_bf16 v[176:179], v[156:159], v[36:39], v[176:179]
    v_mfma_f32_16x16x32_bf16 v[180:183], v[160:163], v[36:39], v[180:183]
    s_waitcnt lgkmcnt(0)
    v_mfma_f32_16x16x32_bf16 v[184:187], v[164:167], v[36:39], v[184:187]
    v_mfma_f32_16x16x32_bf16 v[188:191], v[168:171], v[36:39], v[188:191]
    v_cmp_gt_u32 vcc, 4, v123
    v_mfma_f32_16x16x32_bf16 v[192:195], v[172:175], v[36:39], v[192:195]
    s_branch L_qgd
L_qg2:
    s_cmp_lg_u32 s69, 3
    s_cbranch_scc1 L_zi_66
    v_mov_b32 v213, 0
    buffer_load_dword v214, v213, s[56:59], 0 offen sc1
L_zi_66:
    ds_read_b64_tr_b16 v[136:137], v206 offset:0
    ds_read_b64_tr_b16 v[138:139], v206 offset:1280
    ds_read_b64_tr_b16 v[140:141], v206 offset:32
    ds_read_b64_tr_b16 v[142:143], v206 offset:1312
    ds_read_b64_tr_b16 v[144:145], v206 offset:64
    ds_read_b64_tr_b16 v[146:147], v206 offset:1344
    ds_read_b64_tr_b16 v[148:149], v206 offset:96
    ds_read_b64_tr_b16 v[150:151], v206 offset:1376
    ds_read_b64_tr_b16 v[152:153], v206 offset:128
    ds_read_b64_tr_b16 v[154:155], v206 offset:1408
    ds_read_b32 v208, v209
    s_waitcnt lgkmcnt(7)
    v_mfma_f32_16x16x32_bf16 v[176:179], v[136:139], v[60:63], 0
    ds_read_b64_tr_b16 v[156:157], v206 offset:5120
    ds_read_b64_tr_b16 v[158:159], v206 offset:6400
    v_mfma_f32_16x16x32_bf16 v[180:183], v[140:143], v[60:63], 0
    ds_read_b64_tr_b16 v[160:161], v206 offset:5152
    ds_read_b64_tr_b16 v[162:163], v206 offset:6432
    s_waitcnt lgkmcnt(5)
    v_mfma_f32_16x16x32_bf16 v[184:187], v[144:147], v[60:63], 0
    ds_read_b64_tr_b16 v[164:165], v206 offset:5184
    ds_read_b64_tr_b16 v[166:167], v206 offset:6464
    v_mfma_f32_16x16x32_bf16 v[188:191], v[148:151], v[60:63], 0
    ds_read_b64_tr_b16 v[168:169], v206 offset:5216
    ds_read_b64_tr_b16 v[170:171], v206 offset:6496
    s_waitcnt lgkmcnt(8)
    v_cmp_gt_u32 vcc, 3, v208
    v_mfma_f32_16x16x32_bf16 v[192:195], v[152:155], v[60:63], 0
    ds_read_b64_tr_b16 v[172:173], v206 offset:5248
    ds_read_b64_tr_b16 v[174:175], v206 offset:6528
    s_cbranch_vccnz L_qw_67
L_qwr_68:
    ds_read_b32 v208, v209
    s_waitcnt lgkmcnt(7)
    v_mfma_f32_16x16x32_bf16 v[176:179], v[156:159], v[64:67], v[176:179]
    ds_read_b64_tr_b16 v[136:137], v206 offset:10240
    ds_read_b64_tr_b16 v[138:139], v206 offset:11520
    v_mfma_f32_16x16x32_bf16 v[180:183], v[160:163], v[64:67], v[180:183]
    ds_read_b64_tr_b16 v[140:141], v206 offset:10272
    ds_read_b64_tr_b16 v[142:143], v206 offset:11552
    s_waitcnt lgkmcnt(5)
    v_mfma_f32_16x16x32_bf16 v[184:187], v[164:167], v[64:67], v[184:187]
    ds_read_b64_tr_b16 v[144:145], v206 offset:10304
    ds_read_b64_tr_b16 v[146:147], v206 offset:11584
    v_mfma_f32_16x16x32_bf16 v[188:191], v[168:171], v[64:67], v[188:191]
    ds_read_b64_tr_b16 v[148:149], v206 offset:10336
    ds_read_b64_tr_b16 v[150:151], v206 offset:11616
    s_waitcnt lgkmcnt(8)
    v_cmp_gt_u32 vcc, 4, v208
    v_mfma_f32_16x16x32_bf16 v[192:195], v[172:175], v[64:67], v[192:195]
    ds_read_b64_tr_b16 v[152:153], v206 offset:10368
    ds_read_b64_tr_b16 v[154:155], v206 offset:11648
    s_cbranch_vccnz L_qw_69
L_qwr_70:
    ds_read_b32 v208, v209
    s_waitcnt lgkmcnt(7)
    v_mfma_f32_16x16x32_bf16 v[176:179], v[136:139], v[68:71], v[176:179]
    ds_read_b64_tr_b16 v[156:157], v206 offset:15360
    ds_read_b64_tr_b16 v[158:159], v206 offset:16640
    v_mfma_f32_16x16x32_bf16 v[180:183], v[140:143], v[68:71], v[180:183]
    ds_read_b64_tr_b16 v[160:161], v206 offset:15392
    ds_read_b64_tr_b16 v[162:163], v206 offset:16672
    s_waitcnt lgkmcnt(5)
    v_mfma_f32_16x16x32_bf16 v[184:187], v[144:147], v[68:71], v[184:187]
    ds_read_b64_tr_b16 v[164:165], v206 offset:15424
    ds_read_b64_tr_b16 v[166:167], v206 offset:16704
    v_mfma_f32_16x16x32_bf16 v[188:191], v[148:151], v[68:71], v[188:191]
    ds_read_b64_tr_b16 v[168:169], v206 offset:15456
    ds_read_b64_tr_b16 v[170:171], v206 offset:16736
    s_waitcnt lgkmcnt(8)
    v_cmp_gt_u32 vcc, 5, v208
    v_mfma_f32_16x16x32_bf16 v[192:195], v[152:155], v[68:71], v[192:195]
    ds_read_b64_tr_b16 v[172:173], v206 offset:15488
    ds_read_b64_tr_b16 v[174:175], v206 offset:16768
    s_cbranch_vccnz L_qw_71
L_qwr_72:
    ds_read_b32 v208, v209
    s_waitcnt lgkmcnt(7)
    v_mfma_f32_16x16x32_bf16 v[176:179], v[156:159], v[72:75], v[176:179]
    ds_read_b64_tr_b16 v[136:137], v206 offset:46144
    ds_read_b64_tr_b16 v[138:139], v206 offset:47424
    v_mfma_f32_16x16x32_bf16 v[180:183], v[160:163], v[72:75], v[180:183]
    ds_read_b64_tr_b16 v[140:141], v206 offset:46176
    ds_read_b64_tr_b16 v[142:143], v206 offset:47456
    s_waitcnt lgkmcnt(5)
    v_mfma_f32_16x16x32_bf16 v[184:187], v[164:167], v[72:75], v[184:187]
    ds_read_b64_tr_b16 v[144:145], v206 offset:46208
    ds_read_b64_tr_b16 v[146:147], v206 offset:47488
    v_mfma_f32_16x16x32_bf16 v[188:191], v[168:171], v[72:75], v[188:191]
    ds_read_b64_tr_b16 v[148:149], v206 offset:46240
    ds_read_b64_tr_b16 v[150:151], v206 offset:47520
    s_waitcnt lgkmcnt(8)
    v_cmp_gt_u32 vcc, 6, v208
    v_mfma_f32_16x16x32_bf16 v[192:195], v[172:175], v[72:75], v[192:195]
    ds_read_b64_tr_b16 v[152:153], v206 offset:46272
    ds_read_b64_tr_b16 v[154:155], v206 offset:47552
    s_cmp_lg_u32 s69, 3
    s_cbranch_scc1 L_ze_73
    s_waitcnt vmcnt(0)
    v_readfirstlane_b32 s74, v214
    s_nop 0
    s_cmp_ge_u32 s74, 64
    s_cselect_b32 s74, 1, 0
    v_mov_b32 v214, s74
    v_mov_b32 v213, 163672
    s_mov_b64 exec, 1
    ds_write_b32 v213, v214
    s_mov_b64 exec, -1
L_ze_73:
    s_cbranch_vccnz L_qw_74
L_qwr_75:
    ds_read_b32 v208, v209
    s_waitcnt lgkmcnt(7)
    v_mfma_f32_16x16x32_bf16 v[176:179], v[136:139], v[76:79], v[176:179]
    ds_read_b64_tr_b16 v[156:157], v206 offset:51264
    ds_read_b64_tr_b16 v[158:159], v206 offset:52544
    v_mfma_f32_16x16x32_bf16 v[180:183], v[140:143], v[76:79], v[180:183]
    ds_read_b64_tr_b16 v[160:161], v206 offset:51296
    ds_read_b64_tr_b16 v[162:163], v206 offset:52576
    s_waitcnt lgkmcnt(5)
    v_mfma_f32_16x16x32_bf16 v[184:187], v[144:147], v[76:79], v[184:187]
    ds_read_b64_tr_b16 v[164:165], v206 offset:51328
    ds_read_b64_tr_b16 v[166:167], v206 offset:52608
    v_mfma_f32_16x16x32_bf16 v[188:191], v[148:151], v[76:79], v[188:191]
    ds_read_b64_tr_b16 v[168:169], v206 offset:51360
    ds_read_b64_tr_b16 v[170:171], v206 offset:52640
    s_waitcnt lgkmcnt(8)
    v_cmp_gt_u32 vcc, 8, v208
    v_mfma_f32_16x16x32_bf16 v[192:195], v[152:155], v[76:79], v[192:195]
    ds_read_b64_tr_b16 v[172:173], v206 offset:51392
    ds_read_b64_tr_b16 v[174:175], v206 offset:52672
    s_cbranch_vccnz L_qw_76
L_qwr_77:
    s_waitcnt lgkmcnt(6)
    v_mfma_f32_16x16x32_bf16 v[176:179], v[156:159], v[80:83], v[176:179]
    ds_read_b64_tr_b16 v[136:137], v206 offset:20480
    ds_read_b64_tr_b16 v[138:139], v206 offset:21760
    v_mfma_f32_16x16x32_bf16 v[180:183], v[160:163], v[80:83], v[180:183]
    ds_read_b64_tr_b16 v[140:141], v206 offset:20512
    ds_read_b64_tr_b16 v[142:143], v206 offset:21792
    s_waitcnt lgkmcnt(4)
    v_mfma_f32_16x16x32_bf16 v[184:187], v[164:167], v[80:83], v[184:187]
    ds_read_b64_tr_b16 v[144:145], v206 offset:20544
    ds_read_b64_tr_b16 v[146:147], v206 offset:21824
    v_mfma_f32_16x16x32_bf16 v[188:191], v[168:171], v[80:83], v[188:191]
    ds_read_b64_tr_b16 v[148:149], v206 offset:20576
    ds_read_b64_tr_b16 v[150:151], v206 offset:21856
    v_mfma_f32_16x16x32_bf16 v[192:195], v[172:175], v[80:83], v[192:195]
    ds_read_b64_tr_b16 v[152:153], v206 offset:20608
    ds_read_b64_tr_b16 v[154:155], v206 offset:21888
    ds_read_b32 v208, v209
    s_waitcnt lgkmcnt(7)
    v_mfma_f32_16x16x32_bf16 v[176:179], v[136:139], v[84:87], v[176:179]
    ds_read_b64_tr_b16 v[156:157], v206 offset:25600
    ds_read_b64_tr_b16 v[158:159], v206 offset:26880
    v_mfma_f32_16x16x32_bf16 v[180:183], v[140:143], v[84:87], v[180:183]
    ds_read_b64_tr_b16 v[160:161], v206 offset:25632
    ds_read_b64_tr_b16 v[162:163], v206 offset:26912
    s_waitcnt lgkmcnt(5)
    v_mfma_f32_16x16x32_bf16 v[184:187], v[144:147], v[84:87], v[184:187]
    ds_read_b64_tr_b16 v[164:165], v206 offset:25664
    ds_read_b64_tr_b16 v[166:167], v206 offset:26944
    v_mfma_f32_16x16x32_bf16 v[188:191], v[148:151], v[84:87], v[188:191]
    ds_read_b64_tr_b16 v[168:169], v206 offset:25696
    ds_read_b64_tr_b16 v[170:171], v206 offset:26976
    s_waitcnt lgkmcnt(8)
    v_cmp_gt_u32 vcc, 10, v208
    v_mfma_f32_16x16x32_bf16 v[192:195], v[152:155], v[84:87], v[192:195]
    ds_read_b64_tr_b16 v[172:173], v206 offset:25728
    ds_read_b64_tr_b16 v[174:175], v206 offset:27008
    s_cbranch_vccnz L_qw_78
L_qwr_79:
    s_waitcnt lgkmcnt(6)
    v_mfma_f32_16x16x32_bf16 v[176:179], v[156:159], v[88:91], v[176:179]
    ds_read_b64_tr_b16 v[136:137], v206 offset:30720
    ds_read_b64_tr_b16 v[138:139], v206 offset:32000
    v_mfma_f32_16x16x32_bf16 v[180:183], v[160:163], v[88:91], v[180:183]
    ds_read_b64_tr_b16 v[140:141], v206 offset:30752
    ds_read_b64_tr_b16 v[142:143], v206 offset:32032
    s_waitcnt lgkmcnt(4)
    v_mfma_f32_16x16x32_bf16 v[184:187], v[164:167], v[88:91], v[184:187]
    ds_read_b64_tr_b16 v[144:145], v206 offset:30784
    ds_read_b64_tr_b16 v[146:147], v206 offset:32064
    v_mfma_f32_16x16x32_bf16 v[188:191], v[168:171], v[88:91], v[188:191]
    ds_read_b64_tr_b16 v[148:149], v206 offset:30816
    ds_read_b64_tr_b16 v[150:151], v206 offset:32096
    v_mfma_f32_16x16x32_bf16 v[192:195], v[172:175], v[88:91], v[192:195]
    ds_read_b64_tr_b16 v[152:153], v206 offset:30848
    ds_read_b64_tr_b16 v[154:155], v206 offset:32128
    ds_read_b32 v208, v209
    s_cmp_eq_u32 s69, 3
    s_cbranch_scc1 L_sd_80
    s_waitcnt vmcnt(0)
    v_mov_b32 v213, 163676
    v_mov_b32 v214, 1
    s_mov_b64 exec, 1
    ds_add_u32 v213, v214
    s_mov_b64 exec, -1
L_sd_80:
    s_waitcnt lgkmcnt(7)
    v_mfma_f32_16x16x32_bf16 v[176:179], v[136:139], v[92:95], v[176:179]
    ds_read_b64_tr_b16 v[156:157], v206 offset:35840
    ds_read_b64_tr_b16 v[158:159], v206 offset:37120
    v_mfma_f32_16x16x32_bf16 v[180:183], v[140:143], v[92:95], v[180:183]
    ds_read_b64_tr_b16 v[160:161], v206 offset:35872
    ds_read_b64_tr_b16 v[162:163], v206 offset:37152
    s_waitcnt lgkmcnt(5)
    v_mfma_f32_16x16x32_bf16 v[184:187], v[144:147], v[92:95], v[184:187]
    ds_read_b64_tr_b16 v[164:165], v206 offset:35904
    ds_read_b64_tr_b16 v[166:167], v206 offset:37184
    v_mfma_f32_16x16x32_bf16 v[188:191], v[148:151], v[92:95], v[188:191]
    ds_read_b64_tr_b16 v[168:169], v206 offset:35936
    ds_read_b64_tr_b16 v[170:171], v206 offset:37216
    s_waitcnt lgkmcnt(8)
    v_cmp_gt_u32 vcc, 11, v208
    v_mfma_f32_16x16x32_bf16 v[192:195], v[152:155], v[92:95], v[192:195]
    ds_read_b64_tr_b16 v[172:173], v206 offset:35968
    ds_read_b64_tr_b16 v[174:175], v206 offset:37248
    s_cbranch_vccnz L_qw_81
L_qwr_82:
    ds_read_b32 v208, v209
    s_waitcnt lgkmcnt(7)
    v_mfma_f32_16x16x32_bf16 v[176:179], v[156:159], v[96:99], v[176:179]
    ds_read_b64_tr_b16 v[136:137], v206 offset:40960
    ds_read_b64_tr_b16 v[138:139], v206 offset:42240
    v_mfma_f32_16x16x32_bf16 v[180:183], v[160:163], v[96:99], v[180:183]
    ds_read_b64_tr_b16 v[140:141], v206 offset:40992
    ds_read_b64_tr_b16 v[142:143], v206 offset:42272
    s_waitcnt lgkmcnt(5)
    v_mfma_f32_16x16x32_bf16 v[184:187], v[164:167], v[96:99], v[184:187]
    ds_read_b64_tr_b16 v[144:145], v206 offset:41024
    ds_read_b64_tr_b16 v[146:147], v206 offset:42304
    v_mfma_f32_16x16x32_bf16 v[188:191], v[168:171], v[96:99], v[188:191]
    ds_read_b64_tr_b16 v[148:149], v206 offset:41056
    ds_read_b64_tr_b16 v[150:151], v206 offset:42336
    s_waitcnt lgkmcnt(8)
    v_cmp_gt_u32 vcc, 13, v208
    v_mfma_f32_16x16x32_bf16 v[192:195], v[172:175], v[96:99], v[192:195]
    ds_read_b64_tr_b16 v[152:153], v206 offset:41088
    ds_read_b64_tr_b16 v[154:155], v206 offset:42368
    s_cbranch_vccnz L_qw_83
L_qwr_84:
    s_waitcnt lgkmcnt(6)
    v_mfma_f32_16x16x32_bf16 v[176:179], v[136:139], v[20:23], v[176:179]
    ds_read_b64_tr_b16 v[156:157], v205 offset:0
    ds_read_b64_tr_b16 v[158:159], v205 offset:1280
    v_mfma_f32_16x16x32_bf16 v[180:183], v[140:143], v[20:23], v[180:183]
    ds_read_b64_tr_b16 v[160:161], v205 offset:32
    ds_read_b64_tr_b16 v[162:163], v205 offset:1312
    s_waitcnt lgkmcnt(4)
    v_mfma_f32_16x16x32_bf16 v[184:187], v[144:147], v[20:23], v[184:187]
    ds_read_b64_tr_b16 v[164:165], v205 offset:64
    ds_read_b64_tr_b16 v[166:167], v205 offset:1344
    v_mfma_f32_16x16x32_bf16 v[188:191], v[148:151], v[20:23], v[188:191]
    ds_read_b64_tr_b16 v[168:169], v205 offset:96
    ds_read_b64_tr_b16 v[170:171], v205 offset:1376
    v_mfma_f32_16x16x32_bf16 v[192:195], v[152:155], v[20:23], v[192:195]
    ds_read_b64_tr_b16 v[172:173], v205 offset:128
    ds_read_b64_tr_b16 v[174:175], v205 offset:1408
    ds_read_b32 v208, v209
    v_mov_b32 v12, 163668
    v_mov_b32 v13, 1
    s_mov_b64 exec, 1
    ds_add_u32 v12, v13
    s_mov_b64 exec, -1
    s_waitcnt lgkmcnt(8)
    v_mfma_f32_16x16x32_bf16 v[176:179], v[156:159], v[24:27], v[176:179]
    ds_read_b64_tr_b16 v[136:137], v205 offset:5120
    ds_read_b64_tr_b16 v[138:139], v205 offset:6400
    v_mfma_f32_16x16x32_bf16 v[180:183], v[160:163], v[24:27], v[180:183]
    ds_read_b64_tr_b16 v[140:141], v205 offset:5152
    ds_read_b64_tr_b16 v[142:143], v205 offset:6432
    s_waitcnt lgkmcnt(6)
    v_mfma_f32_16x16x32_bf16 v[184:187], v[164:167], v[24:27], v[184:187]
    ds_read_b64_tr_b16 v[144:145], v205 offset:5184
    ds_read_b64_tr_b16 v[146:147], v205 offset:6464
    v_mfma_f32_16x16x32_bf16 v[188:191], v[168:171], v[24:27], v[188:191]
    ds_read_b64_tr_b16 v[148:149], v205 offset:5216
    ds_read_b64_tr_b16 v[150:151], v205 offset:6496
    s_waitcnt lgkmcnt(9)
    v_cmp_gt_u32 vcc, 15, v208
    v_mfma_f32_16x16x32_bf16 v[192:195], v[172:175], v[24:27], v[192:195]
    ds_read_b64_tr_b16 v[152:153], v205 offset:5248
    ds_read_b64_tr_b16 v[154:155], v205 offset:6528
    s_cbranch_vccnz L_qw_85
L_qwr_86:
    s_waitcnt lgkmcnt(6)
    v_mfma_f32_16x16x32_bf16 v[176:179], v[136:139], v[28:31], v[176:179]
    ds_read_b64_tr_b16 v[156:157], v205 offset:10240
    ds_read_b64_tr_b16 v[158:159], v205 offset:11520
    v_mfma_f32_16x16x32_bf16 v[180:183], v[140:143], v[28:31], v[180:183]
    ds_read_b64_tr_b16 v[160:161], v205 offset:10272
    ds_read_b64_tr_b16 v[162:163], v205 offset:11552
    s_waitcnt lgkmcnt(4)
    v_mfma_f32_16x16x32_bf16 v[184:187], v[144:147], v[28:31], v[184:187]
    ds_read_b64_tr_b16 v[164:165], v205 offset:10304
    ds_read_b64_tr_b16 v[166:167], v205 offset:11584
    v_mfma_f32_16x16x32_bf16 v[188:191], v[148:151], v[28:31], v[188:191]
    ds_read_b64_tr_b16 v[168:169], v205 offset:10336
    ds_read_b64_tr_b16 v[170:171], v205 offset:11616
    v_mfma_f32_16x16x32_bf16 v[192:195], v[152:155], v[28:31], v[192:195]
    ds_read_b64_tr_b16 v[172:173], v205 offset:10368
    ds_read_b64_tr_b16 v[174:175], v205 offset:11648
    ds_read_b32 v208, v209
    s_waitcnt lgkmcnt(7)
    v_mfma_f32_16x16x32_bf16 v[176:179], v[156:159], v[32:35], v[176:179]
    ds_read_b64_tr_b16 v[136:137], v205 offset:15360
    ds_read_b64_tr_b16 v[138:139], v205 offset:16640
    v_mfma_f32_16x16x32_bf16 v[180:183], v[160:163], v[32:35], v[180:183]
    ds_read_b64_tr_b16 v[140:141], v205 offset:15392
    ds_read_b64_tr_b16 v[142:143], v205 offset:16672
    s_waitcnt lgkmcnt(5)
    v_mfma_f32_16x16x32_bf16 v[184:187], v[164:167], v[32:35], v[184:187]
    ds_read_b64_tr_b16 v[144:145], v205 offset:15424
    ds_read_b64_tr_b16 v[146:147], v205 offset:16704
    v_mfma_f32_16x16x32_bf16 v[188:191], v[168:171], v[32:35], v[188:191]
    ds_read_b64_tr_b16 v[148:149], v205 offset:15456
    ds_read_b64_tr_b16 v[150:151], v205 offset:16736
    s_waitcnt lgkmcnt(8)
    v_cmp_gt_u32 vcc, 17, v208
    v_mfma_f32_16x16x32_bf16 v[192:195], v[172:175], v[32:35], v[192:195]
    ds_read_b64_tr_b16 v[152:153], v205 offset:15488
    ds_read_b64_tr_b16 v[154:155], v205 offset:16768
    s_cbranch_vccnz L_qw_87
L_qwr_88:
    s_waitcnt lgkmcnt(6)
    v_mfma_f32_16x16x32_bf16 v[176:179], v[136:139], v[36:39], v[176:179]
    ds_read_b64_tr_b16 v[156:157], v205 offset:20480
    ds_read_b64_tr_b16 v[158:159], v205 offset:21760
    v_mfma_f32_16x16x32_bf16 v[180:183], v[140:143], v[36:39], v[180:183]
    ds_read_b64_tr_b16 v[160:161], v205 offset:20512
    ds_read_b64_tr_b16 v[162:163], v205 offset:21792
    s_waitcnt lgkmcnt(4)
    v_mfma_f32_16x16x32_bf16 v[184:187], v[144:147], v[36:39], v[184:187]
    ds_read_b64_tr_b16 v[164:165], v205 offset:20544
    ds_read_b64_tr_b16 v[166:167], v205 offset:21824
    v_mfma_f32_16x16x32_bf16 v[188:191], v[148:151], v[36:39], v[188:191]
    ds_read_b64_tr_b16 v[168:169], v205 offset:20576
    ds_read_b64_tr_b16 v[170:171], v205 offset:21856
    v_mfma_f32_16x16x32_bf16 v[192:195], v[152:155], v[36:39], v[192:195]
    ds_read_b64_tr_b16 v[172:173], v205 offset:20608
    ds_read_b64_tr_b16 v[174:175], v205 offset:21888
    ds_read_b32 v208, v209
    s_waitcnt lgkmcnt(7)
    v_mfma_f32_16x16x32_bf16 v[176:179], v[156:159], v[40:43], v[176:179]
    ds_read_b64_tr_b16 v[136:137], v205 offset:25600
    ds_read_b64_tr_b16 v[138:139], v205 offset:26880
    v_mfma_f32_16x16x32_bf16 v[180:183], v[160:163], v[40:43], v[180:183]
    ds_read_b64_tr_b16 v[140:141], v205 offset:25632
    ds_read_b64_tr_b16 v[142:143], v205 offset:26912
    s_waitcnt lgkmcnt(5)
    v_mfma_f32_16x16x32_bf16 v[184:187], v[164:167], v[40:43], v[184:187]
    ds_read_b64_tr_b16 v[144:145], v205 offset:25664
    ds_read_b64_tr_b16 v[146:147], v205 offset:26944
    v_mfma_f32_16x16x32_bf16 v[188:191], v[168:171], v[40:43], v[188:191]
    ds_read_b64_tr_b16 v[148:149], v205 offset:25696
    ds_read_b64_tr_b16 v[150:151], v205 offset:26976
    s_waitcnt lgkmcnt(8)
    v_cmp_gt_u32 vcc, 18, v208
    v_mfma_f32_16x16x32_bf16 v[192:195], v[172:175], v[40:43], v[192:195]
    ds_read_b64_tr_b16 v[152:153], v205 offset:25728
    ds_read_b64_tr_b16 v[154:155], v205 offset:27008
    s_cbranch_vccnz L_qw_89
L_qwr_90:
    ds_read_b32 v208, v209
    s_waitcnt lgkmcnt(7)
    v_mfma_f32_16x16x32_bf16 v[176:179], v[136:139], v[44:47], v[176:179]
    ds_read_b64_tr_b16 v[156:157], v205 offset:30720
    ds_read_b64_tr_b16 v[158:159], v205 offset:32000
    v_mfma_f32_16x16x32_bf16 v[180:183], v[140:143], v[44:47], v[180:183]
    ds_read_b64_tr_b16 v[160:161], v205 offset:30752
    ds_read_b64_tr_b16 v[162:163], v205 offset:32032
    s_waitcnt lgkmcnt(5)
    v_mfma_f32_16x16x32_bf16 v[184:187], v[144:147], v[44:47], v[184:187]
    ds_read_b64_tr_b16 v[164:165], v205 offset:30784
    ds_read_b64_tr_b16 v[166:167], v205 offset:32064
    v_mfma_f32_16x16x32_bf16 v[188:191], v[148:151], v[44:47], v[188:191]
    ds_read_b64_tr_b16 v[168:169], v205 offset:30816
    ds_read_b64_tr_b16 v[170:171], v205 offset:32096
    s_waitcnt lgkmcnt(8)
    v_cmp_gt_u32 vcc, 19, v208
    v_mfma_f32_16x16x32_bf16 v[192:195], v[152:155], v[44:47], v[192:195]
    ds_read_b64_tr_b16 v[172:173], v205 offset:30848
    ds_read_b64_tr_b16 v[174:175], v205 offset:32128
    s_cbranch_vccnz L_qw_91
L_qwr_92:
    ds_read_b32 v208, v209
    s_waitcnt lgkmcnt(7)
    v_mfma_f32_16x16x32_bf16 v[176:179], v[156:159], v[48:51], v[176:179]
    ds_read_b64_tr_b16 v[136:137], v205 offset:35840
    ds_read_b64_tr_b16 v[138:139], v205 offset:37120
    v_mfma_f32_16x16x32_bf16 v[180:183], v[160:163], v[48:51], v[180:183]
    ds_read_b64_tr_b16 v[140:141], v205 offset:35872
    ds_read_b64_tr_b16 v[142:143], v205 offset:37152
    s_waitcnt lgkmcnt(5)
    v_mfma_f32_16x16x32_bf16 v[184:187], v[164:167], v[48:51], v[184:187]
    ds_read_b64_tr_b16 v[144:145], v205 offset:35904
    ds_read_b64_tr_b16 v[146:147], v205 offset:37184
    v_mfma_f32_16x16x32_bf16 v[188:191], v[168:171], v[48:51], v[188:191]
    ds_read_b64_tr_b16 v[148:149], v205 offset:35936
    ds_read_b64_tr_b16 v[150:151], v205 offset:37216
    s_waitcnt lgkmcnt(8)
    v_cmp_gt_u32 vcc, 20, v208
    v_mfma_f32_16x16x32_bf16 v[192:195], v[172:175], v[48:51], v[192:195]
    ds_read_b64_tr_b16 v[152:153], v205 offset:35968
    ds_read_b64_tr_b16 v[154:155], v205 offset:37248
    s_cbranch_vccnz L_qw_93
L_qwr_94:
    ds_read_b32 v123, v128
    s_waitcnt lgkmcnt(7)
    v_mfma_f32_16x16x32_bf16 v[176:179], v[136:139], v[52:55], v[176:179]
    ds_read_b64_tr_b16 v[156:157], v205 offset:40960
    ds_read_b64_tr_b16 v[158:159], v205 offset:42240
    v_mfma_f32_16x16x32_bf16 v[180:183], v[140:143], v[52:55], v[180:183]
    ds_read_b64_tr_b16 v[160:161], v205 offset:40992
    ds_read_b64_tr_b16 v[162:163], v205 offset:42272
    s_waitcnt lgkmcnt(5)
    v_mfma_f32_16x16x32_bf16 v[184:187], v[144:147], v[52:55], v[184:187]
    ds_read_b64_tr_b16 v[164:165], v205 offset:41024
    ds_read_b64_tr_b16 v[166:167], v205 offset:42304
    v_mfma_f32_16x16x32_bf16 v[188:191], v[148:151], v[52:55], v[188:191]
    ds_read_b64_tr_b16 v[168:169], v205 offset:41056
    ds_read_b64_tr_b16 v[170:171], v205 offset:42336
    v_mfma_f32_16x16x32_bf16 v[192:195], v[152:155], v[52:55], v[192:195]
    ds_read_b64_tr_b16 v[172:173], v205 offset:41088
    ds_read_b64_tr_b16 v[174:175], v205 offset:42368
    s_waitcnt lgkmcnt(6)
    v_mfma_f32_16x16x32_bf16 v[176:179], v[156:159], v[56:59], v[176:179]
    v_mfma_f32_16x16x32_bf16 v[180:183], v[160:163], v[56:59], v[180:183]
    s_waitcnt lgkmcnt(0)
    v_mfma_f32_16x16x32_bf16 v[184:187], v[164:167], v[56:59], v[184:187]
    v_mfma_f32_16x16x32_bf16 v[188:191], v[168:171], v[56:59], v[188:191]
    v_cmp_gt_u32 vcc, 4, v123
    v_mfma_f32_16x16x32_bf16 v[192:195], v[172:175], v[56:59], v[192:195]
    s_branch L_qgd
L_qg3:
    s_cmp_lg_u32 s69, 3
    s_cbranch_scc1 L_zi_95
    v_mov_b32 v213, 0
    buffer_load_dword v214, v213, s[56:59], 0 offen sc1
L_zi_95:
    ds_read_b64_tr_b16 v[136:137], v206 offset:0
    ds_read_b64_tr_b16 v[138:139], v206 offset:1280
    ds_read_b64_tr_b16 v[140:141], v206 offset:32
    ds_read_b64_tr_b16 v[142:143], v206 offset:1312
    ds_read_b64_tr_b16 v[144:145], v206 offset:64
    ds_read_b64_tr_b16 v[146:147], v206 offset:1344
    ds_read_b64_tr_b16 v[148:149], v206 offset:96
    ds_read_b64_tr_b16 v[150:151], v206 offset:1376
    ds_read_b64_tr_b16 v[152:153], v206 offset:128
    ds_read_b64_tr_b16 v[154:155], v206 offset:1408
    ds_read_b32 v208, v209
    s_waitcnt lgkmcnt(7)
    v_mfma_f32_16x16x32_bf16 v[176:179], v[136:139], v[80:83], 0
    ds_read_b64_tr_b16 v[156:157], v206 offset:5120
    ds_read_b64_tr_b16 v[158:159], v206 offset:6400
    v_mfma_f32_16x16x32_bf16 v[180:183], v[140:143], v[80:83], 0
    ds_read_b64_tr_b16 v[160:161], v206 offset:5152
    ds_read_b64_tr_b16 v[162:163], v206 offset:6432
    s_waitcnt lgkmcnt(5)
    v_mfma_f32_16x16x32_bf16 v[184:187], v[144:147], v[80:83], 0
    ds_read_b64_tr_b16 v[164:165], v206 offset:5184
    ds_read_b64_tr_b16 v[166:167], v206 offset:6464
    v_mfma_f32_16x16x32_bf16 v[188:191], v[148:151], v[80:83], 0
    ds_read_b64_tr_b16 v[168:169], v206 offset:5216
    ds_read_b64_tr_b16 v[170:171], v206 offset:6496
    s_waitcnt lgkmcnt(8)
    v_cmp_gt_u32 vcc, 3, v208
    v_mfma_f32_16x16x32_bf16 v[192:195], v[152:155], v[80:83], 0
    ds_read_b64_tr_b16 v[172:173], v206 offset:5248
    ds_read_b64_tr_b16 v[174:175], v206 offset:6528
    s_cbranch_vccnz L_qw_96
L_qwr_97:
    ds_read_b32 v208, v209
    s_waitcnt lgkmcnt(7)
    v_mfma_f32_16x16x32_bf16 v[176:179], v[156:159], v[84:87], v[176:179]
    ds_read_b64_tr_b16 v[136:137], v206 offset:10240
    ds_read_b64_tr_b16 v[138:139], v206 offset:11520
    v_mfma_f32_16x16x32_bf16 v[180:183], v[160:163], v[84:87], v[180:183]
    ds_read_b64_tr_b16 v[140:141], v206 offset:10272
    ds_read_b64_tr_b16 v[142:143], v206 offset:11552
    s_waitcnt lgkmcnt(5)
    v_mfma_f32_16x16x32_bf16 v[184:187], v[164:167], v[84:87], v[184:187]
    ds_read_b64_tr_b16 v[144:145], v206 offset:10304
    ds_read_b64_tr_b16 v[146:147], v206 offset:11584
    v_mfma_f32_16x16x32_bf16 v[188:191], v[168:171], v[84:87], v[188:191]
    ds_read_b64_tr_b16 v[148:149], v206 offset:10336
    ds_read_b64_tr_b16 v[150:151], v206 offset:11616
    s_waitcnt lgkmcnt(8)
    v_cmp_gt_u32 vcc, 4, v208
    v_mfma_f32_16x16x32_bf16 v[192:195], v[172:175], v[84:87], v[192:195]
    ds_read_b64_tr_b16 v[152:153], v206 offset:10368
    ds_read_b64_tr_b16 v[154:155], v206 offset:11648
    s_cbranch_vccnz L_qw_98
L_qwr_99:
    ds_read_b32 v208, v209
    s_waitcnt lgkmcnt(7)
    v_mfma_f32_16x16x32_bf16 v[176:179], v[136:139], v[88:91], v[176:179]
    ds_read_b64_tr_b16 v[156:157], v206 offset:15360
    ds_read_b64_tr_b16 v[158:159], v206 offset:16640
    v_mfma_f32_16x16x32_bf16 v[180:183], v[140:143], v[88:91], v[180:183]
    ds_read_b64_tr_b16 v[160:161], v206 offset:15392
    ds_read_b64_tr_b16 v[162:163], v206 offset:16672
    s_waitcnt lgkmcnt(5)
    v_mfma_f32_16x16x32_bf16 v[184:187], v[144:147], v[88:91], v[184:187]
    ds_read_b64_tr_b16 v[164:165], v206 offset:15424
    ds_read_b64_tr_b16 v[166:167], v206 offset:16704
    v_mfma_f32_16x16x32_bf16 v[188:191], v[148:151], v[88:91], v[188:191]
    ds_read_b64_tr_b16 v[168:169], v206 offset:15456
    ds_read_b64_tr_b16 v[170:171], v206 offset:16736
    s_waitcnt lgkmcnt(8)
    v_cmp_gt_u32 vcc, 5, v208
    v_mfma_f32_16x16x32_bf16 v[192:195], v[152:155], v[88:91], v[192:195]
    ds_read_b64_tr_b16 v[172:173], v206 offset:15488
    ds_read_b64_tr_b16 v[174:175], v206 offset:16768
    s_cbranch_vccnz L_qw_100
L_qwr_101:
    ds_read_b32 v208, v209
    s_waitcnt lgkmcnt(7)
    v_mfma_f32_16x16x32_bf16 v[176:179], v[156:159], v[92:95], v[176:179]
    ds_read_b64_tr_b16 v[136:137], v206 offset:46144
    ds_read_b64_tr_b16 v[138:139], v206 offset:47424
    v_mfma_f32_16x16x32_bf16 v[180:183], v[160:163], v[92:95], v[180:183]
    ds_read_b64_tr_b16 v[140:141], v206 offset:46176
    ds_read_b64_tr_b16 v[142:143], v206 offset:47456
    s_waitcnt lgkmcnt(5)
    v_mfma_f32_16x16x32_bf16 v[184:187], v[164:167], v[92:95], v[184:187]
    ds_read_b64_tr_b16 v[144:145], v206 offset:46208
    ds_read_b64_tr_b16 v[146:147], v206 offset:47488
    v_mfma_f32_16x16x32_bf16 v[188:191], v[168:171], v[92:95], v[188:191]
    ds_read_b64_tr_b16 v[148:149], v206 offset:46240
    ds_read_b64_tr_b16 v[150:151], v206 offset:47520
    s_waitcnt lgkmcnt(8)
    v_cmp_gt_u32 vcc, 6, v208
    v_mfma_f32_16x16x32_bf16 v[192:195], v[172:175], v[92:95], v[192:195]
    ds_read_b64_tr_b16 v[152:153], v206 offset:46272
    ds_read_b64_tr_b16 v[154:155], v206 offset:47552
    s_cmp_lg_u32 s69, 3
    s_cbranch_scc1 L_ze_102
    s_waitcnt vmcnt(0)
    v_readfirstlane_b32 s74, v214
    s_nop 0
    s_cmp_ge_u32 s74, 64
    s_cselect_b32 s74, 1, 0
    v_mov_b32 v214, s74
    v_mov_b32 v213, 163672
    s_mov_b64 exec, 1
    ds_write_b32 v213, v214
    s_mov_b64 exec, -1
L_ze_102:
    s_cbranch_vccnz L_qw_103
L_qwr_104:
    ds_read_b32 v208, v209
    s_waitcnt lgkmcnt(7)
    v_mfma_f32_16x16x32_bf16 v[176:179], v[136:139], v[96:99], v[176:179]
    ds_read_b64_tr_b16 v[156:157], v206 offset:51264
    ds_read_b64_tr_b16 v[158:159], v206 offset:52544
    v_mfma_f32_16x16x32_bf16 v[180:183], v[140:143], v[96:99], v[180:183]
    ds_read_b64_tr_b16 v[160:161], v206 offset:51296
    ds_read_b64_tr_b16 v[162:163], v206 offset:52576
    s_waitcnt lgkmcnt(5)
    v_mfma_f32_16x16x32_bf16 v[184:187], v[144:147], v[96:99], v[184:187]
    ds_read_b64_tr_b16 v[164:165], v206 offset:51328
    ds_read_b64_tr_b16 v[166:167], v206 offset:52608
    v_mfma_f32_16x16x32_bf16 v[188:191], v[148:151], v[96:99], v[188:191]
    ds_read_b64_tr_b16 v[168:169], v206 offset:51360
    ds_read_b64_tr_b16 v[170:171], v206 offset:52640
    s_waitcnt lgkmcnt(8)
    v_cmp_gt_u32 vcc, 8, v208
    v_mfma_f32_16x16x32_bf16 v[192:195], v[152:155], v[96:99], v[192:195]
    ds_read_b64_tr_b16 v[172:173], v206 offset:51392
    ds_read_b64_tr_b16 v[174:175], v206 offset:52672
    s_cbranch_vccnz L_qw_105
L_qwr_106:
    s_waitcnt lgkmcnt(6)
    v_mfma_f32_16x16x32_bf16 v[176:179], v[156:159], v[20:23], v[176:179]
    ds_read_b64_tr_b16 v[136:137], v206 offset:20480
    ds_read_b64_tr_b16 v[138:139], v206 offset:21760
    v_mfma_f32_16x16x32_bf16 v[180:183], v[160:163], v[20:23], v[180:183]
    ds_read_b64_tr_b16 v[140:141], v206 offset:20512
    ds_read_b64_tr_b16 v[142:143], v206 offset:21792
    s_waitcnt lgkmcnt(4)
    v_mfma_f32_16x16x32_bf16 v[184:187], v[164:167], v[20:23], v[184:187]
    ds_read_b64_tr_b16 v[144:145], v206 offset:20544
    ds_read_b64_tr_b16 v[146:147], v206 offset:21824
    v_mfma_f32_16x16x32_bf16 v[188:191], v[168:171], v[20:23], v[188:191]
    ds_read_b64_tr_b16 v[148:149], v206 offset:20576
    ds_read_b64_tr_b16 v[150:151], v206 offset:21856
    v_mfma_f32_16x16x32_bf16 v[192:195], v[172:175], v[20:23], v[192:195]
    ds_read_b64_tr_b16 v[152:153], v206 offset:20608
    ds_read_b64_tr_b16 v[154:155], v206 offset:21888
    ds_read_b32 v208, v209
    s_waitcnt lgkmcnt(7)
    v_mfma_f32_16x16x32_bf16 v[176:179], v[136:139], v[24:27], v[176:179]
    ds_read_b64_tr_b16 v[156:157], v206 offset:25600
    ds_read_b64_tr_b16 v[158:159], v206 offset:26880
    v_mfma_f32_16x16x32_bf16 v[180:183], v[140:143], v[24:27], v[180:183]
    ds_read_b64_tr_b16 v[160:161], v206 offset:25632
    ds_read_b64_tr_b16 v[162:163], v206 offset:26912
    s_waitcnt lgkmcnt(5)
    v_mfma_f32_16x16x32_bf16 v[184:187], v[144:147], v[24:27], v[184:187]
    ds_read_b64_tr_b16 v[164:165], v206 offset:25664
    ds_read_b64_tr_b16 v[166:167], v206 offset:26944
    v_mfma_f32_16x16x32_bf16 v[188:191], v[148:151], v[24:27], v[188:191]
    ds_read_b64_tr_b16 v[168:169], v206 offset:25696
    ds_read_b64_tr_b16 v[170:171], v206 offset:26976
    s_waitcnt lgkmcnt(8)
    v_cmp_gt_u32 vcc, 10, v208
    v_mfma_f32_16x16x32_bf16 v[192:195], v[152:155], v[24:27], v[192:195]
    ds_read_b64_tr_b16 v[172:173], v206 offset:25728
    ds_read_b64_tr_b16 v[174:175], v206 offset:27008
    s_cbranch_vccnz L_qw_107
L_qwr_108:
    s_waitcnt lgkmcnt(6)
    v_mfma_f32_16x16x32_bf16 v[176:179], v[156:159], v[28:31], v[176:179]
    ds_read_b64_tr_b16 v[136:137], v206 offset:30720
    ds_read_b64_tr_b16 v[138:139], v206 offset:32000
    v_mfma_f32_16x16x32_bf16 v[180:183], v[160:163], v[28:31], v[180:183]
    ds_read_b64_tr_b16 v[140:141], v206 offset:30752
    ds_read_b64_tr_b16 v[142:143], v206 offset:32032
    s_waitcnt lgkmcnt(4)
    v_mfma_f32_16x16x32_bf16 v[184:187], v[164:167], v[28:31], v[184:187]
    ds_read_b64_tr_b16 v[144:145], v206 offset:30784
    ds_read_b64_tr_b16 v[146:147], v206 offset:32064
    v_mfma_f32_16x16x32_bf16 v[188:191], v[168:171], v[28:31], v[188:191]
    ds_read_b64_tr_b16 v[148:149], v206 offset:30816
    ds_read_b64_tr_b16 v[150:151], v206 offset:32096
    v_mfma_f32_16x16x32_bf16 v[192:195], v[172:175], v[28:31], v[192:195]
    ds_read_b64_tr_b16 v[152:153], v206 offset:30848
    ds_read_b64_tr_b16 v[154:155], v206 offset:32128
    ds_read_b32 v208, v209
    s_cmp_eq_u32 s69, 3
    s_cbranch_scc1 L_sd_109
    s_waitcnt vmcnt(0)
    v_mov_b32 v213, 163676
    v_mov_b32 v214, 1
    s_mov_b64 exec, 1
    ds_add_u32 v213, v214
    s_mov_b64 exec, -1
L_sd_109:
    s_waitcnt lgkmcnt(7)
    v_mfma_f32_16x16x32_bf16 v[176:179], v[136:139], v[32:35], v[176:179]
    ds_read_b64_tr_b16 v[156:157], v206 offset:35840
    ds_read_b64_tr_b16 v[158:159], v206 offset:37120
    v_mfma_f32_16x16x32_bf16 v[180:183], v[140:143], v[32:35], v[180:183]
    ds_read_b64_tr_b16 v[160:161], v206 offset:35872
    ds_read_b64_tr_b16 v[162:163], v206 offset:37152
    s_waitcnt lgkmcnt(5)
    v_mfma_f32_16x16x32_bf16 v[184:187], v[144:147], v[32:35], v[184:187]
    ds_read_b64_tr_b16 v[164:165], v206 offset:35904
    ds_read_b64_tr_b16 v[166:167], v206 offset:37184
    v_mfma_f32_16x16x32_bf16 v[188:191], v[148:151], v[32:35], v[188:191]
    ds_read_b64_tr_b16 v[168:169], v206 offset:35936
    ds_read_b64_tr_b16 v[170:171], v206 offset:37216
    s_waitcnt lgkmcnt(8)
    v_cmp_gt_u32 vcc, 11, v208
    v_mfma_f32_16x16x32_bf16 v[192:195], v[152:155], v[32:35], v[192:195]
    ds_read_b64_tr_b16 v[172:173], v206 offset:35968
    ds_read_b64_tr_b16 v[174:175], v206 offset:37248
    s_cbranch_vccnz L_qw_110
L_qwr_111:
    ds_read_b32 v208, v209
    s_waitcnt lgkmcnt(7)
    v_mfma_f32_16x16x32_bf16 v[176:179], v[156:159], v[36:39], v[176:179]
    ds_read_b64_tr_b16 v[136:137], v206 offset:40960
    ds_read_b64_tr_b16 v[138:139], v206 offset:42240
    v_mfma_f32_16x16x32_bf16 v[180:183], v[160:163], v[36:39], v[180:183]
    ds_read_b64_tr_b16 v[140:141], v206 offset:40992
    ds_read_b64_tr_b16 v[142:143], v206 offset:42272
    s_waitcnt lgkmcnt(5)
    v_mfma_f32_16x16x32_bf16 v[184:187], v[164:167], v[36:39], v[184:187]
    ds_read_b64_tr_b16 v[144:145], v206 offset:41024
    ds_read_b64_tr_b16 v[146:147], v206 offset:42304
    v_mfma_f32_16x16x32_bf16 v[188:191], v[168:171], v[36:39], v[188:191]
    ds_read_b64_tr_b16 v[148:149], v206 offset:41056
    ds_read_b64_tr_b16 v[150:151], v206 offset:42336
    s_waitcnt lgkmcnt(8)
    v_cmp_gt_u32 vcc, 13, v208
    v_mfma_f32_16x16x32_bf16 v[192:195], v[172:175], v[36:39], v[192:195]
    ds_read_b64_tr_b16 v[152:153], v206 offset:41088
    ds_read_b64_tr_b16 v[154:155], v206 offset:42368
    s_cbranch_vccnz L_qw_112
L_qwr_113:
    s_waitcnt lgkmcnt(6)
    v_mfma_f32_16x16x32_bf16 v[176:179], v[136:139], v[40:43], v[176:179]
    ds_read_b64_tr_b16 v[156:157], v205 offset:0
    ds_read_b64_tr_b16 v[158:159], v205 offset:1280
    v_mfma_f32_16x16x32_bf16 v[180:183], v[140:143], v[40:43], v[180:183]
    ds_read_b64_tr_b16 v[160:161], v205 offset:32
    ds_read_b64_tr_b16 v[162:163], v205 offset:1312
    s_waitcnt lgkmcnt(4)
    v_mfma_f32_16x16x32_bf16 v[184:187], v[144:147], v[40:43], v[184:187]
    ds_read_b64_tr_b16 v[164:165], v205 offset:64
    ds_read_b64_tr_b16 v[166:167], v205 offset:1344
    v_mfma_f32_16x16x32_bf16 v[188:191], v[148:151], v[40:43], v[188:191]
    ds_read_b64_tr_b16 v[168:169], v205 offset:96
    ds_read_b64_tr_b16 v[170:171], v205 offset:1376
    v_mfma_f32_16x16x32_bf16 v[192:195], v[152:155], v[40:43], v[192:195]
    ds_read_b64_tr_b16 v[172:173], v205 offset:128
    ds_read_b64_tr_b16 v[174:175], v205 offset:1408
    ds_read_b32 v208, v209
    v_mov_b32 v12, 163668
    v_mov_b32 v13, 1
    s_mov_b64 exec, 1
    ds_add_u32 v12, v13
    s_mov_b64 exec, -1
    s_waitcnt lgkmcnt(8)
    v_mfma_f32_16x16x32_bf16 v[176:179], v[156:159], v[44:47], v[176:179]
    ds_read_b64_tr_b16 v[136:137], v205 offset:5120
    ds_read_b64_tr_b16 v[138:139], v205 offset:6400
    v_mfma_f32_16x16x32_bf16 v[180:183], v[160:163], v[44:47], v[180:183]
    ds_read_b64_tr_b16 v[140:141], v205 offset:5152
    ds_read_b64_tr_b16 v[142:143], v205 offset:6432
    s_waitcnt lgkmcnt(6)
    v_mfma_f32_16x16x32_bf16 v[184:187], v[164:167], v[44:47], v[184:187]
    ds_read_b64_tr_b16 v[144:145], v205 offset:5184
    ds_read_b64_tr_b16 v[146:147], v205 offset:6464
    v_mfma_f32_16x16x32_bf16 v[188:191], v[168:171], v[44:47], v[188:191]
    ds_read_b64_tr_b16 v[148:149], v205 offset:5216
    ds_read_b64_tr_b16 v[150:151], v205 offset:6496
    s_waitcnt lgkmcnt(9)
    v_cmp_gt_u32 vcc, 15, v208
    v_mfma_f32_16x16x32_bf16 v[192:195], v[172:175], v[44:47], v[192:195]
    ds_read_b64_tr_b16 v[152:153], v205 offset:5248
    ds_read_b64_tr_b16 v[154:155], v205 offset:6528
    s_cbranch_vccnz L_qw_114
L_qwr_115:
    s_waitcnt lgkmcnt(6)
    v_mfma_f32_16x16x32_bf16 v[176:179], v[136:139], v[48:51], v[176:179]
    ds_read_b64_tr_b16 v[156:157], v205 offset:10240
    ds_read_b64_tr_b16 v[158:159], v205 offset:11520
    v_mfma_f32_16x16x32_bf16 v[180:183], v[140:143], v[48:51], v[180:183]
    ds_read_b64_tr_b16 v[160:161], v205 offset:10272
    ds_read_b64_tr_b16 v[162:163], v205 offset:11552
    s_waitcnt lgkmcnt(4)
    v_mfma_f32_16x16x32_bf16 v[184:187], v[144:147], v[48:51], v[184:187]
    ds_read_b64_tr_b16 v[164:165], v205 offset:10304
    ds_read_b64_tr_b16 v[166:167], v205 offset:11584
    v_mfma_f32_16x16x32_bf16 v[188:191], v[148:151], v[48:51], v[188:191]
    ds_read_b64_tr_b16 v[168:169], v205 offset:10336
    ds_read_b64_tr_b16 v[170:171], v205 offset:11616
    v_mfma_f32_16x16x32_bf16 v[192:195], v[152:155], v[48:51], v[192:195]
    ds_read_b64_tr_b16 v[172:173], v205 offset:10368
    ds_read_b64_tr_b16 v[174:175], v205 offset:11648
    ds_read_b32 v208, v209
    s_waitcnt lgkmcnt(7)
    v_mfma_f32_16x16x32_bf16 v[176:179], v[156:159], v[52:55], v[176:179]
    ds_read_b64_tr_b16 v[136:137], v205 offset:15360
    ds_read_b64_tr_b16 v[138:139], v205 offset:16640
    v_mfma_f32_16x16x32_bf16 v[180:183], v[160:163], v[52:55], v[180:183]
    ds_read_b64_tr_b16 v[140:141], v205 offset:15392
    ds_read_b64_tr_b16 v[142:143], v205 offset:16672
    s_waitcnt lgkmcnt(5)
    v_mfma_f32_16x16x32_bf16 v[184:187], v[164:167], v[52:55], v[184:187]
    ds_read_b64_tr_b16 v[144:145], v205 offset:15424
    ds_read_b64_tr_b16 v[146:147], v205 offset:16704
    v_mfma_f32_16x16x32_bf16 v[188:191], v[168:171], v[52:55], v[188:191]
    ds_read_b64_tr_b16 v[148:149], v205 offset:15456
    ds_read_b64_tr_b16 v[150:151], v205 offset:16736
    s_waitcnt lgkmcnt(8)
    v_cmp_gt_u32 vcc, 17, v208
    v_mfma_f32_16x16x32_bf16 v[192:195], v[172:175], v[52:55], v[192:195]
    ds_read_b64_tr_b16 v[152:153], v205 offset:15488
    ds_read_b64_tr_b16 v[154:155], v205 offset:16768
    s_cbranch_vccnz L_qw_116
L_qwr_117:
    s_waitcnt lgkmcnt(6)
    v_mfma_f32_16x16x32_bf16 v[176:179], v[136:139], v[56:59], v[176:179]
    ds_read_b64_tr_b16 v[156:157], v205 offset:20480
    ds_read_b64_tr_b16 v[158:159], v205 offset:21760
    v_mfma_f32_16x16x32_bf16 v[180:183], v[140:143], v[56:59], v[180:183]
    ds_read_b64_tr_b16 v[160:161], v205 offset:20512
    ds_read_b64_tr_b16 v[162:163], v205 offset:21792
    s_waitcnt lgkmcnt(4)
    v_mfma_f32_16x16x32_bf16 v[184:187], v[144:147], v[56:59], v[184:187]
    ds_read_b64_tr_b16 v[164:165], v205 offset:20544
    ds_read_b64_tr_b16 v[166:167], v205 offset:21824
    v_mfma_f32_16x16x32_bf16 v[188:191], v[148:151], v[56:59], v[188:191]
    ds_read_b64_tr_b16 v[168:169], v205 offset:20576
    ds_read_b64_tr_b16 v[170:171], v205 offset:21856
    v_mfma_f32_16x16x32_bf16 v[192:195], v[152:155], v[56:59], v[192:195]
    ds_read_b64_tr_b16 v[172:173], v205 offset:20608
    ds_read_b64_tr_b16 v[174:175], v205 offset:21888
    ds_read_b32 v208, v209
    s_waitcnt lgkmcnt(7)
    v_mfma_f32_16x16x32_bf16 v[176:179], v[156:159], v[60:63], v[176:179]
    ds_read_b64_tr_b16 v[136:137], v205 offset:25600
    ds_read_b64_tr_b16 v[138:139], v205 offset:26880
    v_mfma_f32_16x16x32_bf16 v[180:183], v[160:163], v[60:63], v[180:183]
    ds_read_b64_tr_b16 v[140:141], v205 offset:25632
    ds_read_b64_tr_b16 v[142:143], v205 offset:26912
    s_waitcnt lgkmcnt(5)
    v_mfma_f32_16x16x32_bf16 v[184:187], v[164:167], v[60:63], v[184:187]
    ds_read_b64_tr_b16 v[144:145], v205 offset:25664
    ds_read_b64_tr_b16 v[146:147], v205 offset:26944
    v_mfma_f32_16x16x32_bf16 v[188:191], v[168:171], v[60:63], v[188:191]
    ds_read_b64_tr_b16 v[148:149], v205 offset:25696
    ds_read_b64_tr_b16 v[150:151], v205 offset:26976
    s_waitcnt lgkmcnt(8)
    v_cmp_gt_u32 vcc, 18, v208
    v_mfma_f32_16x16x32_bf16 v[192:195], v[172:175], v[60:63], v[192:195]
    ds_read_b64_tr_b16 v[152:153], v205 offset:25728
    ds_read_b64_tr_b16 v[154:155], v205 offset:27008
    s_cbranch_vccnz L_qw_118
L_qwr_119:
    ds_read_b32 v208, v209
    s_waitcnt lgkmcnt(7)
    v_mfma_f32_16x16x32_bf16 v[176:179], v[136:139], v[64:67], v[176:179]
    ds_read_b64_tr_b16 v[156:157], v205 offset:30720
    ds_read_b64_tr_b16 v[158:159], v205 offset:32000
    v_mfma_f32_16x16x32_bf16 v[180:183], v[140:143], v[64:67], v[180:183]
    ds_read_b64_tr_b16 v[160:161], v205 offset:30752
    ds_read_b64_tr_b16 v[162:163], v205 offset:32032
    s_waitcnt lgkmcnt(5)
    v_mfma_f32_16x16x32_bf16 v[184:187], v[144:147], v[64:67], v[184:187]
    ds_read_b64_tr_b16 v[164:165], v205 offset:30784
    ds_read_b64_tr_b16 v[166:167], v205 offset:32064
    v_mfma_f32_16x16x32_bf16 v[188:191], v[148:151], v[64:67], v[188:191]
    ds_read_b64_tr_b16 v[168:169], v205 offset:30816
    ds_read_b64_tr_b16 v[170:171], v205 offset:32096
    s_waitcnt lgkmcnt(8)
    v_cmp_gt_u32 vcc, 19, v208
    v_mfma_f32_16x16x32_bf16 v[192:195], v[152:155], v[64:67], v[192:195]
    ds_read_b64_tr_b16 v[172:173], v205 offset:30848
    ds_read_b64_tr_b16 v[174:175], v205 offset:32128
    s_cbranch_vccnz L_qw_120
L_qwr_121:
    ds_read_b32 v208, v209
    s_waitcnt lgkmcnt(7)
    v_mfma_f32_16x16x32_bf16 v[176:179], v[156:159], v[68:71], v[176:179]
    ds_read_b64_tr_b16 v[136:137], v205 offset:35840
    ds_read_b64_tr_b16 v[138:139], v205 offset:37120
    v_mfma_f32_16x16x32_bf16 v[180:183], v[160:163], v[68:71], v[180:183]
    ds_read_b64_tr_b16 v[140:141], v205 offset:35872
    ds_read_b64_tr_b16 v[142:143], v205 offset:37152
    s_waitcnt lgkmcnt(5)
    v_mfma_f32_16x16x32_bf16 v[184:187], v[164:167], v[68:71], v[184:187]
    ds_read_b64_tr_b16 v[144:145], v205 offset:35904
    ds_read_b64_tr_b16 v[146:147], v205 offset:37184
    v_mfma_f32_16x16x32_bf16 v[188:191], v[168:171], v[68:71], v[188:191]
    ds_read_b64_tr_b16 v[148:149], v205 offset:35936
    ds_read_b64_tr_b16 v[150:151], v205 offset:37216
    s_waitcnt lgkmcnt(8)
    v_cmp_gt_u32 vcc, 20, v208
    v_mfma_f32_16x16x32_bf16 v[192:195], v[172:175], v[68:71], v[192:195]
    ds_read_b64_tr_b16 v[152:153], v205 offset:35968
    ds_read_b64_tr_b16 v[154:155], v205 offset:37248
    s_cbranch_vccnz L_qw_122
L_qwr_123:
    ds_read_b32 v123, v128
    s_waitcnt lgkmcnt(7)
    v_mfma_f32_16x16x32_bf16 v[176:179], v[136:139], v[72:75], v[176:179]
    ds_read_b64_tr_b16 v[156:157], v205 offset:40960
    ds_read_b64_tr_b16 v[158:159], v205 offset:42240
    v_mfma_f32_16x16x32_bf16 v[180:183], v[140:143], v[72:75], v[180:183]
    ds_read_b64_tr_b16 v[160:161], v205 offset:40992
    ds_read_b64_tr_b16 v[162:163], v205 offset:42272
    s_waitcnt lgkmcnt(5)
    v_mfma_f32_16x16x32_bf16 v[184:187], v[144:147], v[72:75], v[184:187]
    ds_read_b64_tr_b16 v[164:165], v205 offset:41024
    ds_read_b64_tr_b16 v[166:167], v205 offset:42304
    v_mfma_f32_16x16x32_bf16 v[188:191], v[148:151], v[72:75], v[188:191]
    ds_read_b64_tr_b16 v[168:169], v205 offset:41056
    ds_read_b64_tr_b16 v[170:171], v205 offset:42336
    v_mfma_f32_16x16x32_bf16 v[192:195], v[152:155], v[72:75], v[192:195]
    ds_read_b64_tr_b16 v[172:173], v205 offset:41088
    ds_read_b64_tr_b16 v[174:175], v205 offset:42368
    s_waitcnt lgkmcnt(6)
    v_mfma_f32_16x16x32_bf16 v[176:179], v[156:159], v[76:79], v[176:179]
    v_mfma_f32_16x16x32_bf16 v[180:183], v[160:163], v[76:79], v[180:183]
    s_waitcnt lgkmcnt(0)
    v_mfma_f32_16x16x32_bf16 v[184:187], v[164:167], v[76:79], v[184:187]
    v_mfma_f32_16x16x32_bf16 v[188:191], v[168:171], v[76:79], v[188:191]
    v_cmp_gt_u32 vcc, 4, v123
    v_mfma_f32_16x16x32_bf16 v[192:195], v[172:175], v[76:79], v[192:195]
L_qgd:
    s_cbranch_vccnz L_c4slow
L_c4ok:
    s_mov_b64 exec, 0xffff
    ds_write_b32 v212, v121
    s_mov_b64 exec, -1
    v_pk_mul_f32 v[176:177], v[176:177], v[126:127] op_sel_hi:[1,0]
    v_pk_mul_f32 v[178:179], v[178:179], v[126:127] op_sel_hi:[1,0]
    v_cvt_pk_bf16_f32 v176, v176, v177
    v_cvt_pk_bf16_f32 v177, v178, v179
    ds_write_b64 v210, v[176:177] offset:0
    v_pk_mul_f32 v[180:181], v[180:181], v[126:127] op_sel_hi:[1,0]
    v_pk_mul_f32 v[182:183], v[182:183], v[126:127] op_sel_hi:[1,0]
    v_cvt_pk_bf16_f32 v180, v180, v181
    v_cvt_pk_bf16_f32 v181, v182, v183
    ds_write_b64 v210, v[180:181] offset:32
    v_pk_mul_f32 v[184:185], v[184:185], v[126:127] op_sel_hi:[1,0]
    v_pk_mul_f32 v[186:187], v[186:187], v[126:127] op_sel_hi:[1,0]
    v_cvt_pk_bf16_f32 v184, v184, v185
    v_cvt_pk_bf16_f32 v185, v186, v187
    ds_write_b64 v210, v[184:185] offset:64
    v_pk_mul_f32 v[188:189], v[188:189], v[126:127] op_sel_hi:[1,0]
    v_pk_mul_f32 v[190:191], v[190:191], v[126:127] op_sel_hi:[1,0]
    v_cvt_pk_bf16_f32 v188, v188, v189
    v_cvt_pk_bf16_f32 v189, v190, v191
    ds_write_b64 v210, v[188:189] offset:96
    v_pk_mul_f32 v[192:193], v[192:193], v[126:127] op_sel_hi:[1,0]
    v_pk_mul_f32 v[194:195], v[194:195], v[126:127] op_sel_hi:[1,0]
    v_cvt_pk_bf16_f32 v192, v192, v193
    v_cvt_pk_bf16_f32 v193, v194, v195
    ds_write_b64 v210, v[192:193] offset:128
    s_waitcnt vmcnt(0)
    s_branch L_x1
L_c4slow:
    v_mov_b32 v12, 163668
    s_mov_b32 s99, 0
L_c4_124:
    ds_read_b32 v13, v12
    s_waitcnt lgkmcnt(0)
    v_readfirstlane_b32 s74, v13
    s_nop 0
    s_cmp_ge_u32 s74, 4
    s_cbranch_scc1 L_c4d_125
    s_add_u32 s99, s99, 1
    s_cmp_lt_u32 s99, 2097152
    s_cbranch_scc1 L_c4_124
L_c4d_125:
    s_branch L_c4ok
L_qw_9:
    s_mov_b32 s99, 0
L_qw_9s:
    ds_read_b32 v208, v209
    s_waitcnt lgkmcnt(0)
    v_readfirstlane_b32 s74, v208
    s_nop 0
    s_cmp_ge_u32 s74, 3
    s_cbranch_scc1 L_qwr_10
    s_add_u32 s99, s99, 1
    s_cmp_lt_u32 s99, 2097152
    s_cbranch_scc1 L_qw_9s
    s_branch L_qwr_10
L_qw_11:
    s_mov_b32 s99, 0
L_qw_11s:
    ds_read_b32 v208, v209
    s_waitcnt lgkmcnt(0)
    v_readfirstlane_b32 s74, v208
    s_nop 0
    s_cmp_ge_u32 s74, 4
    s_cbranch_scc1 L_qwr_12
    s_add_u32 s99, s99, 1
    s_cmp_lt_u32 s99, 2097152
    s_cbranch_scc1 L_qw_11s
    s_branch L_qwr_12
L_qw_13:
    s_mov_b32 s99, 0
L_qw_13s:
    ds_read_b32 v208, v209
    s_waitcnt lgkmcnt(0)
    v_readfirstlane_b32 s74, v208
    s_nop 0
    s_cmp_ge_u32 s74, 5
    s_cbranch_scc1 L_qwr_14
    s_add_u32 s99, s99, 1
    s_cmp_lt_u32 s99, 2097152
    s_cbranch_scc1 L_qw_13s
    s_branch L_qwr_14
L_qw_16:
    s_mov_b32 s99, 0
L_qw_16s:
    ds_read_b32 v208, v209
    s_waitcnt lgkmcnt(0)
    v_readfirstlane_b32 s74, v208
    s_nop 0
    s_cmp_ge_u32 s74, 6
    s_cbranch_scc1 L_qwr_17
    s_add_u32 s99, s99, 1
    s_cmp_lt_u32 s99, 2097152
    s_cbranch_scc1 L_qw_16s
    s_branch L_qwr_17
L_qw_18:
    s_mov_b32 s99, 0
L_qw_18s:
    ds_read_b32 v208, v209
    s_waitcnt lgkmcnt(0)
    v_readfirstlane_b32 s74, v208
    s_nop 0
    s_cmp_ge_u32 s74, 8
    s_cbranch_scc1 L_qwr_19
    s_add_u32 s99, s99, 1
    s_cmp_lt_u32 s99, 2097152
    s_cbranch_scc1 L_qw_18s
    s_branch L_qwr_19
L_qw_20:
    s_mov_b32 s99, 0
L_qw_20s:
    ds_read_b32 v208, v209
    s_waitcnt lgkmcnt(0)
    v_readfirstlane_b32 s74, v208
    s_nop 0
    s_cmp_ge_u32 s74, 10
    s_cbranch_scc1 L_qwr_21
    s_add_u32 s99, s99, 1
    s_cmp_lt_u32 s99, 2097152
    s_cbranch_scc1 L_qw_20s
    s_branch L_qwr_21
L_qw_23:
    s_mov_b32 s99, 0
L_qw_23s:
    ds_read_b32 v208, v209
    s_waitcnt lgkmcnt(0)
    v_readfirstlane_b32 s74, v208
    s_nop 0
    s_cmp_ge_u32 s74, 11
    s_cbranch_scc1 L_qwr_24
    s_add_u32 s99, s99, 1
    s_cmp_lt_u32 s99, 2097152
    s_cbranch_scc1 L_qw_23s
    s_branch L_qwr_24
L_qw_25:
    s_mov_b32 s99, 0
L_qw_25s:
    ds_read_b32 v208, v209
    s_waitcnt lgkmcnt(0)
    v_readfirstlane_b32 s74, v208
    s_nop 0
    s_cmp_ge_u32 s74, 13
    s_cbranch_scc1 L_qwr_26
    s_add_u32 s99, s99, 1
    s_cmp_lt_u32 s99, 2097152
    s_cbranch_scc1 L_qw_25s
    s_branch L_qwr_26
L_qw_27:
    s_mov_b32 s99, 0
L_qw_27s:
    ds_read_b32 v208, v209
    s_waitcnt lgkmcnt(0)
    v_readfirstlane_b32 s74, v208
    s_nop 0
    s_cmp_ge_u32 s74, 15
    s_cbranch_scc1 L_qwr_28
    s_add_u32 s99, s99, 1
    s_cmp_lt_u32 s99, 2097152
    s_cbranch_scc1 L_qw_27s
    s_branch L_qwr_28
L_qw_29:
    s_mov_b32 s99, 0
L_qw_29s:
    ds_read_b32 v208, v209
    s_waitcnt lgkmcnt(0)
    v_readfirstlane_b32 s74, v208
    s_nop 0
    s_cmp_ge_u32 s74, 17
    s_cbranch_scc1 L_qwr_30
    s_add_u32 s99, s99, 1
    s_cmp_lt_u32 s99, 2097152
    s_cbranch_scc1 L_qw_29s
    s_branch L_qwr_30
L_qw_31:
    s_mov_b32 s99, 0
L_qw_31s:
    ds_read_b32 v208, v209
    s_waitcnt lgkmcnt(0)
    v_readfirstlane_b32 s74, v208
    s_nop 0
    s_cmp_ge_u32 s74, 18
    s_cbranch_scc1 L_qwr_32
    s_add_u32 s99, s99, 1
    s_cmp_lt_u32 s99, 2097152
    s_cbranch_scc1 L_qw_31s
    s_branch L_qwr_32
L_qw_33:
    s_mov_b32 s99, 0
L_qw_33s:
    ds_read_b32 v208, v209
    s_waitcnt lgkmcnt(0)
    v_readfirstlane_b32 s74, v208
    s_nop 0
    s_cmp_ge_u32 s74, 19
    s_cbranch_scc1 L_qwr_34
    s_add_u32 s99, s99, 1
    s_cmp_lt_u32 s99, 2097152
    s_cbranch_scc1 L_qw_33s
    s_branch L_qwr_34
L_qw_35:
    s_mov_b32 s99, 0
L_qw_35s:
    ds_read_b32 v208, v209
    s_waitcnt lgkmcnt(0)
    v_readfirstlane_b32 s74, v208
    s_nop 0
    s_cmp_ge_u32 s74, 20
    s_cbranch_scc1 L_qwr_36
    s_add_u32 s99, s99, 1
    s_cmp_lt_u32 s99, 2097152
    s_cbranch_scc1 L_qw_35s
    s_branch L_qwr_36
L_qw_38:
    s_mov_b32 s99, 0
L_qw_38s:
    ds_read_b32 v208, v209
    s_waitcnt lgkmcnt(0)
    v_readfirstlane_b32 s74, v208
    s_nop 0
    s_cmp_ge_u32 s74, 3
    s_cbranch_scc1 L_qwr_39
    s_add_u32 s99, s99, 1
    s_cmp_lt_u32 s99, 2097152
    s_cbranch_scc1 L_qw_38s
    s_branch L_qwr_39
L_qw_40:
    s_mov_b32 s99, 0
L_qw_40s:
    ds_read_b32 v208, v209
    s_waitcnt lgkmcnt(0)
    v_readfirstlane_b32 s74, v208
    s_nop 0
    s_cmp_ge_u32 s74, 4
    s_cbranch_scc1 L_qwr_41
    s_add_u32 s99, s99, 1
    s_cmp_lt_u32 s99, 2097152
    s_cbranch_scc1 L_qw_40s
    s_branch L_qwr_41
L_qw_42:
    s_mov_b32 s99, 0
L_qw_42s:
    ds_read_b32 v208, v209
    s_waitcnt lgkmcnt(0)
    v_readfirstlane_b32 s74, v208
    s_nop 0
    s_cmp_ge_u32 s74, 5
    s_cbranch_scc1 L_qwr_43
    s_add_u32 s99, s99, 1
    s_cmp_lt_u32 s99, 2097152
    s_cbranch_scc1 L_qw_42s
    s_branch L_qwr_43
L_qw_45:
    s_mov_b32 s99, 0
L_qw_45s:
    ds_read_b32 v208, v209
    s_waitcnt lgkmcnt(0)
    v_readfirstlane_b32 s74, v208
    s_nop 0
    s_cmp_ge_u32 s74, 6
    s_cbranch_scc1 L_qwr_46
    s_add_u32 s99, s99, 1
    s_cmp_lt_u32 s99, 2097152
    s_cbranch_scc1 L_qw_45s
    s_branch L_qwr_46
L_qw_47:
    s_mov_b32 s99, 0
L_qw_47s:
    ds_read_b32 v208, v209
    s_waitcnt lgkmcnt(0)
    v_readfirstlane_b32 s74, v208
    s_nop 0
    s_cmp_ge_u32 s74, 8
    s_cbranch_scc1 L_qwr_48
    s_add_u32 s99, s99, 1
    s_cmp_lt_u32 s99, 2097152
    s_cbranch_scc1 L_qw_47s
    s_branch L_qwr_48
L_qw_49:
    s_mov_b32 s99, 0
L_qw_49s:
    ds_read_b32 v208, v209
    s_waitcnt lgkmcnt(0)
    v_readfirstlane_b32 s74, v208
    s_nop 0
    s_cmp_ge_u32 s74, 10
    s_cbranch_scc1 L_qwr_50
    s_add_u32 s99, s99, 1
    s_cmp_lt_u32 s99, 2097152
    s_cbranch_scc1 L_qw_49s
    s_branch L_qwr_50
L_qw_52:
    s_mov_b32 s99, 0
L_qw_52s:
    ds_read_b32 v208, v209
    s_waitcnt lgkmcnt(0)
    v_readfirstlane_b32 s74, v208
    s_nop 0
    s_cmp_ge_u32 s74, 11
    s_cbranch_scc1 L_qwr_53
    s_add_u32 s99, s99, 1
    s_cmp_lt_u32 s99, 2097152
    s_cbranch_scc1 L_qw_52s
    s_branch L_qwr_53
L_qw_54:
    s_mov_b32 s99, 0
L_qw_54s:
    ds_read_b32 v208, v209
    s_waitcnt lgkmcnt(0)
    v_readfirstlane_b32 s74, v208
    s_nop 0
    s_cmp_ge_u32 s74, 13
    s_cbranch_scc1 L_qwr_55
    s_add_u32 s99, s99, 1
    s_cmp_lt_u32 s99, 2097152
    s_cbranch_scc1 L_qw_54s
    s_branch L_qwr_55
L_qw_56:
    s_mov_b32 s99, 0
L_qw_56s:
    ds_read_b32 v208, v209
    s_waitcnt lgkmcnt(0)
    v_readfirstlane_b32 s74, v208
    s_nop 0
    s_cmp_ge_u32 s74, 15
    s_cbranch_scc1 L_qwr_57
    s_add_u32 s99, s99, 1
    s_cmp_lt_u32 s99, 2097152
    s_cbranch_scc1 L_qw_56s
    s_branch L_qwr_57
L_qw_58:
    s_mov_b32 s99, 0
L_qw_58s:
    ds_read_b32 v208, v209
    s_waitcnt lgkmcnt(0)
    v_readfirstlane_b32 s74, v208
    s_nop 0
    s_cmp_ge_u32 s74, 17
    s_cbranch_scc1 L_qwr_59
    s_add_u32 s99, s99, 1
    s_cmp_lt_u32 s99, 2097152
    s_cbranch_scc1 L_qw_58s
    s_branch L_qwr_59
L_qw_60:
    s_mov_b32 s99, 0
L_qw_60s:
    ds_read_b32 v208, v209
    s_waitcnt lgkmcnt(0)
    v_readfirstlane_b32 s74, v208
    s_nop 0
    s_cmp_ge_u32 s74, 18
    s_cbranch_scc1 L_qwr_61
    s_add_u32 s99, s99, 1
    s_cmp_lt_u32 s99, 2097152
    s_cbranch_scc1 L_qw_60s
    s_branch L_qwr_61
L_qw_62:
    s_mov_b32 s99, 0
L_qw_62s:
    ds_read_b32 v208, v209
    s_waitcnt lgkmcnt(0)
    v_readfirstlane_b32 s74, v208
    s_nop 0
    s_cmp_ge_u32 s74, 19
    s_cbranch_scc1 L_qwr_63
    s_add_u32 s99, s99, 1
    s_cmp_lt_u32 s99, 2097152
    s_cbranch_scc1 L_qw_62s
    s_branch L_qwr_63
L_qw_64:
    s_mov_b32 s99, 0
L_qw_64s:
    ds_read_b32 v208, v209
    s_waitcnt lgkmcnt(0)
    v_readfirstlane_b32 s74, v208
    s_nop 0
    s_cmp_ge_u32 s74, 20
    s_cbranch_scc1 L_qwr_65
    s_add_u32 s99, s99, 1
    s_cmp_lt_u32 s99, 2097152
    s_cbranch_scc1 L_qw_64s
    s_branch L_qwr_65
L_qw_67:
    s_mov_b32 s99, 0
L_qw_67s:
    ds_read_b32 v208, v209
    s_waitcnt lgkmcnt(0)
    v_readfirstlane_b32 s74, v208
    s_nop 0
    s_cmp_ge_u32 s74, 3
    s_cbranch_scc1 L_qwr_68
    s_add_u32 s99, s99, 1
    s_cmp_lt_u32 s99, 2097152
    s_cbranch_scc1 L_qw_67s
    s_branch L_qwr_68
L_qw_69:
    s_mov_b32 s99, 0
L_qw_69s:
    ds_read_b32 v208, v209
    s_waitcnt lgkmcnt(0)
    v_readfirstlane_b32 s74, v208
    s_nop 0
    s_cmp_ge_u32 s74, 4
    s_cbranch_scc1 L_qwr_70
    s_add_u32 s99, s99, 1
    s_cmp_lt_u32 s99, 2097152
    s_cbranch_scc1 L_qw_69s
    s_branch L_qwr_70
L_qw_71:
    s_mov_b32 s99, 0
L_qw_71s:
    ds_read_b32 v208, v209
    s_waitcnt lgkmcnt(0)
    v_readfirstlane_b32 s74, v208
    s_nop 0
    s_cmp_ge_u32 s74, 5
    s_cbranch_scc1 L_qwr_72
    s_add_u32 s99, s99, 1
    s_cmp_lt_u32 s99, 2097152
    s_cbranch_scc1 L_qw_71s
    s_branch L_qwr_72
L_qw_74:
    s_mov_b32 s99, 0
L_qw_74s:
    ds_read_b32 v208, v209
    s_waitcnt lgkmcnt(0)
    v_readfirstlane_b32 s74, v208
    s_nop 0
    s_cmp_ge_u32 s74, 6
    s_cbranch_scc1 L_qwr_75
    s_add_u32 s99, s99, 1
    s_cmp_lt_u32 s99, 2097152
    s_cbranch_scc1 L_qw_74s
    s_branch L_qwr_75
L_qw_76:
    s_mov_b32 s99, 0
L_qw_76s:
    ds_read_b32 v208, v209
    s_waitcnt lgkmcnt(0)
    v_readfirstlane_b32 s74, v208
    s_nop 0
    s_cmp_ge_u32 s74, 8
    s_cbranch_scc1 L_qwr_77
    s_add_u32 s99, s99, 1
    s_cmp_lt_u32 s99, 2097152
    s_cbranch_scc1 L_qw_76s
    s_branch L_qwr_77
L_qw_78:
    s_mov_b32 s99, 0
L_qw_78s:
    ds_read_b32 v208, v209
    s_waitcnt lgkmcnt(0)
    v_readfirstlane_b32 s74, v208
    s_nop 0
    s_cmp_ge_u32 s74, 10
    s_cbranch_scc1 L_qwr_79
    s_add_u32 s99, s99, 1
    s_cmp_lt_u32 s99, 2097152
    s_cbranch_scc1 L_qw_78s
    s_branch L_qwr_79
L_qw_81:
    s_mov_b32 s99, 0
L_qw_81s:
    ds_read_b32 v208, v209
    s_waitcnt lgkmcnt(0)
    v_readfirstlane_b32 s74, v208
    s_nop 0
    s_cmp_ge_u32 s74, 11
    s_cbranch_scc1 L_qwr_82
    s_add_u32 s99, s99, 1
    s_cmp_lt_u32 s99, 2097152
    s_cbranch_scc1 L_qw_81s
    s_branch L_qwr_82
L_qw_83:
    s_mov_b32 s99, 0
L_qw_83s:
    ds_read_b32 v208, v209
    s_waitcnt lgkmcnt(0)
    v_readfirstlane_b32 s74, v208
    s_nop 0
    s_cmp_ge_u32 s74, 13
    s_cbranch_scc1 L_qwr_84
    s_add_u32 s99, s99, 1
    s_cmp_lt_u32 s99, 2097152
    s_cbranch_scc1 L_qw_83s
    s_branch L_qwr_84
L_qw_85:
    s_mov_b32 s99, 0
L_qw_85s:
    ds_read_b32 v208, v209
    s_waitcnt lgkmcnt(0)
    v_readfirstlane_b32 s74, v208
    s_nop 0
    s_cmp_ge_u32 s74, 15
    s_cbranch_scc1 L_qwr_86
    s_add_u32 s99, s99, 1
    s_cmp_lt_u32 s99, 2097152
    s_cbranch_scc1 L_qw_85s
    s_branch L_qwr_86
L_qw_87:
    s_mov_b32 s99, 0
L_qw_87s:
    ds_read_b32 v208, v209
    s_waitcnt lgkmcnt(0)
    v_readfirstlane_b32 s74, v208
    s_nop 0
    s_cmp_ge_u32 s74, 17
    s_cbranch_scc1 L_qwr_88
    s_add_u32 s99, s99, 1
    s_cmp_lt_u32 s99, 2097152
    s_cbranch_scc1 L_qw_87s
    s_branch L_qwr_88
L_qw_89:
    s_mov_b32 s99, 0
L_qw_89s:
    ds_read_b32 v208, v209
    s_waitcnt lgkmcnt(0)
    v_readfirstlane_b32 s74, v208
    s_nop 0
    s_cmp_ge_u32 s74, 18
    s_cbranch_scc1 L_qwr_90
    s_add_u32 s99, s99, 1
    s_cmp_lt_u32 s99, 2097152
    s_cbranch_scc1 L_qw_89s
    s_branch L_qwr_90
L_qw_91:
    s_mov_b32 s99, 0
L_qw_91s:
    ds_read_b32 v208, v209
    s_waitcnt lgkmcnt(0)
    v_readfirstlane_b32 s74, v208
    s_nop 0
    s_cmp_ge_u32 s74, 19
    s_cbranch_scc1 L_qwr_92
    s_add_u32 s99, s99, 1
    s_cmp_lt_u32 s99, 2097152
    s_cbranch_scc1 L_qw_91s
    s_branch L_qwr_92
L_qw_93:
    s_mov_b32 s99, 0
L_qw_93s:
    ds_read_b32 v208, v209
    s_waitcnt lgkmcnt(0)
    v_readfirstlane_b32 s74, v208
    s_nop 0
    s_cmp_ge_u32 s74, 20
    s_cbranch_scc1 L_qwr_94
    s_add_u32 s99, s99, 1
    s_cmp_lt_u32 s99, 2097152
    s_cbranch_scc1 L_qw_93s
    s_branch L_qwr_94
L_qw_96:
    s_mov_b32 s99, 0
L_qw_96s:
    ds_read_b32 v208, v209
    s_waitcnt lgkmcnt(0)
    v_readfirstlane_b32 s74, v208
    s_nop 0
    s_cmp_ge_u32 s74, 3
    s_cbranch_scc1 L_qwr_97
    s_add_u32 s99, s99, 1
    s_cmp_lt_u32 s99, 2097152
    s_cbranch_scc1 L_qw_96s
    s_branch L_qwr_97
L_qw_98:
    s_mov_b32 s99, 0
L_qw_98s:
    ds_read_b32 v208, v209
    s_waitcnt lgkmcnt(0)
    v_readfirstlane_b32 s74, v208
    s_nop 0
    s_cmp_ge_u32 s74, 4
    s_cbranch_scc1 L_qwr_99
    s_add_u32 s99, s99, 1
    s_cmp_lt_u32 s99, 2097152
    s_cbranch_scc1 L_qw_98s
    s_branch L_qwr_99
L_qw_100:
    s_mov_b32 s99, 0
L_qw_100s:
    ds_read_b32 v208, v209
    s_waitcnt lgkmcnt(0)
    v_readfirstlane_b32 s74, v208
    s_nop 0
    s_cmp_ge_u32 s74, 5
    s_cbranch_scc1 L_qwr_101
    s_add_u32 s99, s99, 1
    s_cmp_lt_u32 s99, 2097152
    s_cbranch_scc1 L_qw_100s
    s_branch L_qwr_101
L_qw_103:
    s_mov_b32 s99, 0
L_qw_103s:
    ds_read_b32 v208, v209
    s_waitcnt lgkmcnt(0)
    v_readfirstlane_b32 s74, v208
    s_nop 0
    s_cmp_ge_u32 s74, 6
    s_cbranch_scc1 L_qwr_104
    s_add_u32 s99, s99, 1
    s_cmp_lt_u32 s99, 2097152
    s_cbranch_scc1 L_qw_103s
    s_branch L_qwr_104
L_qw_105:
    s_mov_b32 s99, 0
L_qw_105s:
    ds_read_b32 v208, v209
    s_waitcnt lgkmcnt(0)
    v_readfirstlane_b32 s74, v208
    s_nop 0
    s_cmp_ge_u32 s74, 8
    s_cbranch_scc1 L_qwr_106
    s_add_u32 s99, s99, 1
    s_cmp_lt_u32 s99, 2097152
    s_cbranch_scc1 L_qw_105s
    s_branch L_qwr_106
L_qw_107:
    s_mov_b32 s99, 0
L_qw_107s:
    ds_read_b32 v208, v209
    s_waitcnt lgkmcnt(0)
    v_readfirstlane_b32 s74, v208
    s_nop 0
    s_cmp_ge_u32 s74, 10
    s_cbranch_scc1 L_qwr_108
    s_add_u32 s99, s99, 1
    s_cmp_lt_u32 s99, 2097152
    s_cbranch_scc1 L_qw_107s
    s_branch L_qwr_108
L_qw_110:
    s_mov_b32 s99, 0
L_qw_110s:
    ds_read_b32 v208, v209
    s_waitcnt lgkmcnt(0)
    v_readfirstlane_b32 s74, v208
    s_nop 0
    s_cmp_ge_u32 s74, 11
    s_cbranch_scc1 L_qwr_111
    s_add_u32 s99, s99, 1
    s_cmp_lt_u32 s99, 2097152
    s_cbranch_scc1 L_qw_110s
    s_branch L_qwr_111
L_qw_112:
    s_mov_b32 s99, 0
L_qw_112s:
    ds_read_b32 v208, v209
    s_waitcnt lgkmcnt(0)
    v_readfirstlane_b32 s74, v208
    s_nop 0
    s_cmp_ge_u32 s74, 13
    s_cbranch_scc1 L_qwr_113
    s_add_u32 s99, s99, 1
    s_cmp_lt_u32 s99, 2097152
    s_cbranch_scc1 L_qw_112s
    s_branch L_qwr_113
L_qw_114:
    s_mov_b32 s99, 0
L_qw_114s:
    ds_read_b32 v208, v209
    s_waitcnt lgkmcnt(0)
    v_readfirstlane_b32 s74, v208
    s_nop 0
    s_cmp_ge_u32 s74, 15
    s_cbranch_scc1 L_qwr_115
    s_add_u32 s99, s99, 1
    s_cmp_lt_u32 s99, 2097152
    s_cbranch_scc1 L_qw_114s
    s_branch L_qwr_115
L_qw_116:
    s_mov_b32 s99, 0
L_qw_116s:
    ds_read_b32 v208, v209
    s_waitcnt lgkmcnt(0)
    v_readfirstlane_b32 s74, v208
    s_nop 0
    s_cmp_ge_u32 s74, 17
    s_cbranch_scc1 L_qwr_117
    s_add_u32 s99, s99, 1
    s_cmp_lt_u32 s99, 2097152
    s_cbranch_scc1 L_qw_116s
    s_branch L_qwr_117
L_qw_118:
    s_mov_b32 s99, 0
L_qw_118s:
    ds_read_b32 v208, v209
    s_waitcnt lgkmcnt(0)
    v_readfirstlane_b32 s74, v208
    s_nop 0
    s_cmp_ge_u32 s74, 18
    s_cbranch_scc1 L_qwr_119
    s_add_u32 s99, s99, 1
    s_cmp_lt_u32 s99, 2097152
    s_cbranch_scc1 L_qw_118s
    s_branch L_qwr_119
L_qw_120:
    s_mov_b32 s99, 0
L_qw_120s:
    ds_read_b32 v208, v209
    s_waitcnt lgkmcnt(0)
    v_readfirstlane_b32 s74, v208
    s_nop 0
    s_cmp_ge_u32 s74, 19
    s_cbranch_scc1 L_qwr_121
    s_add_u32 s99, s99, 1
    s_cmp_lt_u32 s99, 2097152
    s_cbranch_scc1 L_qw_120s
    s_branch L_qwr_121
L_qw_122:
    s_mov_b32 s99, 0
L_qw_122s:
    ds_read_b32 v208, v209
    s_waitcnt lgkmcnt(0)
    v_readfirstlane_b32 s74, v208
    s_nop 0
    s_cmp_ge_u32 s74, 20
    s_cbranch_scc1 L_qwr_123
    s_add_u32 s99, s99, 1
    s_cmp_lt_u32 s99, 2097152
    s_cbranch_scc1 L_qw_122s
    s_branch L_qwr_123
L_pre_ld:
    s_waitcnt lgkmcnt(0)
    s_mov_b32 s44, s24
    s_mov_b32 s45, s25
    s_mov_b32 s46, 819200
    s_mov_b32 s47, 0x20000
    s_mov_b32 s56, s36
    s_mov_b32 s57, s37
    s_mov_b32 s58, 256
    s_mov_b32 s59, 0x20000
    s_add_u32 s78, s96, 819200
    s_add_u32 s76, s96, 0
    s_lshr_b32 s74, s2, 6
    s_mul_i32 s74, s74, 204800
    s_add_u32 s76, s76, s74
    s_cmp_ge_u32 s76, s78
    s_cselect_b32 s79, 819200, 0
    s_sub_u32 s76, s76, s79
    s_mov_b32 s77, 81920
    v_mov_b32 v15, 163652
    s_barrier
    v_mov_b32 v12, 163664
    s_mov_b32 s99, 0
L_wxi_126:
    ds_read_b32 v13, v12
    s_waitcnt lgkmcnt(0)
    v_readfirstlane_b32 s74, v13
    s_nop 0
    s_cmp_ge_u32 s74, 3
    s_cbranch_scc1 L_wxid_127
    s_add_u32 s99, s99, 1
    s_cmp_lt_u32 s99, 2097152
    s_cbranch_scc1 L_wxi_126
L_wxid_127:
    s_mov_b32 m0, s77
    s_nop 0
    buffer_load_dwordx4 v4, s[44:47], s76 offen offset:0 lds
    buffer_load_dwordx4 v5, s[44:47], s76 offen offset:1024 lds
    buffer_load_dwordx4 v6, s[44:47], s76 offen offset:2048 lds
    buffer_load_dwordx4 v7, s[44:47], s76 offen offset:3072 lds
    s_add_u32 m0, s77, 4096
    s_nop 0
    buffer_load_dwordx4 v8, s[44:47], s76 offen lds
    s_add_u32 s76, s76, 40960
    s_add_u32 s77, s77, 5120
    s_cmp_ge_u32 s76, s78
    s_cselect_b32 s79, 819200, 0
    s_sub_u32 s76, s76, s79
    s_mov_b32 m0, s77
    s_nop 0
    buffer_load_dwordx4 v4, s[44:47], s76 offen offset:0 lds
    buffer_load_dwordx4 v5, s[44:47], s76 offen offset:1024 lds
    buffer_load_dwordx4 v6, s[44:47], s76 offen offset:2048 lds
    buffer_load_dwordx4 v7, s[44:47], s76 offen offset:3072 lds
    s_add_u32 m0, s77, 4096
    s_nop 0
    buffer_load_dwordx4 v8, s[44:47], s76 offen lds
    s_add_u32 s76, s76, 40960
    s_add_u32 s77, s77, 5120
    s_cmp_ge_u32 s76, s78
    s_cselect_b32 s79, 819200, 0
    s_sub_u32 s76, s76, s79
    s_mov_b32 m0, s77
    s_nop 0
    buffer_load_dwordx4 v4, s[44:47], s76 offen offset:0 lds
    buffer_load_dwordx4 v5, s[44:47], s76 offen offset:1024 lds
    buffer_load_dwordx4 v6, s[44:47], s76 offen offset:2048 lds
    buffer_load_dwordx4 v7, s[44:47], s76 offen offset:3072 lds
    s_add_u32 m0, s77, 4096
    s_nop 0
    buffer_load_dwordx4 v8, s[44:47], s76 offen lds
    s_add_u32 s76, s76, 40960
    s_add_u32 s77, s77, 5120
    s_cmp_ge_u32 s76, s78
    s_cselect_b32 s79, 819200, 0
    s_sub_u32 s76, s76, s79
    s_mov_b32 m0, s77
    s_nop 0
    buffer_load_dwordx4 v4, s[44:47], s76 offen offset:0 lds
    buffer_load_dwordx4 v5, s[44:47], s76 offen offset:1024 lds
    buffer_load_dwordx4 v6, s[44:47], s76 offen offset:2048 lds
    buffer_load_dwordx4 v7, s[44:47], s76 offen offset:3072 lds
    s_add_u32 m0, s77, 4096
    s_nop 0
    buffer_load_dwordx4 v8, s[44:47], s76 offen lds
    s_add_u32 s76, s76, 40960
    s_add_u32 s77, s77, 5120
    s_cmp_ge_u32 s76, s78
    s_cselect_b32 s79, 819200, 0
    s_sub_u32 s76, s76, s79
    s_mov_b32 s77, 128064
    s_mov_b32 m0, s77
    s_nop 0
    buffer_load_dwordx4 v4, s[44:47], s76 offen offset:0 lds
    buffer_load_dwordx4 v5, s[44:47], s76 offen offset:1024 lds
    buffer_load_dwordx4 v6, s[44:47], s76 offen offset:2048 lds
    buffer_load_dwordx4 v7, s[44:47], s76 offen offset:3072 lds
    s_add_u32 m0, s77, 4096
    s_nop 0
    buffer_load_dwordx4 v8, s[44:47], s76 offen lds
    s_add_u32 s76, s76, 40960
    s_add_u32 s77, s77, 5120
    s_cmp_ge_u32 s76, s78
    s_cselect_b32 s79, 819200, 0
    s_sub_u32 s76, s76, s79
    s_mov_b32 m0, s77
    s_nop 0
    buffer_load_dwordx4 v4, s[44:47], s76 offen offset:0 lds
    buffer_load_dwordx4 v5, s[44:47], s76 offen offset:1024 lds
    buffer_load_dwordx4 v6, s[44:47], s76 offen offset:2048 lds
    buffer_load_dwordx4 v7, s[44:47], s76 offen offset:3072 lds
    s_add_u32 m0, s77, 4096
    s_nop 0
    buffer_load_dwordx4 v8, s[44:47], s76 offen lds
    s_add_u32 s76, s76, 40960
    s_add_u32 s77, s77, 5120
    s_cmp_ge_u32 s76, s78
    s_cselect_b32 s79, 819200, 0
    s_sub_u32 s76, s76, s79
    s_and_b32 s70, s65, 1
    s_lshr_b32 s74, s65, 1
    s_mul_i32 s74, s74, 5
    s_mul_i32 s75, s66, 80
    s_add_u32 s74, s74, s75
    s_mul_i32 s75, s70, 3
    s_add_u32 s71, s74, s75
    s_add_u32 s72, s71, 1
    s_add_u32 s73, s74, 2
    s_mul_i32 s88, s64, 3
    s_min_u32 s88, s88, 18
    s_lshl_b32 s88, s88, 10
    s_lshr_b32 s98, s64, 2
    s_lshl_b32 s74, s98, 5
    v_add_u32 v255, s74, v10
    v_mul_u32_u24 v255, 160, v255
    s_mul_i32 s74, s67, 40
    s_add_u32 s74, s74, 128064
    v_add_u32 v255, s74, v255
    v_lshl_add_u32 v254, v11, 4, v255
    s_lshl_b32 s74, s64, 6
    v_add_u32 v12, s74, v1
    v_mul_u32_u24 v13, 13108, v12
    v_lshrrev_b32 v13, 16, v13
    v_mul_u32_u24 v14, 5, v13
    v_sub_u32 v12, v12, v14
    v_min_u32 v12, 3, v12
    v_lshlrev_b32 v12, 4, v12
    v_lshl_add_u32 v244, v13, 6, v12
    v_lshlrev_b32 v12, 3, v10
    v_add_u32 v12, 1024, v12
    v_mov_b32 v13, 1280
    v_cmp_eq_u32 vcc, 0, v11
    s_nop 1
    v_cndmask_b32 v12, v13, v12, vcc
    v_lshlrev_b32 v13, 4, v10
    v_mul_u32_u24 v14, 336, v11
    v_add3_u32 v13, v13, v14, 0
    v_add_u32 v245, 102400, v9
    v_add_u32 v248, 102400, v12
    v_add_u32 v251, 103744, v13
    v_add_u32 v246, 138304, v9
    v_add_u32 v249, 138304, v12
    v_add_u32 v252, 139648, v13
    v_add_u32 v247, 0, v9
    v_add_u32 v250, 0, v12
    v_add_u32 v253, 1344, v13
    s_mov_b32 s90, 0x001fffff
    s_mov_b32 s91, 0x001fffff
    s_mul_i32 s81, s64, 11
    s_lshr_b32 s81, s81, 5
    s_mul_i32 s74, s81, 3
    s_sub_u32 s82, s64, s74
    s_sub_u32 s74, s64, 5
    s_mul_i32 s74, s74, s70
    s_cmp_ge_u32 s64, 6
    s_cselect_b32 s82, s74, s82
    s_cmp_eq_u32 s81, 0
    s_cselect_b32 s83, s71, s73
    s_cmp_eq_u32 s81, 1
    s_cselect_b32 s83, s72, s83
    s_xor_b32 s74, s70, 1
    s_cmp_eq_u32 s64, 7
    s_cselect_b32 s84, s74, 0
    s_mov_b32 s94, -1
    s_mov_b32 s95, 0
    s_mov_b32 s89, 0
    s_mov_b32 s60, s20
    s_mov_b32 s61, s21
    s_mov_b32 s62, 1280
    s_mov_b32 s63, 0x20000
    s_waitcnt vmcnt(20)
    v_mov_b32 v16, 2
    s_mov_b64 exec, 1
    ds_write_b32 v15, v16
    s_mov_b64 exec, -1
    s_waitcnt vmcnt(15)
    v_mov_b32 v16, 3
    s_mov_b64 exec, 1
    ds_write_b32 v15, v16
    s_mov_b64 exec, -1
    v_mov_b32 v12, 163648
    s_mov_b32 s99, 0
L_kd_128:
    ds_read_b32 v13, v12
    s_waitcnt lgkmcnt(0)
    v_readfirstlane_b32 s74, v13
    s_nop 0
    s_cmp_ge_u32 s74, 1
    s_cbranch_scc1 L_kdd_129
    s_add_u32 s99, s99, 1
    s_cmp_lt_u32 s99, 2097152
    s_cbranch_scc1 L_kd_128
L_kdd_129:
    s_mov_b32 s77, 102400
    s_mov_b32 m0, s77
    s_nop 0
    buffer_load_dwordx4 v4, s[44:47], s76 offen offset:0 lds
    buffer_load_dwordx4 v5, s[44:47], s76 offen offset:1024 lds
    buffer_load_dwordx4 v6, s[44:47], s76 offen offset:2048 lds
    buffer_load_dwordx4 v7, s[44:47], s76 offen offset:3072 lds
    s_add_u32 m0, s77, 4096
    s_nop 0
    buffer_load_dwordx4 v8, s[44:47], s76 offen lds
    s_add_u32 s76, s76, 40960
    s_add_u32 s77, s77, 5120
    s_cmp_ge_u32 s76, s78
    s_cselect_b32 s79, 819200, 0
    s_sub_u32 s76, s76, s79
    s_mov_b32 m0, s77
    s_nop 0
    buffer_load_dwordx4 v4, s[44:47], s76 offen offset:0 lds
    buffer_load_dwordx4 v5, s[44:47], s76 offen offset:1024 lds
    buffer_load_dwordx4 v6, s[44:47], s76 offen offset:2048 lds
    buffer_load_dwordx4 v7, s[44:47], s76 offen offset:3072 lds
    s_add_u32 m0, s77, 4096
    s_nop 0
    buffer_load_dwordx4 v8, s[44:47], s76 offen lds
    s_add_u32 s76, s76, 40960
    s_add_u32 s77, s77, 5120
    s_cmp_ge_u32 s76, s78
    s_cselect_b32 s79, 819200, 0
    s_sub_u32 s76, s76, s79
    s_mov_b32 m0, s77
    s_nop 0
    buffer_load_dwordx4 v4, s[44:47], s76 offen offset:0 lds
    buffer_load_dwordx4 v5, s[44:47], s76 offen offset:1024 lds
    buffer_load_dwordx4 v6, s[44:47], s76 offen offset:2048 lds
    buffer_load_dwordx4 v7, s[44:47], s76 offen offset:3072 lds
    s_add_u32 m0, s77, 4096
    s_nop 0
    buffer_load_dwordx4 v8, s[44:47], s76 offen lds
    s_add_u32 s76, s76, 40960
    s_add_u32 s77, s77, 5120
    s_cmp_ge_u32 s76, s78
    s_cselect_b32 s79, 819200, 0
    s_sub_u32 s76, s76, s79
    s_mov_b32 m0, s77
    s_nop 0
    buffer_load_dwordx4 v4, s[44:47], s76 offen offset:0 lds
    buffer_load_dwordx4 v5, s[44:47], s76 offen offset:1024 lds
    buffer_load_dwordx4 v6, s[44:47], s76 offen offset:2048 lds
    buffer_load_dwordx4 v7, s[44:47], s76 offen offset:3072 lds
    s_add_u32 m0, s77, 4096
    s_nop 0
    buffer_load_dwordx4 v8, s[44:47], s76 offen lds
    s_add_u32 s76, s76, 40960
    s_add_u32 s77, s77, 5120
    s_cmp_ge_u32 s76, s78
    s_cselect_b32 s79, 819200, 0
    s_sub_u32 s76, s76, s79
    s_mov_b32 m0, s77
    s_nop 0
    buffer_load_dwordx4 v4, s[44:47], s76 offen offset:0 lds
    buffer_load_dwordx4 v5, s[44:47], s76 offen offset:1024 lds
    buffer_load_dwordx4 v6, s[44:47], s76 offen offset:2048 lds
    buffer_load_dwordx4 v7, s[44:47], s76 offen offset:3072 lds
    s_add_u32 m0, s77, 4096
    s_nop 0
    buffer_load_dwordx4 v8, s[44:47], s76 offen lds
    s_add_u32 s76, s76, 40960
    s_add_u32 s77, s77, 5120
    s_cmp_ge_u32 s76, s78
    s_cselect_b32 s79, 819200, 0
    s_sub_u32 s76, s76, s79
    s_waitcnt vmcnt(35)
    v_mov_b32 v16, 4
    s_mov_b64 exec, 1
    ds_write_b32 v15, v16
    s_mov_b64 exec, -1
    s_waitcnt vmcnt(30)
    v_mov_b32 v16, 5
    s_mov_b64 exec, 1
    ds_write_b32 v15, v16
    s_mov_b64 exec, -1
    s_waitcnt vmcnt(25)
    v_mov_b32 v16, 6
    s_mov_b64 exec, 1
    ds_write_b32 v15, v16
    s_mov_b64 exec, -1
    v_mov_b32 v12, 163660
    s_mov_b32 s99, 0
L_xc_130:
    ds_read_b32 v13, v12
    s_waitcnt lgkmcnt(0)
    v_readfirstlane_b32 s74, v13
    s_nop 0
    s_cmp_ge_u32 s74, 4
    s_cbranch_scc1 L_xcd_131
    s_add_u32 s99, s99, 1
    s_cmp_lt_u32 s99, 2097152
    s_cbranch_scc1 L_xc_130
L_xcd_131:
    s_mov_b32 s77, 0
    s_mov_b32 m0, s77
    s_nop 0
    buffer_load_dwordx4 v4, s[44:47], s76 offen offset:0 lds
    buffer_load_dwordx4 v5, s[44:47], s76 offen offset:1024 lds
    buffer_load_dwordx4 v6, s[44:47], s76 offen offset:2048 lds
    buffer_load_dwordx4 v7, s[44:47], s76 offen offset:3072 lds
    s_add_u32 m0, s77, 4096
    s_nop 0
    buffer_load_dwordx4 v8, s[44:47], s76 offen lds
    s_add_u32 s76, s76, 40960
    s_add_u32 s77, s77, 5120
    s_cmp_ge_u32 s76, s78
    s_cselect_b32 s79, 819200, 0
    s_sub_u32 s76, s76, s79
    s_mov_b32 m0, s77
    s_nop 0
    buffer_load_dwordx4 v4, s[44:47], s76 offen offset:0 lds
    buffer_load_dwordx4 v5, s[44:47], s76 offen offset:1024 lds
    buffer_load_dwordx4 v6, s[44:47], s76 offen offset:2048 lds
    buffer_load_dwordx4 v7, s[44:47], s76 offen offset:3072 lds
    s_add_u32 m0, s77, 4096
    s_nop 0
    buffer_load_dwordx4 v8, s[44:47], s76 offen lds
    s_add_u32 s76, s76, 40960
    s_add_u32 s77, s77, 5120
    s_cmp_ge_u32 s76, s78
    s_cselect_b32 s79, 819200, 0
    s_sub_u32 s76, s76, s79
    s_mov_b32 m0, s77
    s_nop 0
    buffer_load_dwordx4 v4, s[44:47], s76 offen offset:0 lds
    buffer_load_dwordx4 v5, s[44:47], s76 offen offset:1024 lds
    buffer_load_dwordx4 v6, s[44:47], s76 offen offset:2048 lds
    buffer_load_dwordx4 v7, s[44:47], s76 offen offset:3072 lds
    s_add_u32 m0, s77, 4096
    s_nop 0
    buffer_load_dwordx4 v8, s[44:47], s76 offen lds
    s_add_u32 s76, s76, 40960
    s_add_u32 s77, s77, 5120
    s_cmp_ge_u32 s76, s78
    s_cselect_b32 s79, 819200, 0
    s_sub_u32 s76, s76, s79
    s_mov_b32 m0, s77
    s_nop 0
    buffer_load_dwordx4 v4, s[44:47], s76 offen offset:0 lds
    buffer_load_dwordx4 v5, s[44:47], s76 offen offset:1024 lds
    buffer_load_dwordx4 v6, s[44:47], s76 offen offset:2048 lds
    buffer_load_dwordx4 v7, s[44:47], s76 offen offset:3072 lds
    s_add_u32 m0, s77, 4096
    s_nop 0
    buffer_load_dwordx4 v8, s[44:47], s76 offen lds
    s_add_u32 s76, s76, 40960
    s_add_u32 s77, s77, 5120
    s_cmp_ge_u32 s76, s78
    s_cselect_b32 s79, 819200, 0
    s_sub_u32 s76, s76, s79
    s_waitcnt vmcnt(35)
    v_mov_b32 v16, 8
    s_mov_b64 exec, 1
    ds_write_b32 v15, v16
    s_mov_b64 exec, -1
    s_mov_b32 m0, s77
    s_nop 0
    buffer_load_dwordx4 v4, s[44:47], s76 offen offset:0 lds
    buffer_load_dwordx4 v5, s[44:47], s76 offen offset:1024 lds
    buffer_load_dwordx4 v6, s[44:47], s76 offen offset:2048 lds
    buffer_load_dwordx4 v7, s[44:47], s76 offen offset:3072 lds
    s_add_u32 m0, s77, 4096
    s_nop 0
    buffer_load_dwordx4 v8, s[44:47], s76 offen lds
    s_add_u32 s76, s76, 40960
    s_add_u32 s77, s77, 5120
    s_cmp_ge_u32 s76, s78
    s_cselect_b32 s79, 819200, 0
    s_sub_u32 s76, s76, s79
    s_mov_b32 m0, s77
    s_nop 0
    buffer_load_dwordx4 v4, s[44:47], s76 offen offset:0 lds
    buffer_load_dwordx4 v5, s[44:47], s76 offen offset:1024 lds
    buffer_load_dwordx4 v6, s[44:47], s76 offen offset:2048 lds
    buffer_load_dwordx4 v7, s[44:47], s76 offen offset:3072 lds
    s_add_u32 m0, s77, 4096
    s_nop 0
    buffer_load_dwordx4 v8, s[44:47], s76 offen lds
    s_add_u32 s76, s76, 40960
    s_add_u32 s77, s77, 5120
    s_cmp_ge_u32 s76, s78
    s_cselect_b32 s79, 819200, 0
    s_sub_u32 s76, s76, s79
    s_waitcnt vmcnt(35)
    v_mov_b32 v16, 10
    s_mov_b64 exec, 1
    ds_write_b32 v15, v16
    s_mov_b64 exec, -1
    s_waitcnt vmcnt(30)
    v_mov_b32 v16, 11
    s_mov_b64 exec, 1
    ds_write_b32 v15, v16
    s_mov_b64 exec, -1
    s_mov_b32 m0, s77
    s_nop 0
    buffer_load_dwordx4 v4, s[44:47], s76 offen offset:0 lds
    buffer_load_dwordx4 v5, s[44:47], s76 offen offset:1024 lds
    buffer_load_dwordx4 v6, s[44:47], s76 offen offset:2048 lds
    buffer_load_dwordx4 v7, s[44:47], s76 offen offset:3072 lds
    s_add_u32 m0, s77, 4096
    s_nop 0
    buffer_load_dwordx4 v8, s[44:47], s76 offen lds
    s_add_u32 s76, s76, 40960
    s_add_u32 s77, s77, 5120
    s_cmp_ge_u32 s76, s78
    s_cselect_b32 s79, 819200, 0
    s_sub_u32 s76, s76, s79
    s_mov_b32 m0, s77
    s_nop 0
    buffer_load_dwordx4 v4, s[44:47], s76 offen offset:0 lds
    buffer_load_dwordx4 v5, s[44:47], s76 offen offset:1024 lds
    buffer_load_dwordx4 v6, s[44:47], s76 offen offset:2048 lds
    buffer_load_dwordx4 v7, s[44:47], s76 offen offset:3072 lds
    s_add_u32 m0, s77, 4096
    s_nop 0
    buffer_load_dwordx4 v8, s[44:47], s76 offen lds
    s_add_u32 s76, s76, 40960
    s_add_u32 s77, s77, 5120
    s_cmp_ge_u32 s76, s78
    s_cselect_b32 s79, 819200, 0
    s_sub_u32 s76, s76, s79
    s_mov_b32 m0, s77
    s_nop 0
    buffer_load_dwordx4 v4, s[44:47], s76 offen offset:0 lds
    buffer_load_dwordx4 v5, s[44:47], s76 offen offset:1024 lds
    buffer_load_dwordx4 v6, s[44:47], s76 offen offset:2048 lds
    buffer_load_dwordx4 v7, s[44:47], s76 offen offset:3072 lds
    s_add_u32 m0, s77, 4096
    s_nop 0
    buffer_load_dwordx4 v8, s[44:47], s76 offen lds
    s_add_u32 s76, s76, 40960
    s_add_u32 s77, s77, 5120
    s_cmp_ge_u32 s76, s78
    s_cselect_b32 s79, 819200, 0
    s_sub_u32 s76, s76, s79
    s_mov_b32 s44, s30
    s_mov_b32 s45, s31
    s_mov_b32 s46, 819200
    s_mov_b32 s47, 0x20000
    s_waitcnt vmcnt(35)
    v_mov_b32 v16, 13
    s_mov_b64 exec, 1
    ds_write_b32 v15, v16
    s_mov_b64 exec, -1
    s_waitcnt vmcnt(25)
    v_mov_b32 v16, 15
    s_mov_b64 exec, 1
    ds_write_b32 v15, v16
    s_mov_b64 exec, -1
    s_waitcnt vmcnt(15)
    v_mov_b32 v16, 17
    s_mov_b64 exec, 1
    ds_write_b32 v15, v16
    s_mov_b64 exec, -1
    s_waitcnt vmcnt(10)
    v_mov_b32 v16, 18
    s_mov_b64 exec, 1
    ds_write_b32 v15, v16
    s_mov_b64 exec, -1
    s_waitcnt vmcnt(5)
    v_mov_b32 v16, 19
    s_mov_b64 exec, 1
    ds_write_b32 v15, v16
    s_mov_b64 exec, -1
    s_waitcnt vmcnt(0)
    v_mov_b32 v16, 20
    s_mov_b64 exec, 1
    ds_write_b32 v15, v16
    s_mov_b64 exec, -1
    s_mov_b32 s52, s38
    s_mov_b32 s53, s39
    s_mov_b32 s54, 18874368
    s_mov_b32 s55, 0x20000
    s_mov_b32 s56, s36
    s_mov_b32 s57, s37
    s_mov_b32 s58, 256
    s_mov_b32 s59, 0x20000
    s_mov_b32 s40, s4
    s_mov_b32 s41, s5
    s_mov_b32 s42, 2621440
    s_mov_b32 s43, 0x20000
    s_branch L_x1
L_pre_kg:
    s_and_b32 s70, s65, 1
    s_lshr_b32 s74, s65, 1
    s_mul_i32 s74, s74, 5
    s_mul_i32 s75, s66, 80
    s_add_u32 s74, s74, s75
    s_mul_i32 s75, s70, 3
    s_add_u32 s71, s74, s75
    s_add_u32 s72, s71, 1
    s_add_u32 s73, s74, 2
    s_cmp_eq_u32 s64, 0
    s_cselect_b32 s83, s71, s73
    s_cmp_eq_u32 s64, 1
    s_cselect_b32 s83, s72, s83
    s_waitcnt lgkmcnt(0)
    s_lshl_b32 s74, s83, 8
    v_lshlrev_b32 v16, 2, v1
    v_add_u32 v16, s74, v16
    global_load_dword v188, v16, s[6:7]
    global_load_dword v189, v16, s[8:9]
    global_load_dword v190, v16, s[10:11]
    global_load_dword v191, v16, s[12:13]
    global_load_dword v192, v16, s[14:15]
    global_load_dword v193, v16, s[16:17]
    s_lshl_b32 s74, s83, 1
    v_mov_b32 v17, s74
    global_load_ushort v194, v17, s[18:19]
    s_barrier
    s_mul_i32 s78, s64, 8448
    s_add_u32 s78, s78, 138304
    v_lshlrev_b32 v186, 3, v1
    v_add_u32 v186, s78, v186
    v_mul_u32_u24 v187, 528, v3
    v_lshl_add_u32 v187, v2, 4, v187
    v_add_u32 v187, s78, v187
    v_lshlrev_b32 v14, 4, v3
    v_add_u32 v14, s78, v14
    v_add_u32 v14, 16, v14
    v_lshrrev_b32 v12, 1, v2
    v_lshlrev_b32 v12, 8, v12
    v_and_b32 v13, 1, v2
    v_lshl_add_u32 v12, v13, 3, v12
    v_add_u32 v116, v14, v12
    v_cmp_gt_u32 vcc, 2, v2
    v_lshlrev_b32 v12, 8, v2
    v_add_u32 v12, 512, v12
    v_lshlrev_b32 v13, 9, v2
    v_add_u32 v13, 0, v13
    v_cndmask_b32 v12, v13, v12, vcc
    v_add_u32 v117, v14, v12
    v_lshlrev_b32 v12, 8, v2
    v_add_u32 v12, 516, v12
    v_lshlrev_b32 v13, 9, v2
    v_add_u32 v13, 8, v13
    v_cndmask_b32 v12, v13, v12, vcc
    v_add_u32 v118, v14, v12
    v_lshlrev_b32 v12, 8, v2
    v_add_u32 v12, 520, v12
    v_lshlrev_b32 v13, 9, v2
    v_add_u32 v13, 256, v13
    v_cndmask_b32 v12, v13, v12, vcc
    v_add_u32 v119, v14, v12
    v_lshlrev_b32 v12, 8, v2
    v_add_u32 v12, 524, v12
    v_lshlrev_b32 v13, 9, v2
    v_add_u32 v13, 264, v13
    v_cndmask_b32 v12, v13, v12, vcc
    v_add_u32 v120, v14, v12
    v_lshlrev_b32 v12, 10, v2
    v_add_u32 v12, 2048, v12
    v_min_u32 v12, 4352, v12
    v_add_u32 v121, v14, v12
    v_lshlrev_b32 v12, 10, v2
    v_add_u32 v12, 2304, v12
    v_min_u32 v12, 4352, v12
    v_add_u32 v122, v14, v12
    v_lshlrev_b32 v12, 10, v2
    v_add_u32 v12, 2560, v12
    v_min_u32 v12, 4352, v12
    v_add_u32 v123, v14, v12
    v_lshlrev_b32 v12, 10, v2
    v_add_u32 v12, 2816, v12
    v_min_u32 v12, 4352, v12
    v_add_u32 v124, v14, v12
    s_add_u32 s79, s78, 16
    v_lshlrev_b32 v12, 1, v1
    v_sub_u32 v14, 127, v12
    v_lshlrev_b32 v125, 1, v14
    v_add_u32 v125, s79, v125
    v_bfe_u32 v12, v14, 1, 1
    v_add3_u32 v12, v14, v12, 0
    v_and_b32 v12, 4294967294, v12
    v_lshlrev_b32 v128, 1, v12
    v_add_u32 v128, s79, v128
    v_bfe_u32 v12, v14, 2, 1
    v_add3_u32 v12, v14, v12, 1
    v_and_b32 v12, 4294967292, v12
    v_lshlrev_b32 v131, 1, v12
    v_add_u32 v131, s79, v131
    v_bfe_u32 v12, v14, 3, 1
    v_add3_u32 v12, v14, v12, 3
    v_and_b32 v12, 4294967288, v12
    v_lshlrev_b32 v134, 1, v12
    v_add_u32 v134, s79, v134
    v_lshlrev_b32 v12, 1, v1
    v_sub_u32 v14, 126, v12
    v_lshlrev_b32 v126, 1, v14
    v_add_u32 v126, s79, v126
    v_bfe_u32 v12, v14, 1, 1
    v_add3_u32 v12, v14, v12, 0
    v_and_b32 v12, 4294967294, v12
    v_lshlrev_b32 v129, 1, v12
    v_add_u32 v129, s79, v129
    v_bfe_u32 v12, v14, 2, 1
    v_add3_u32 v12, v14, v12, 1
    v_and_b32 v12, 4294967292, v12
    v_lshlrev_b32 v132, 1, v12
    v_add_u32 v132, s79, v132
    v_bfe_u32 v12, v14, 3, 1
    v_add3_u32 v12, v14, v12, 3
    v_and_b32 v12, 4294967288, v12
    v_lshlrev_b32 v135, 1, v12
    v_add_u32 v135, s79, v135
    v_lshlrev_b32 v12, 1, v1
    v_sub_u32 v14, 125, v12
    v_lshlrev_b32 v127, 1, v14
    v_add_u32 v127, s79, v127
    v_bfe_u32 v12, v14, 1, 1
    v_add3_u32 v12, v14, v12, 0
    v_and_b32 v12, 4294967294, v12
    v_lshlrev_b32 v130, 1, v12
    v_add_u32 v130, s79, v130
    v_bfe_u32 v12, v14, 2, 1
    v_add3_u32 v12, v14, v12, 1
    v_and_b32 v12, 4294967292, v12
    v_lshlrev_b32 v133, 1, v12
    v_add_u32 v133, s79, v133
    v_bfe_u32 v12, v14, 3, 1
    v_add3_u32 v12, v14, v12, 3
    v_and_b32 v12, 4294967288, v12
    v_lshlrev_b32 v136, 1, v12
    v_add_u32 v136, s79, v136
    v_cmp_eq_u32 vcc, 63, v1
    s_nop 1
    v_cndmask_b32 v137, v130, v127, vcc
    s_mov_b32 s40, s4
    s_mov_b32 s41, s5
    s_mov_b32 s42, 2621440
    s_mov_b32 s43, 0x20000
    s_mov_b32 s52, s38
    s_mov_b32 s53, s39
    s_mov_b32 s54, 18874368
    s_mov_b32 s55, 0x20000
    s_mov_b32 s56, s36
    s_mov_b32 s57, s37
    s_mov_b32 s58, 256
    s_mov_b32 s59, 0x20000
    s_waitcnt vmcnt(0)
    s_setprio 2
    v_lshlrev_b32 v196, 16, v188
    v_and_b32 v197, 0xffff0000, v188
    v_lshlrev_b32 v198, 16, v189
    v_and_b32 v199, 0xffff0000, v189
    v_lshlrev_b32 v200, 16, v190
    v_and_b32 v201, 0xffff0000, v190
    v_lshlrev_b32 v202, 16, v191
    v_and_b32 v203, 0xffff0000, v191
    v_lshlrev_b32 v204, 16, v192
    v_and_b32 v205, 0xffff0000, v192
    v_lshlrev_b32 v206, 16, v193
    v_and_b32 v207, 0xffff0000, v193
    v_lshlrev_b32 v194, 16, v194
    v_mul_f32 v194, 0x3fb8aa3b, v194
    v_exp_f32 v194, v194
    s_nop 0
    v_cvt_pk_bf16_f32 v194, v194, v194
    v_lshlrev_b32 v194, 16, v194
    v_mul_f32 v138, v194, v196
    v_mul_f32 v139, v194, v198
    v_mul_f32 v212, v194, v200
    v_mul_f32 v213, v194, v202
    v_mov_b32 v216, v204
    v_mov_b32 v217, v206
    v_mul_f32 v140, v194, v197
    v_mul_f32 v141, v194, v199
    v_mul_f32 v214, v194, v201
    v_mul_f32 v215, v194, v203
    v_mov_b32 v218, v205
    v_mov_b32 v219, v207
    v_mul_f32 v138, 0x3fb8aa3b, v138
    v_mul_f32 v139, 0x3e22f983, v139
    v_mul_f32 v140, 0x3fb8aa3b, v140
    v_mul_f32 v141, 0x3e22f983, v141
    v_pk_mul_f32 v[158:159], v[216:217], v[212:213] op_sel:[0,0] op_sel_hi:[0,1]
    v_pk_mul_f32 v[160:161], v[218:219], v[214:215] op_sel:[0,0] op_sel_hi:[0,1]
    v_pk_fma_f32 v[158:159], v[216:217], v[212:213], v[158:159] op_sel:[1,1,0] op_sel_hi:[1,0,1] neg_lo:[0,1,0]
    v_pk_fma_f32 v[160:161], v[218:219], v[214:215], v[160:161] op_sel:[1,1,0] op_sel_hi:[1,0,1] neg_lo:[0,1,0]
    v_mul_f32 v188, 0x41000000, v138
    v_mul_f32 v189, 0x41000000, v139
    v_mul_f32 v190, 0x41000000, v140
    v_mul_f32 v191, 0x41000000, v141
    v_mul_f32 v192, 0x41800000, v138
    v_mul_f32 v193, 0x41800000, v139
    v_mul_f32 v194, 0x41800000, v140
    v_mul_f32 v195, 0x41800000, v141
    v_mul_f32 v196, 0x3f800000, v138
    v_mul_f32 v197, 0x3f800000, v139
    v_mul_f32 v198, 0x3f800000, v140
    v_mul_f32 v199, 0x3f800000, v141
    v_mul_f32 v200, 0x43000000, v138
    v_mul_f32 v201, 0x43000000, v139
    v_mul_f32 v202, 0x43000000, v140
    v_mul_f32 v203, 0x43000000, v141
    v_exp_f32 v188, v188
    v_fract_f32 v189, v189
    v_exp_f32 v190, v190
    v_fract_f32 v191, v191
    v_exp_f32 v192, v192
    v_fract_f32 v193, v193
    v_exp_f32 v194, v194
    v_fract_f32 v195, v195
    v_exp_f32 v196, v196
    v_fract_f32 v197, v197
    v_exp_f32 v198, v198
    v_fract_f32 v199, v199
    v_exp_f32 v200, v200
    v_fract_f32 v201, v201
    v_exp_f32 v202, v202
    v_fract_f32 v203, v203
    v_cos_f32 v146, v189
    v_sin_f32 v147, v189
    v_cos_f32 v148, v191
    v_sin_f32 v149, v191
    v_cos_f32 v154, v193
    v_sin_f32 v155, v193
    v_cos_f32 v156, v195
    v_sin_f32 v157, v195
    v_cos_f32 v142, v197
    v_sin_f32 v143, v197
    v_cos_f32 v144, v199
    v_sin_f32 v145, v199
    v_cos_f32 v150, v201
    v_sin_f32 v151, v201
    v_cos_f32 v152, v203
    v_sin_f32 v153, v203
    v_mul_f32 v146, v188, v146
    v_mul_f32 v147, v188, v147
    v_mul_f32 v148, v190, v148
    v_mul_f32 v149, v190, v149
    v_mul_f32 v154, v192, v154
    v_mul_f32 v155, v192, v155
    v_mul_f32 v156, v194, v156
    v_mul_f32 v157, v194, v157
    v_mul_f32 v142, v196, v142
    v_mul_f32 v143, v196, v143
    v_mul_f32 v144, v198, v144
    v_mul_f32 v145, v198, v145
    v_mul_f32 v150, v200, v150
    v_mul_f32 v151, v200, v151
    v_mul_f32 v152, v202, v152
    v_mul_f32 v153, v202, v153
    v_mov_b32 v188, 1.0
    v_mov_b32 v189, 0
    v_mov_b32 v192, v146
    v_mov_b32 v193, v147
    v_mov_b32 v190, 1.0
    v_mov_b32 v191, 0
    v_mov_b32 v194, v148
    v_mov_b32 v195, v149
    v_pk_mul_f32 v[196:197], v[188:189], v[154:155] op_sel:[0,0] op_sel_hi:[0,1]
    v_pk_mul_f32 v[198:199], v[190:191], v[156:157] op_sel:[0,0] op_sel_hi:[0,1]
    v_pk_mul_f32 v[200:201], v[192:193], v[154:155] op_sel:[0,0] op_sel_hi:[0,1]
    v_pk_mul_f32 v[202:203], v[194:195], v[156:157] op_sel:[0,0] op_sel_hi:[0,1]
    v_pk_fma_f32 v[196:197], v[188:189], v[154:155], v[196:197] op_sel:[1,1,0] op_sel_hi:[1,0,1] neg_lo:[0,1,0]
    v_pk_fma_f32 v[198:199], v[190:191], v[156:157], v[198:199] op_sel:[1,1,0] op_sel_hi:[1,0,1] neg_lo:[0,1,0]
    v_pk_fma_f32 v[200:201], v[192:193], v[154:155], v[200:201] op_sel:[1,1,0] op_sel_hi:[1,0,1] neg_lo:[0,1,0]
    v_pk_fma_f32 v[202:203], v[194:195], v[156:157], v[202:203] op_sel:[1,1,0] op_sel_hi:[1,0,1] neg_lo:[0,1,0]
    v_cvt_pk_bf16_f32 v212, v188, v189
    v_cvt_pk_bf16_f32 v213, v190, v191
    v_cvt_pk_bf16_f32 v214, v192, v193
    v_cvt_pk_bf16_f32 v215, v194, v195
    v_cvt_pk_bf16_f32 v216, v196, v197
    v_cvt_pk_bf16_f32 v217, v198, v199
    v_cvt_pk_bf16_f32 v218, v200, v201
    v_cvt_pk_bf16_f32 v219, v202, v203
    v_pk_mul_f32 v[188:189], v[196:197], v[154:155] op_sel:[0,0] op_sel_hi:[0,1]
    v_pk_mul_f32 v[190:191], v[198:199], v[156:157] op_sel:[0,0] op_sel_hi:[0,1]
    v_pk_mul_f32 v[192:193], v[200:201], v[154:155] op_sel:[0,0] op_sel_hi:[0,1]
    v_pk_mul_f32 v[194:195], v[202:203], v[156:157] op_sel:[0,0] op_sel_hi:[0,1]
    v_pk_fma_f32 v[188:189], v[196:197], v[154:155], v[188:189] op_sel:[1,1,0] op_sel_hi:[1,0,1] neg_lo:[0,1,0]
    v_pk_fma_f32 v[190:191], v[198:199], v[156:157], v[190:191] op_sel:[1,1,0] op_sel_hi:[1,0,1] neg_lo:[0,1,0]
    v_pk_fma_f32 v[192:193], v[200:201], v[154:155], v[192:193] op_sel:[1,1,0] op_sel_hi:[1,0,1] neg_lo:[0,1,0]
    v_pk_fma_f32 v[194:195], v[202:203], v[156:157], v[194:195] op_sel:[1,1,0] op_sel_hi:[1,0,1] neg_lo:[0,1,0]
    ds_write_b64 v186, v[212:213] offset:0
    ds_write_b64 v186, v[214:215] offset:528
    ds_write_b64 v186, v[216:217] offset:1056
    ds_write_b64 v186, v[218:219] offset:1584
    v_pk_mul_f32 v[162:163], v[142:143], v[142:143] op_sel:[0,0] op_sel_hi:[0,1]
    v_pk_mul_f32 v[164:165], v[144:145], v[144:145] op_sel:[0,0] op_sel_hi:[0,1]
    v_pk_fma_f32 v[162:163], v[142:143], v[142:143], v[162:163] op_sel:[1,1,0] op_sel_hi:[1,0,1] neg_lo:[0,1,0]
    v_pk_fma_f32 v[164:165], v[144:145], v[144:145], v[164:165] op_sel:[1,1,0] op_sel_hi:[1,0,1] neg_lo:[0,1,0]
    v_pk_mul_f32 v[196:197], v[188:189], v[154:155] op_sel:[0,0] op_sel_hi:[0,1]
    v_pk_mul_f32 v[198:199], v[190:191], v[156:157] op_sel:[0,0] op_sel_hi:[0,1]
    v_pk_mul_f32 v[200:201], v[192:193], v[154:155] op_sel:[0,0] op_sel_hi:[0,1]
    v_pk_mul_f32 v[202:203], v[194:195], v[156:157] op_sel:[0,0] op_sel_hi:[0,1]
    v_pk_fma_f32 v[196:197], v[188:189], v[154:155], v[196:197] op_sel:[1,1,0] op_sel_hi:[1,0,1] neg_lo:[0,1,0]
    v_pk_fma_f32 v[198:199], v[190:191], v[156:157], v[198:199] op_sel:[1,1,0] op_sel_hi:[1,0,1] neg_lo:[0,1,0]
    v_pk_fma_f32 v[200:201], v[192:193], v[154:155], v[200:201] op_sel:[1,1,0] op_sel_hi:[1,0,1] neg_lo:[0,1,0]
    v_pk_fma_f32 v[202:203], v[194:195], v[156:157], v[202:203] op_sel:[1,1,0] op_sel_hi:[1,0,1] neg_lo:[0,1,0]
    v_cvt_pk_bf16_f32 v212, v188, v189
    v_cvt_pk_bf16_f32 v213, v190, v191
    v_cvt_pk_bf16_f32 v214, v192, v193
    v_cvt_pk_bf16_f32 v215, v194, v195
    v_cvt_pk_bf16_f32 v216, v196, v197
    v_cvt_pk_bf16_f32 v217, v198, v199
    v_cvt_pk_bf16_f32 v218, v200, v201
    v_cvt_pk_bf16_f32 v219, v202, v203
    v_pk_mul_f32 v[188:189], v[196:197], v[154:155] op_sel:[0,0] op_sel_hi:[0,1]
    v_pk_mul_f32 v[190:191], v[198:199], v[156:157] op_sel:[0,0] op_sel_hi:[0,1]
    v_pk_mul_f32 v[192:193], v[200:201], v[154:155] op_sel:[0,0] op_sel_hi:[0,1]
    v_pk_mul_f32 v[194:195], v[202:203], v[156:157] op_sel:[0,0] op_sel_hi:[0,1]
    v_pk_fma_f32 v[188:189], v[196:197], v[154:155], v[188:189] op_sel:[1,1,0] op_sel_hi:[1,0,1] neg_lo:[0,1,0]
    v_pk_fma_f32 v[190:191], v[198:199], v[156:157], v[190:191] op_sel:[1,1,0] op_sel_hi:[1,0,1] neg_lo:[0,1,0]
    v_pk_fma_f32 v[192:193], v[200:201], v[154:155], v[192:193] op_sel:[1,1,0] op_sel_hi:[1,0,1] neg_lo:[0,1,0]
    v_pk_fma_f32 v[194:195], v[202:203], v[156:157], v[194:195] op_sel:[1,1,0] op_sel_hi:[1,0,1] neg_lo:[0,1,0]
    ds_write_b64 v186, v[212:213] offset:2112
    ds_write_b64 v186, v[214:215] offset:2640
    ds_write_b64 v186, v[216:217] offset:3168
    ds_write_b64 v186, v[218:219] offset:3696
    v_pk_mul_f32 v[166:167], v[162:163], v[142:143] op_sel:[0,0] op_sel_hi:[0,1]
    v_pk_mul_f32 v[168:169], v[164:165], v[144:145] op_sel:[0,0] op_sel_hi:[0,1]
    v_pk_mul_f32 v[170:171], v[162:163], v[162:163] op_sel:[0,0] op_sel_hi:[0,1]
    v_pk_mul_f32 v[172:173], v[164:165], v[164:165] op_sel:[0,0] op_sel_hi:[0,1]
    v_pk_fma_f32 v[166:167], v[162:163], v[142:143], v[166:167] op_sel:[1,1,0] op_sel_hi:[1,0,1] neg_lo:[0,1,0]
    v_pk_fma_f32 v[168:169], v[164:165], v[144:145], v[168:169] op_sel:[1,1,0] op_sel_hi:[1,0,1] neg_lo:[0,1,0]
    v_pk_fma_f32 v[170:171], v[162:163], v[162:163], v[170:171] op_sel:[1,1,0] op_sel_hi:[1,0,1] neg_lo:[0,1,0]
    v_pk_fma_f32 v[172:173], v[164:165], v[164:165], v[172:173] op_sel:[1,1,0] op_sel_hi:[1,0,1] neg_lo:[0,1,0]
    v_pk_mul_f32 v[196:197], v[188:189], v[154:155] op_sel:[0,0] op_sel_hi:[0,1]
    v_pk_mul_f32 v[198:199], v[190:191], v[156:157] op_sel:[0,0] op_sel_hi:[0,1]
    v_pk_mul_f32 v[200:201], v[192:193], v[154:155] op_sel:[0,0] op_sel_hi:[0,1]
    v_pk_mul_f32 v[202:203], v[194:195], v[156:157] op_sel:[0,0] op_sel_hi:[0,1]
    v_pk_fma_f32 v[196:197], v[188:189], v[154:155], v[196:197] op_sel:[1,1,0] op_sel_hi:[1,0,1] neg_lo:[0,1,0]
    v_pk_fma_f32 v[198:199], v[190:191], v[156:157], v[198:199] op_sel:[1,1,0] op_sel_hi:[1,0,1] neg_lo:[0,1,0]
    v_pk_fma_f32 v[200:201], v[192:193], v[154:155], v[200:201] op_sel:[1,1,0] op_sel_hi:[1,0,1] neg_lo:[0,1,0]
    v_pk_fma_f32 v[202:203], v[194:195], v[156:157], v[202:203] op_sel:[1,1,0] op_sel_hi:[1,0,1] neg_lo:[0,1,0]
    v_cvt_pk_bf16_f32 v212, v188, v189
    v_cvt_pk_bf16_f32 v213, v190, v191
    v_cvt_pk_bf16_f32 v214, v192, v193
    v_cvt_pk_bf16_f32 v215, v194, v195
    v_cvt_pk_bf16_f32 v216, v196, v197
    v_cvt_pk_bf16_f32 v217, v198, v199
    v_cvt_pk_bf16_f32 v218, v200, v201
    v_cvt_pk_bf16_f32 v219, v202, v203
    v_pk_mul_f32 v[188:189], v[196:197], v[154:155] op_sel:[0,0] op_sel_hi:[0,1]
    v_pk_mul_f32 v[190:191], v[198:199], v[156:157] op_sel:[0,0] op_sel_hi:[0,1]
    v_pk_mul_f32 v[192:193], v[200:201], v[154:155] op_sel:[0,0] op_sel_hi:[0,1]
    v_pk_mul_f32 v[194:195], v[202:203], v[156:157] op_sel:[0,0] op_sel_hi:[0,1]
    v_pk_fma_f32 v[188:189], v[196:197], v[154:155], v[188:189] op_sel:[1,1,0] op_sel_hi:[1,0,1] neg_lo:[0,1,0]
    v_pk_fma_f32 v[190:191], v[198:199], v[156:157], v[190:191] op_sel:[1,1,0] op_sel_hi:[1,0,1] neg_lo:[0,1,0]
    v_pk_fma_f32 v[192:193], v[200:201], v[154:155], v[192:193] op_sel:[1,1,0] op_sel_hi:[1,0,1] neg_lo:[0,1,0]
    v_pk_fma_f32 v[194:195], v[202:203], v[156:157], v[194:195] op_sel:[1,1,0] op_sel_hi:[1,0,1] neg_lo:[0,1,0]
    ds_write_b64 v186, v[212:213] offset:4224
    ds_write_b64 v186, v[214:215] offset:4752
    ds_write_b64 v186, v[216:217] offset:5280
    ds_write_b64 v186, v[218:219] offset:5808
    v_pk_mul_f32 v[174:175], v[170:171], v[142:143] op_sel:[0,0] op_sel_hi:[0,1]
    v_pk_mul_f32 v[176:177], v[172:173], v[144:145] op_sel:[0,0] op_sel_hi:[0,1]
    v_pk_mul_f32 v[178:179], v[170:171], v[162:163] op_sel:[0,0] op_sel_hi:[0,1]
    v_pk_mul_f32 v[180:181], v[172:173], v[164:165] op_sel:[0,0] op_sel_hi:[0,1]
    v_pk_mul_f32 v[182:183], v[170:171], v[166:167] op_sel:[0,0] op_sel_hi:[0,1]
    v_pk_mul_f32 v[184:185], v[172:173], v[168:169] op_sel:[0,0] op_sel_hi:[0,1]
    v_pk_fma_f32 v[174:175], v[170:171], v[142:143], v[174:175] op_sel:[1,1,0] op_sel_hi:[1,0,1] neg_lo:[0,1,0]
    v_pk_fma_f32 v[176:177], v[172:173], v[144:145], v[176:177] op_sel:[1,1,0] op_sel_hi:[1,0,1] neg_lo:[0,1,0]
    v_pk_fma_f32 v[178:179], v[170:171], v[162:163], v[178:179] op_sel:[1,1,0] op_sel_hi:[1,0,1] neg_lo:[0,1,0]
    v_pk_fma_f32 v[180:181], v[172:173], v[164:165], v[180:181] op_sel:[1,1,0] op_sel_hi:[1,0,1] neg_lo:[0,1,0]
    v_pk_fma_f32 v[182:183], v[170:171], v[166:167], v[182:183] op_sel:[1,1,0] op_sel_hi:[1,0,1] neg_lo:[0,1,0]
    v_pk_fma_f32 v[184:185], v[172:173], v[168:169], v[184:185] op_sel:[1,1,0] op_sel_hi:[1,0,1] neg_lo:[0,1,0]
    v_pk_mul_f32 v[196:197], v[188:189], v[154:155] op_sel:[0,0] op_sel_hi:[0,1]
    v_pk_mul_f32 v[198:199], v[190:191], v[156:157] op_sel:[0,0] op_sel_hi:[0,1]
    v_pk_mul_f32 v[200:201], v[192:193], v[154:155] op_sel:[0,0] op_sel_hi:[0,1]
    v_pk_mul_f32 v[202:203], v[194:195], v[156:157] op_sel:[0,0] op_sel_hi:[0,1]
    v_pk_fma_f32 v[196:197], v[188:189], v[154:155], v[196:197] op_sel:[1,1,0] op_sel_hi:[1,0,1] neg_lo:[0,1,0]
    v_pk_fma_f32 v[198:199], v[190:191], v[156:157], v[198:199] op_sel:[1,1,0] op_sel_hi:[1,0,1] neg_lo:[0,1,0]
    v_pk_fma_f32 v[200:201], v[192:193], v[154:155], v[200:201] op_sel:[1,1,0] op_sel_hi:[1,0,1] neg_lo:[0,1,0]
    v_pk_fma_f32 v[202:203], v[194:195], v[156:157], v[202:203] op_sel:[1,1,0] op_sel_hi:[1,0,1] neg_lo:[0,1,0]
    v_cvt_pk_bf16_f32 v212, v188, v189
    v_cvt_pk_bf16_f32 v213, v190, v191
    v_cvt_pk_bf16_f32 v214, v192, v193
    v_cvt_pk_bf16_f32 v215, v194, v195
    v_cvt_pk_bf16_f32 v216, v196, v197
    v_cvt_pk_bf16_f32 v217, v198, v199
    v_cvt_pk_bf16_f32 v218, v200, v201
    v_cvt_pk_bf16_f32 v219, v202, v203
    ds_write_b64 v186, v[212:213] offset:6336
    ds_write_b64 v186, v[214:215] offset:6864
    ds_write_b64 v186, v[216:217] offset:7392
    ds_write_b64 v186, v[218:219] offset:7920
    s_waitcnt lgkmcnt(0)
    ds_read_b128 v[224:227], v187 offset:0
    ds_read_b128 v[228:231], v187 offset:64
    ds_read_b128 v[232:235], v187 offset:128
    ds_read_b128 v[236:239], v187 offset:192
    ds_read_b128 v[240:243], v187 offset:256
    ds_read_b128 v[244:247], v187 offset:320
    ds_read_b128 v[248:251], v187 offset:384
    ds_read_b128 v[252:255], v187 offset:448
    v_pk_mul_f32 v[192:193], v[158:159], v[142:143] op_sel:[0,0] op_sel_hi:[0,1]
    v_pk_mul_f32 v[194:195], v[160:161], v[144:145] op_sel:[0,0] op_sel_hi:[0,1]
    v_pk_mul_f32 v[196:197], v[158:159], v[162:163] op_sel:[0,0] op_sel_hi:[0,1]
    v_pk_mul_f32 v[198:199], v[160:161], v[164:165] op_sel:[0,0] op_sel_hi:[0,1]
    v_pk_mul_f32 v[200:201], v[158:159], v[166:167] op_sel:[0,0] op_sel_hi:[0,1]
    v_pk_mul_f32 v[202:203], v[160:161], v[168:169] op_sel:[0,0] op_sel_hi:[0,1]
    v_pk_fma_f32 v[192:193], v[158:159], v[142:143], v[192:193] op_sel:[1,1,0] op_sel_hi:[1,0,1] neg_lo:[0,1,0]
    v_pk_fma_f32 v[194:195], v[160:161], v[144:145], v[194:195] op_sel:[1,1,0] op_sel_hi:[1,0,1] neg_lo:[0,1,0]
    v_pk_fma_f32 v[196:197], v[158:159], v[162:163], v[196:197] op_sel:[1,1,0] op_sel_hi:[1,0,1] neg_lo:[0,1,0]
    v_pk_fma_f32 v[198:199], v[160:161], v[164:165], v[198:199] op_sel:[1,1,0] op_sel_hi:[1,0,1] neg_lo:[0,1,0]
    v_pk_fma_f32 v[200:201], v[158:159], v[166:167], v[200:201] op_sel:[1,1,0] op_sel_hi:[1,0,1] neg_lo:[0,1,0]
    v_pk_fma_f32 v[202:203], v[160:161], v[168:169], v[202:203] op_sel:[1,1,0] op_sel_hi:[1,0,1] neg_lo:[0,1,0]
    v_cvt_pk_bf16_f32 v212, v158, -v159
    v_cvt_pk_bf16_f32 v213, v160, -v161
    v_cvt_pk_bf16_f32 v214, v192, -v193
    v_cvt_pk_bf16_f32 v215, v194, -v195
    v_cvt_pk_bf16_f32 v216, v196, -v197
    v_cvt_pk_bf16_f32 v217, v198, -v199
    v_cvt_pk_bf16_f32 v218, v200, -v201
    v_cvt_pk_bf16_f32 v219, v202, -v203
    s_waitcnt lgkmcnt(0)
    ds_write_b64 v186, v[212:213] offset:0
    ds_write_b64 v186, v[214:215] offset:528
    ds_write_b64 v186, v[216:217] offset:1056
    ds_write_b64 v186, v[218:219] offset:1584
    v_pk_mul_f32 v[188:189], v[158:159], v[170:171] op_sel:[0,0] op_sel_hi:[0,1]
    v_pk_mul_f32 v[190:191], v[160:161], v[172:173] op_sel:[0,0] op_sel_hi:[0,1]
    v_pk_mul_f32 v[192:193], v[158:159], v[174:175] op_sel:[0,0] op_sel_hi:[0,1]
    v_pk_mul_f32 v[194:195], v[160:161], v[176:177] op_sel:[0,0] op_sel_hi:[0,1]
    v_pk_mul_f32 v[196:197], v[158:159], v[178:179] op_sel:[0,0] op_sel_hi:[0,1]
    v_pk_mul_f32 v[198:199], v[160:161], v[180:181] op_sel:[0,0] op_sel_hi:[0,1]
    v_pk_mul_f32 v[200:201], v[158:159], v[182:183] op_sel:[0,0] op_sel_hi:[0,1]
    v_pk_mul_f32 v[202:203], v[160:161], v[184:185] op_sel:[0,0] op_sel_hi:[0,1]
    v_pk_fma_f32 v[188:189], v[158:159], v[170:171], v[188:189] op_sel:[1,1,0] op_sel_hi:[1,0,1] neg_lo:[0,1,0]
    v_pk_fma_f32 v[190:191], v[160:161], v[172:173], v[190:191] op_sel:[1,1,0] op_sel_hi:[1,0,1] neg_lo:[0,1,0]
    v_pk_fma_f32 v[192:193], v[158:159], v[174:175], v[192:193] op_sel:[1,1,0] op_sel_hi:[1,0,1] neg_lo:[0,1,0]
    v_pk_fma_f32 v[194:195], v[160:161], v[176:177], v[194:195] op_sel:[1,1,0] op_sel_hi:[1,0,1] neg_lo:[0,1,0]
    v_pk_fma_f32 v[196:197], v[158:159], v[178:179], v[196:197] op_sel:[1,1,0] op_sel_hi:[1,0,1] neg_lo:[0,1,0]
    v_pk_fma_f32 v[198:199], v[160:161], v[180:181], v[198:199] op_sel:[1,1,0] op_sel_hi:[1,0,1] neg_lo:[0,1,0]
    v_pk_fma_f32 v[200:201], v[158:159], v[182:183], v[200:201] op_sel:[1,1,0] op_sel_hi:[1,0,1] neg_lo:[0,1,0]
    v_pk_fma_f32 v[202:203], v[160:161], v[184:185], v[202:203] op_sel:[1,1,0] op_sel_hi:[1,0,1] neg_lo:[0,1,0]
    v_cvt_pk_bf16_f32 v212, v188, -v189
    v_cvt_pk_bf16_f32 v213, v190, -v191
    v_cvt_pk_bf16_f32 v214, v192, -v193
    v_cvt_pk_bf16_f32 v215, v194, -v195
    v_cvt_pk_bf16_f32 v216, v196, -v197
    v_cvt_pk_bf16_f32 v217, v198, -v199
    v_cvt_pk_bf16_f32 v218, v200, -v201
    v_cvt_pk_bf16_f32 v219, v202, -v203
    ds_write_b64 v186, v[212:213] offset:2112
    ds_write_b64 v186, v[214:215] offset:2640
    ds_write_b64 v186, v[216:217] offset:3168
    ds_write_b64 v186, v[218:219] offset:3696
    v_pk_mul_f32 v[204:205], v[158:159], v[150:151] op_sel:[0,0] op_sel_hi:[0,1]
    v_pk_mul_f32 v[206:207], v[160:161], v[152:153] op_sel:[0,0] op_sel_hi:[0,1]
    v_pk_fma_f32 v[204:205], v[158:159], v[150:151], v[204:205] op_sel:[1,1,0] op_sel_hi:[1,0,1] neg_lo:[0,1,0]
    v_pk_fma_f32 v[206:207], v[160:161], v[152:153], v[206:207] op_sel:[1,1,0] op_sel_hi:[1,0,1] neg_lo:[0,1,0]
    v_pk_mul_f32 v[192:193], v[204:205], v[142:143] op_sel:[0,0] op_sel_hi:[0,1]
    v_pk_mul_f32 v[194:195], v[206:207], v[144:145] op_sel:[0,0] op_sel_hi:[0,1]
    v_pk_mul_f32 v[196:197], v[204:205], v[162:163] op_sel:[0,0] op_sel_hi:[0,1]
    v_pk_mul_f32 v[198:199], v[206:207], v[164:165] op_sel:[0,0] op_sel_hi:[0,1]
    v_pk_mul_f32 v[200:201], v[204:205], v[166:167] op_sel:[0,0] op_sel_hi:[0,1]
    v_pk_mul_f32 v[202:203], v[206:207], v[168:169] op_sel:[0,0] op_sel_hi:[0,1]
    v_pk_fma_f32 v[192:193], v[204:205], v[142:143], v[192:193] op_sel:[1,1,0] op_sel_hi:[1,0,1] neg_lo:[0,1,0]
    v_pk_fma_f32 v[194:195], v[206:207], v[144:145], v[194:195] op_sel:[1,1,0] op_sel_hi:[1,0,1] neg_lo:[0,1,0]
    v_pk_fma_f32 v[196:197], v[204:205], v[162:163], v[196:197] op_sel:[1,1,0] op_sel_hi:[1,0,1] neg_lo:[0,1,0]
    v_pk_fma_f32 v[198:199], v[206:207], v[164:165], v[198:199] op_sel:[1,1,0] op_sel_hi:[1,0,1] neg_lo:[0,1,0]
    v_pk_fma_f32 v[200:201], v[204:205], v[166:167], v[200:201] op_sel:[1,1,0] op_sel_hi:[1,0,1] neg_lo:[0,1,0]
    v_pk_fma_f32 v[202:203], v[206:207], v[168:169], v[202:203] op_sel:[1,1,0] op_sel_hi:[1,0,1] neg_lo:[0,1,0]
    v_cvt_pk_bf16_f32 v212, v204, -v205
    v_cvt_pk_bf16_f32 v213, v206, -v207
    v_cvt_pk_bf16_f32 v214, v192, -v193
    v_cvt_pk_bf16_f32 v215, v194, -v195
    v_cvt_pk_bf16_f32 v216, v196, -v197
    v_cvt_pk_bf16_f32 v217, v198, -v199
    v_cvt_pk_bf16_f32 v218, v200, -v201
    v_cvt_pk_bf16_f32 v219, v202, -v203
    ds_write_b64 v186, v[212:213] offset:4224
    ds_write_b64 v186, v[214:215] offset:4752
    ds_write_b64 v186, v[216:217] offset:5280
    ds_write_b64 v186, v[218:219] offset:5808
    v_pk_mul_f32 v[188:189], v[204:205], v[170:171] op_sel:[0,0] op_sel_hi:[0,1]
    v_pk_mul_f32 v[190:191], v[206:207], v[172:173] op_sel:[0,0] op_sel_hi:[0,1]
    v_pk_mul_f32 v[192:193], v[204:205], v[174:175] op_sel:[0,0] op_sel_hi:[0,1]
    v_pk_mul_f32 v[194:195], v[206:207], v[176:177] op_sel:[0,0] op_sel_hi:[0,1]
    v_pk_mul_f32 v[196:197], v[204:205], v[178:179] op_sel:[0,0] op_sel_hi:[0,1]
    v_pk_mul_f32 v[198:199], v[206:207], v[180:181] op_sel:[0,0] op_sel_hi:[0,1]
    v_pk_mul_f32 v[200:201], v[204:205], v[182:183] op_sel:[0,0] op_sel_hi:[0,1]
    v_pk_mul_f32 v[202:203], v[206:207], v[184:185] op_sel:[0,0] op_sel_hi:[0,1]
    v_pk_fma_f32 v[188:189], v[204:205], v[170:171], v[188:189] op_sel:[1,1,0] op_sel_hi:[1,0,1] neg_lo:[0,1,0]
    v_pk_fma_f32 v[190:191], v[206:207], v[172:173], v[190:191] op_sel:[1,1,0] op_sel_hi:[1,0,1] neg_lo:[0,1,0]
    v_pk_fma_f32 v[192:193], v[204:205], v[174:175], v[192:193] op_sel:[1,1,0] op_sel_hi:[1,0,1] neg_lo:[0,1,0]
    v_pk_fma_f32 v[194:195], v[206:207], v[176:177], v[194:195] op_sel:[1,1,0] op_sel_hi:[1,0,1] neg_lo:[0,1,0]
    v_pk_fma_f32 v[196:197], v[204:205], v[178:179], v[196:197] op_sel:[1,1,0] op_sel_hi:[1,0,1] neg_lo:[0,1,0]
    v_pk_fma_f32 v[198:199], v[206:207], v[180:181], v[198:199] op_sel:[1,1,0] op_sel_hi:[1,0,1] neg_lo:[0,1,0]
    v_pk_fma_f32 v[200:201], v[204:205], v[182:183], v[200:201] op_sel:[1,1,0] op_sel_hi:[1,0,1] neg_lo:[0,1,0]
    v_pk_fma_f32 v[202:203], v[206:207], v[184:185], v[202:203] op_sel:[1,1,0] op_sel_hi:[1,0,1] neg_lo:[0,1,0]
    v_cvt_pk_bf16_f32 v212, v188, -v189
    v_cvt_pk_bf16_f32 v213, v190, -v191
    v_cvt_pk_bf16_f32 v214, v192, -v193
    v_cvt_pk_bf16_f32 v215, v194, -v195
    v_cvt_pk_bf16_f32 v216, v196, -v197
    v_cvt_pk_bf16_f32 v217, v198, -v199
    v_cvt_pk_bf16_f32 v218, v200, -v201
    v_cvt_pk_bf16_f32 v219, v202, -v203
    ds_write_b64 v186, v[212:213] offset:6336
    ds_write_b64 v186, v[214:215] offset:6864
    ds_write_b64 v186, v[216:217] offset:7392
    ds_write_b64 v186, v[218:219] offset:7920
    s_waitcnt lgkmcnt(0)
    ds_read_b128 v[72:75], v187 offset:0
    ds_read_b128 v[76:79], v187 offset:64
    ds_read_b128 v[80:83], v187 offset:128
    ds_read_b128 v[84:87], v187 offset:192
    ds_read_b128 v[88:91], v187 offset:256
    ds_read_b128 v[92:95], v187 offset:320
    ds_read_b128 v[96:99], v187 offset:384
    ds_read_b128 v[100:103], v187 offset:448
    v_pk_mul_f32 v[158:159], v[204:205], v[150:151] op_sel:[0,0] op_sel_hi:[0,1]
    v_pk_mul_f32 v[160:161], v[206:207], v[152:153] op_sel:[0,0] op_sel_hi:[0,1]
    v_pk_fma_f32 v[158:159], v[204:205], v[150:151], v[158:159] op_sel:[1,1,0] op_sel_hi:[1,0,1] neg_lo:[0,1,0]
    v_pk_fma_f32 v[160:161], v[206:207], v[152:153], v[160:161] op_sel:[1,1,0] op_sel_hi:[1,0,1] neg_lo:[0,1,0]
    v_pk_mul_f32 v[192:193], v[158:159], v[162:163] op_sel:[0,0] op_sel_hi:[0,1]
    v_pk_mul_f32 v[194:195], v[160:161], v[164:165] op_sel:[0,0] op_sel_hi:[0,1]
    v_pk_mul_f32 v[196:197], v[158:159], v[170:171] op_sel:[0,0] op_sel_hi:[0,1]
    v_pk_mul_f32 v[198:199], v[160:161], v[172:173] op_sel:[0,0] op_sel_hi:[0,1]
    v_pk_mul_f32 v[200:201], v[158:159], v[178:179] op_sel:[0,0] op_sel_hi:[0,1]
    v_pk_mul_f32 v[202:203], v[160:161], v[180:181] op_sel:[0,0] op_sel_hi:[0,1]
    v_pk_fma_f32 v[192:193], v[158:159], v[162:163], v[192:193] op_sel:[1,1,0] op_sel_hi:[1,0,1] neg_lo:[0,1,0]
    v_pk_fma_f32 v[194:195], v[160:161], v[164:165], v[194:195] op_sel:[1,1,0] op_sel_hi:[1,0,1] neg_lo:[0,1,0]
    v_pk_fma_f32 v[196:197], v[158:159], v[170:171], v[196:197] op_sel:[1,1,0] op_sel_hi:[1,0,1] neg_lo:[0,1,0]
    v_pk_fma_f32 v[198:199], v[160:161], v[172:173], v[198:199] op_sel:[1,1,0] op_sel_hi:[1,0,1] neg_lo:[0,1,0]
    v_pk_fma_f32 v[200:201], v[158:159], v[178:179], v[200:201] op_sel:[1,1,0] op_sel_hi:[1,0,1] neg_lo:[0,1,0]
    v_pk_fma_f32 v[202:203], v[160:161], v[180:181], v[202:203] op_sel:[1,1,0] op_sel_hi:[1,0,1] neg_lo:[0,1,0]
    v_cvt_pk_bf16_f32 v212, v158, -v159
    v_cvt_pk_bf16_f32 v213, v160, -v161
    v_cvt_pk_bf16_f32 v214, v192, -v193
    v_cvt_pk_bf16_f32 v215, v194, -v195
    v_cvt_pk_bf16_f32 v216, v196, -v197
    v_cvt_pk_bf16_f32 v217, v198, -v199
    v_cvt_pk_bf16_f32 v218, v200, -v201
    v_cvt_pk_bf16_f32 v219, v202, -v203
    s_waitcnt lgkmcnt(0)
    v_mfma_f32_16x16x32_bf16 v[104:107], v[72:75], v[224:227], 0
    v_mfma_f32_16x16x32_bf16 v[104:107], v[76:79], v[228:231], v[104:107]
    v_mfma_f32_16x16x32_bf16 v[104:107], v[80:83], v[232:235], v[104:107]
    v_mfma_f32_16x16x32_bf16 v[104:107], v[84:87], v[236:239], v[104:107]
    v_mfma_f32_16x16x32_bf16 v[104:107], v[88:91], v[240:243], v[104:107]
    v_mfma_f32_16x16x32_bf16 v[104:107], v[92:95], v[244:247], v[104:107]
    v_mfma_f32_16x16x32_bf16 v[104:107], v[96:99], v[248:251], v[104:107]
    v_mfma_f32_16x16x32_bf16 v[104:107], v[100:103], v[252:255], v[104:107]
    ds_write_b64 v186, v[212:213] offset:0
    ds_write_b64 v186, v[214:215] offset:528
    ds_write_b64 v186, v[216:217] offset:1056
    ds_write_b64 v186, v[218:219] offset:1584
    v_pk_mul_f32 v[204:205], v[158:159], v[150:151] op_sel:[0,0] op_sel_hi:[0,1]
    v_pk_mul_f32 v[206:207], v[160:161], v[152:153] op_sel:[0,0] op_sel_hi:[0,1]
    v_pk_fma_f32 v[204:205], v[158:159], v[150:151], v[204:205] op_sel:[1,1,0] op_sel_hi:[1,0,1] neg_lo:[0,1,0]
    v_pk_fma_f32 v[206:207], v[160:161], v[152:153], v[206:207] op_sel:[1,1,0] op_sel_hi:[1,0,1] neg_lo:[0,1,0]
    v_pk_mul_f32 v[192:193], v[204:205], v[162:163] op_sel:[0,0] op_sel_hi:[0,1]
    v_pk_mul_f32 v[194:195], v[206:207], v[164:165] op_sel:[0,0] op_sel_hi:[0,1]
    v_pk_mul_f32 v[196:197], v[204:205], v[170:171] op_sel:[0,0] op_sel_hi:[0,1]
    v_pk_mul_f32 v[198:199], v[206:207], v[172:173] op_sel:[0,0] op_sel_hi:[0,1]
    v_pk_mul_f32 v[200:201], v[204:205], v[178:179] op_sel:[0,0] op_sel_hi:[0,1]
    v_pk_mul_f32 v[202:203], v[206:207], v[180:181] op_sel:[0,0] op_sel_hi:[0,1]
    v_pk_fma_f32 v[192:193], v[204:205], v[162:163], v[192:193] op_sel:[1,1,0] op_sel_hi:[1,0,1] neg_lo:[0,1,0]
    v_pk_fma_f32 v[194:195], v[206:207], v[164:165], v[194:195] op_sel:[1,1,0] op_sel_hi:[1,0,1] neg_lo:[0,1,0]
    v_pk_fma_f32 v[196:197], v[204:205], v[170:171], v[196:197] op_sel:[1,1,0] op_sel_hi:[1,0,1] neg_lo:[0,1,0]
    v_pk_fma_f32 v[198:199], v[206:207], v[172:173], v[198:199] op_sel:[1,1,0] op_sel_hi:[1,0,1] neg_lo:[0,1,0]
    v_pk_fma_f32 v[200:201], v[204:205], v[178:179], v[200:201] op_sel:[1,1,0] op_sel_hi:[1,0,1] neg_lo:[0,1,0]
    v_pk_fma_f32 v[202:203], v[206:207], v[180:181], v[202:203] op_sel:[1,1,0] op_sel_hi:[1,0,1] neg_lo:[0,1,0]
    v_cvt_pk_bf16_f32 v212, v204, -v205
    v_cvt_pk_bf16_f32 v213, v206, -v207
    v_cvt_pk_bf16_f32 v214, v192, -v193
    v_cvt_pk_bf16_f32 v215, v194, -v195
    v_cvt_pk_bf16_f32 v216, v196, -v197
    v_cvt_pk_bf16_f32 v217, v198, -v199
    v_cvt_pk_bf16_f32 v218, v200, -v201
    v_cvt_pk_bf16_f32 v219, v202, -v203
    ds_write_b64 v186, v[212:213] offset:2112
    ds_write_b64 v186, v[214:215] offset:2640
    ds_write_b64 v186, v[216:217] offset:3168
    ds_write_b64 v186, v[218:219] offset:3696
    v_pk_mul_f32 v[158:159], v[204:205], v[150:151] op_sel:[0,0] op_sel_hi:[0,1]
    v_pk_mul_f32 v[160:161], v[206:207], v[152:153] op_sel:[0,0] op_sel_hi:[0,1]
    v_pk_fma_f32 v[158:159], v[204:205], v[150:151], v[158:159] op_sel:[1,1,0] op_sel_hi:[1,0,1] neg_lo:[0,1,0]
    v_pk_fma_f32 v[160:161], v[206:207], v[152:153], v[160:161] op_sel:[1,1,0] op_sel_hi:[1,0,1] neg_lo:[0,1,0]
    v_pk_mul_f32 v[192:193], v[158:159], v[170:171] op_sel:[0,0] op_sel_hi:[0,1]
    v_pk_mul_f32 v[194:195], v[160:161], v[172:173] op_sel:[0,0] op_sel_hi:[0,1]
    v_pk_fma_f32 v[192:193], v[158:159], v[170:171], v[192:193] op_sel:[1,1,0] op_sel_hi:[1,0,1] neg_lo:[0,1,0]
    v_pk_fma_f32 v[194:195], v[160:161], v[172:173], v[194:195] op_sel:[1,1,0] op_sel_hi:[1,0,1] neg_lo:[0,1,0]
    v_cvt_pk_bf16_f32 v212, v158, -v159
    v_cvt_pk_bf16_f32 v213, v160, -v161
    v_pk_mul_f32 v[204:205], v[158:159], v[150:151] op_sel:[0,0] op_sel_hi:[0,1]
    v_pk_mul_f32 v[206:207], v[160:161], v[152:153] op_sel:[0,0] op_sel_hi:[0,1]
    v_pk_fma_f32 v[204:205], v[158:159], v[150:151], v[204:205] op_sel:[1,1,0] op_sel_hi:[1,0,1] neg_lo:[0,1,0]
    v_pk_fma_f32 v[206:207], v[160:161], v[152:153], v[206:207] op_sel:[1,1,0] op_sel_hi:[1,0,1] neg_lo:[0,1,0]
    v_pk_mul_f32 v[200:201], v[204:205], v[170:171] op_sel:[0,0] op_sel_hi:[0,1]
    v_pk_mul_f32 v[202:203], v[206:207], v[172:173] op_sel:[0,0] op_sel_hi:[0,1]
    v_pk_fma_f32 v[200:201], v[204:205], v[170:171], v[200:201] op_sel:[1,1,0] op_sel_hi:[1,0,1] neg_lo:[0,1,0]
    v_pk_fma_f32 v[202:203], v[206:207], v[172:173], v[202:203] op_sel:[1,1,0] op_sel_hi:[1,0,1] neg_lo:[0,1,0]
    v_cvt_pk_bf16_f32 v216, v204, -v205
    v_cvt_pk_bf16_f32 v217, v206, -v207
    v_cvt_pk_bf16_f32 v214, v192, -v193
    v_cvt_pk_bf16_f32 v215, v194, -v195
    v_cvt_pk_bf16_f32 v218, v200, -v201
    v_cvt_pk_bf16_f32 v219, v202, -v203
    ds_write_b64 v186, v[212:213] offset:4224
    ds_write_b64 v186, v[214:215] offset:4752
    ds_write_b64 v186, v[216:217] offset:5280
    ds_write_b64 v186, v[218:219] offset:5808
    v_pk_mul_f32 v[158:159], v[204:205], v[150:151] op_sel:[0,0] op_sel_hi:[0,1]
    v_pk_mul_f32 v[160:161], v[206:207], v[152:153] op_sel:[0,0] op_sel_hi:[0,1]
    v_pk_fma_f32 v[158:159], v[204:205], v[150:151], v[158:159] op_sel:[1,1,0] op_sel_hi:[1,0,1] neg_lo:[0,1,0]
    v_pk_fma_f32 v[160:161], v[206:207], v[152:153], v[160:161] op_sel:[1,1,0] op_sel_hi:[1,0,1] neg_lo:[0,1,0]
    v_pk_mul_f32 v[192:193], v[158:159], v[170:171] op_sel:[0,0] op_sel_hi:[0,1]
    v_pk_mul_f32 v[194:195], v[160:161], v[172:173] op_sel:[0,0] op_sel_hi:[0,1]
    v_pk_fma_f32 v[192:193], v[158:159], v[170:171], v[192:193] op_sel:[1,1,0] op_sel_hi:[1,0,1] neg_lo:[0,1,0]
    v_pk_fma_f32 v[194:195], v[160:161], v[172:173], v[194:195] op_sel:[1,1,0] op_sel_hi:[1,0,1] neg_lo:[0,1,0]
    v_cvt_pk_bf16_f32 v212, v158, -v159
    v_cvt_pk_bf16_f32 v213, v160, -v161
    v_pk_mul_f32 v[204:205], v[158:159], v[150:151] op_sel:[0,0] op_sel_hi:[0,1]
    v_pk_mul_f32 v[206:207], v[160:161], v[152:153] op_sel:[0,0] op_sel_hi:[0,1]
    v_pk_fma_f32 v[204:205], v[158:159], v[150:151], v[204:205] op_sel:[1,1,0] op_sel_hi:[1,0,1] neg_lo:[0,1,0]
    v_pk_fma_f32 v[206:207], v[160:161], v[152:153], v[206:207] op_sel:[1,1,0] op_sel_hi:[1,0,1] neg_lo:[0,1,0]
    v_pk_mul_f32 v[200:201], v[204:205], v[170:171] op_sel:[0,0] op_sel_hi:[0,1]
    v_pk_mul_f32 v[202:203], v[206:207], v[172:173] op_sel:[0,0] op_sel_hi:[0,1]
    v_pk_fma_f32 v[200:201], v[204:205], v[170:171], v[200:201] op_sel:[1,1,0] op_sel_hi:[1,0,1] neg_lo:[0,1,0]
    v_pk_fma_f32 v[202:203], v[206:207], v[172:173], v[202:203] op_sel:[1,1,0] op_sel_hi:[1,0,1] neg_lo:[0,1,0]
    v_cvt_pk_bf16_f32 v216, v204, -v205
    v_cvt_pk_bf16_f32 v217, v206, -v207
    v_cvt_pk_bf16_f32 v214, v192, -v193
    v_cvt_pk_bf16_f32 v215, v194, -v195
    v_cvt_pk_bf16_f32 v218, v200, -v201
    v_cvt_pk_bf16_f32 v219, v202, -v203
    ds_write_b64 v186, v[212:213] offset:6336
    ds_write_b64 v186, v[214:215] offset:6864
    ds_write_b64 v186, v[216:217] offset:7392
    ds_write_b64 v186, v[218:219] offset:7920
    s_waitcnt lgkmcnt(0)
    ds_read_b128 v[72:75], v187 offset:0
    ds_read_b128 v[76:79], v187 offset:64
    ds_read_b128 v[80:83], v187 offset:128
    ds_read_b128 v[84:87], v187 offset:192
    ds_read_b128 v[88:91], v187 offset:256
    ds_read_b128 v[92:95], v187 offset:320
    ds_read_b128 v[96:99], v187 offset:384
    ds_read_b128 v[100:103], v187 offset:448
    v_pk_mul_f32 v[158:159], v[204:205], v[150:151] op_sel:[0,0] op_sel_hi:[0,1]
    v_pk_mul_f32 v[160:161], v[206:207], v[152:153] op_sel:[0,0] op_sel_hi:[0,1]
    v_pk_fma_f32 v[158:159], v[204:205], v[150:151], v[158:159] op_sel:[1,1,0] op_sel_hi:[1,0,1] neg_lo:[0,1,0]
    v_pk_fma_f32 v[160:161], v[206:207], v[152:153], v[160:161] op_sel:[1,1,0] op_sel_hi:[1,0,1] neg_lo:[0,1,0]
    v_cvt_pk_bf16_f32 v212, v158, -v159
    v_cvt_pk_bf16_f32 v213, v160, -v161
    v_pk_mul_f32 v[204:205], v[158:159], v[150:151] op_sel:[0,0] op_sel_hi:[0,1]
    v_pk_mul_f32 v[206:207], v[160:161], v[152:153] op_sel:[0,0] op_sel_hi:[0,1]
    v_pk_fma_f32 v[204:205], v[158:159], v[150:151], v[204:205] op_sel:[1,1,0] op_sel_hi:[1,0,1] neg_lo:[0,1,0]
    v_pk_fma_f32 v[206:207], v[160:161], v[152:153], v[206:207] op_sel:[1,1,0] op_sel_hi:[1,0,1] neg_lo:[0,1,0]
    v_cvt_pk_bf16_f32 v214, v204, -v205
    v_cvt_pk_bf16_f32 v215, v206, -v207
    v_pk_mul_f32 v[158:159], v[204:205], v[150:151] op_sel:[0,0] op_sel_hi:[0,1]
    v_pk_mul_f32 v[160:161], v[206:207], v[152:153] op_sel:[0,0] op_sel_hi:[0,1]
    v_pk_fma_f32 v[158:159], v[204:205], v[150:151], v[158:159] op_sel:[1,1,0] op_sel_hi:[1,0,1] neg_lo:[0,1,0]
    v_pk_fma_f32 v[160:161], v[206:207], v[152:153], v[160:161] op_sel:[1,1,0] op_sel_hi:[1,0,1] neg_lo:[0,1,0]
    v_cvt_pk_bf16_f32 v216, v158, -v159
    v_cvt_pk_bf16_f32 v217, v160, -v161
    v_pk_mul_f32 v[204:205], v[158:159], v[150:151] op_sel:[0,0] op_sel_hi:[0,1]
    v_pk_mul_f32 v[206:207], v[160:161], v[152:153] op_sel:[0,0] op_sel_hi:[0,1]
    v_pk_fma_f32 v[204:205], v[158:159], v[150:151], v[204:205] op_sel:[1,1,0] op_sel_hi:[1,0,1] neg_lo:[0,1,0]
    v_pk_fma_f32 v[206:207], v[160:161], v[152:153], v[206:207] op_sel:[1,1,0] op_sel_hi:[1,0,1] neg_lo:[0,1,0]
    v_cvt_pk_bf16_f32 v218, v204, -v205
    v_cvt_pk_bf16_f32 v219, v206, -v207
    s_waitcnt lgkmcnt(0)
    v_mfma_f32_16x16x32_bf16 v[108:111], v[72:75], v[224:227], 0
    v_mfma_f32_16x16x32_bf16 v[108:111], v[76:79], v[228:231], v[108:111]
    v_mfma_f32_16x16x32_bf16 v[108:111], v[80:83], v[232:235], v[108:111]
    v_mfma_f32_16x16x32_bf16 v[108:111], v[84:87], v[236:239], v[108:111]
    v_mfma_f32_16x16x32_bf16 v[108:111], v[88:91], v[240:243], v[108:111]
    v_mfma_f32_16x16x32_bf16 v[108:111], v[92:95], v[244:247], v[108:111]
    v_mfma_f32_16x16x32_bf16 v[108:111], v[96:99], v[248:251], v[108:111]
    v_mfma_f32_16x16x32_bf16 v[108:111], v[100:103], v[252:255], v[108:111]
    ds_write_b64 v186, v[212:213] offset:0
    ds_write_b64 v186, v[214:215] offset:528
    ds_write_b64 v186, v[216:217] offset:1056
    ds_write_b64 v186, v[218:219] offset:1584
    v_pk_mul_f32 v[158:159], v[204:205], v[150:151] op_sel:[0,0] op_sel_hi:[0,1]
    v_pk_mul_f32 v[160:161], v[206:207], v[152:153] op_sel:[0,0] op_sel_hi:[0,1]
    v_pk_fma_f32 v[158:159], v[204:205], v[150:151], v[158:159] op_sel:[1,1,0] op_sel_hi:[1,0,1] neg_lo:[0,1,0]
    v_pk_fma_f32 v[160:161], v[206:207], v[152:153], v[160:161] op_sel:[1,1,0] op_sel_hi:[1,0,1] neg_lo:[0,1,0]
    v_cvt_pk_bf16_f32 v212, v158, -v159
    v_cvt_pk_bf16_f32 v213, v160, -v161
    v_pk_mul_f32 v[204:205], v[158:159], v[150:151] op_sel:[0,0] op_sel_hi:[0,1]
    v_pk_mul_f32 v[206:207], v[160:161], v[152:153] op_sel:[0,0] op_sel_hi:[0,1]
    v_pk_fma_f32 v[204:205], v[158:159], v[150:151], v[204:205] op_sel:[1,1,0] op_sel_hi:[1,0,1] neg_lo:[0,1,0]
    v_pk_fma_f32 v[206:207], v[160:161], v[152:153], v[206:207] op_sel:[1,1,0] op_sel_hi:[1,0,1] neg_lo:[0,1,0]
    v_cvt_pk_bf16_f32 v214, v204, -v205
    v_cvt_pk_bf16_f32 v215, v206, -v207
    v_pk_mul_f32 v[158:159], v[204:205], v[150:151] op_sel:[0,0] op_sel_hi:[0,1]
    v_pk_mul_f32 v[160:161], v[206:207], v[152:153] op_sel:[0,0] op_sel_hi:[0,1]
    v_pk_fma_f32 v[158:159], v[204:205], v[150:151], v[158:159] op_sel:[1,1,0] op_sel_hi:[1,0,1] neg_lo:[0,1,0]
    v_pk_fma_f32 v[160:161], v[206:207], v[152:153], v[160:161] op_sel:[1,1,0] op_sel_hi:[1,0,1] neg_lo:[0,1,0]
    v_cvt_pk_bf16_f32 v216, v158, -v159
    v_cvt_pk_bf16_f32 v217, v160, -v161
    v_pk_mul_f32 v[204:205], v[158:159], v[150:151] op_sel:[0,0] op_sel_hi:[0,1]
    v_pk_mul_f32 v[206:207], v[160:161], v[152:153] op_sel:[0,0] op_sel_hi:[0,1]
    v_pk_fma_f32 v[204:205], v[158:159], v[150:151], v[204:205] op_sel:[1,1,0] op_sel_hi:[1,0,1] neg_lo:[0,1,0]
    v_pk_fma_f32 v[206:207], v[160:161], v[152:153], v[206:207] op_sel:[1,1,0] op_sel_hi:[1,0,1] neg_lo:[0,1,0]
    v_cvt_pk_bf16_f32 v218, v204, -v205
    v_cvt_pk_bf16_f32 v219, v206, -v207
    ds_write_b64 v186, v[212:213] offset:2112
    ds_write_b64 v186, v[214:215] offset:2640
    ds_write_b64 v186, v[216:217] offset:3168
    ds_write_b64 v186, v[218:219] offset:3696
    v_pk_mul_f32 v[158:159], v[204:205], v[150:151] op_sel:[0,0] op_sel_hi:[0,1]
    v_pk_mul_f32 v[160:161], v[206:207], v[152:153] op_sel:[0,0] op_sel_hi:[0,1]
    v_pk_fma_f32 v[158:159], v[204:205], v[150:151], v[158:159] op_sel:[1,1,0] op_sel_hi:[1,0,1] neg_lo:[0,1,0]
    v_pk_fma_f32 v[160:161], v[206:207], v[152:153], v[160:161] op_sel:[1,1,0] op_sel_hi:[1,0,1] neg_lo:[0,1,0]
    v_cvt_pk_bf16_f32 v212, v158, -v159
    v_cvt_pk_bf16_f32 v213, v160, -v161
    ds_write_b64 v186, v[212:213] offset:4224
    s_waitcnt lgkmcnt(0)
    ds_read_b128 v[72:75], v187 offset:0
    ds_read_b128 v[76:79], v187 offset:64
    ds_read_b128 v[80:83], v187 offset:128
    ds_read_b128 v[84:87], v187 offset:192
    ds_read_b128 v[88:91], v187 offset:256
    ds_read_b128 v[92:95], v187 offset:320
    ds_read_b128 v[96:99], v187 offset:384
    ds_read_b128 v[100:103], v187 offset:448
    v_mov_b32 v12, 0
    v_subrev_u32 v13, -12, v186
    v_cvt_pk_bf16_f32 v104, v104, v105
    v_cvt_pk_bf16_f32 v105, v106, v107
    v_cvt_pk_bf16_f32 v108, v108, v109
    v_cvt_pk_bf16_f32 v109, v110, v111
    s_waitcnt lgkmcnt(0)
    v_mfma_f32_16x16x32_bf16 v[112:115], v[72:75], v[224:227], 0
    v_mfma_f32_16x16x32_bf16 v[112:115], v[76:79], v[228:231], v[112:115]
    v_mfma_f32_16x16x32_bf16 v[112:115], v[80:83], v[232:235], v[112:115]
    v_mfma_f32_16x16x32_bf16 v[112:115], v[84:87], v[236:239], v[112:115]
    v_mfma_f32_16x16x32_bf16 v[112:115], v[88:91], v[240:243], v[112:115]
    v_mfma_f32_16x16x32_bf16 v[112:115], v[92:95], v[244:247], v[112:115]
    v_mfma_f32_16x16x32_bf16 v[112:115], v[96:99], v[248:251], v[112:115]
    v_mfma_f32_16x16x32_bf16 v[112:115], v[100:103], v[252:255], v[112:115]
    s_mov_b64 exec, 1
    ds_write_b32 v13, v12
    s_mov_b64 exec, -1
    ds_write_b16 v116, v104 offset:0
    ds_write_b16_d16_hi v116, v104 offset:2
    ds_write_b16 v116, v105 offset:4
    ds_write_b16_d16_hi v116, v105 offset:6
    ds_write_b16 v117, v108
    ds_write_b16_d16_hi v118, v108
    ds_write_b16 v119, v109
    ds_write_b16_d16_hi v120, v109
    v_cvt_pk_bf16_f32 v112, v112, v113
    v_cvt_pk_bf16_f32 v113, v114, v115
    ds_write_b16 v121, v112
    ds_write_b16_d16_hi v122, v112
    ds_write_b16 v123, v113
    ds_write_b16_d16_hi v124, v113
    s_waitcnt lgkmcnt(0)
    ds_read_u16 v224, v134 offset:3840
    ds_read_u16 v240, v135 offset:3840
    ds_read_u16 v72, v136 offset:3840
    ds_read_u16 v225, v134 offset:3584
    ds_read_u16 v241, v135 offset:3584
    ds_read_u16 v73, v136 offset:3584
    ds_read_u16 v226, v134 offset:3328
    ds_read_u16 v242, v135 offset:3328
    ds_read_u16 v74, v136 offset:3328
    ds_read_u16 v227, v134 offset:3072
    ds_read_u16 v243, v135 offset:3072
    ds_read_u16 v75, v136 offset:3072
    s_waitcnt lgkmcnt(3)
    ds_read_u16 v228, v134 offset:2816
    ds_read_u16 v244, v135 offset:2816
    ds_read_u16 v76, v136 offset:2816
    ds_read_u16 v229, v134 offset:2560
    ds_read_u16 v245, v135 offset:2560
    ds_read_u16 v77, v136 offset:2560
    ds_read_u16 v230, v134 offset:2304
    ds_read_u16 v246, v135 offset:2304
    ds_read_u16 v78, v136 offset:2304
    ds_read_u16 v231, v134 offset:2048
    ds_read_u16 v247, v135 offset:2048
    ds_read_u16 v79, v136 offset:2048
    s_waitcnt lgkmcnt(3)
    ds_read_u16 v232, v131 offset:1792
    ds_read_u16 v248, v132 offset:1792
    ds_read_u16 v80, v133 offset:1792
    ds_read_u16 v233, v131 offset:1536
    ds_read_u16 v249, v132 offset:1536
    ds_read_u16 v81, v133 offset:1536
    ds_read_u16 v234, v131 offset:1280
    ds_read_u16 v250, v132 offset:1280
    ds_read_u16 v82, v133 offset:1280
    ds_read_u16 v235, v131 offset:1024
    ds_read_u16 v251, v132 offset:1024
    ds_read_u16 v83, v133 offset:1024
    s_waitcnt lgkmcnt(3)
    ds_read_u16 v236, v128 offset:768
    ds_read_u16 v252, v129 offset:768
    ds_read_u16 v84, v130 offset:768
    ds_read_u16 v237, v128 offset:512
    ds_read_u16 v253, v129 offset:512
    ds_read_u16 v85, v137 offset:512
    ds_read_u16 v238, v125 offset:256
    ds_read_u16 v254, v126 offset:256
    ds_read_u16 v86, v127 offset:256
    ds_read_u16 v239, v125 offset:0
    ds_read_u16 v255, v126 offset:0
    ds_read_u16 v87, v127 offset:0
    s_waitcnt lgkmcnt(0)
    v_lshl_or_b32 v188, v240, 16, v224
    v_lshl_or_b32 v204, v72, 16, v240
    v_lshl_or_b32 v189, v241, 16, v225
    v_lshl_or_b32 v205, v73, 16, v241
    v_lshl_or_b32 v190, v242, 16, v226
    v_lshl_or_b32 v206, v74, 16, v242
    v_lshl_or_b32 v191, v243, 16, v227
    v_lshl_or_b32 v207, v75, 16, v243
    v_lshl_or_b32 v192, v244, 16, v228
    v_lshl_or_b32 v208, v76, 16, v244
    v_lshl_or_b32 v193, v245, 16, v229
    v_lshl_or_b32 v209, v77, 16, v245
    v_lshl_or_b32 v194, v246, 16, v230
    v_lshl_or_b32 v210, v78, 16, v246
    v_lshl_or_b32 v195, v247, 16, v231
    v_lshl_or_b32 v211, v79, 16, v247
    v_lshl_or_b32 v196, v248, 16, v232
    v_lshl_or_b32 v212, v80, 16, v248
    v_lshl_or_b32 v197, v249, 16, v233
    v_lshl_or_b32 v213, v81, 16, v249
    v_lshl_or_b32 v198, v250, 16, v234
    v_lshl_or_b32 v214, v82, 16, v250
    v_lshl_or_b32 v199, v251, 16, v235
    v_lshl_or_b32 v215, v83, 16, v251
    v_lshl_or_b32 v200, v252, 16, v236
    v_lshl_or_b32 v216, v84, 16, v252
    v_lshl_or_b32 v201, v253, 16, v237
    v_lshl_or_b32 v217, v85, 16, v253
    v_lshl_or_b32 v202, v254, 16, v238
    v_lshl_or_b32 v218, v86, 16, v254
    v_lshl_or_b32 v203, v255, 16, v239
    v_lshl_or_b32 v219, v87, 16, v255
    s_and_b32 s92, s2, 3
    s_lshl_b32 s92, s92, 10
    s_add_u32 s92, s92, 14057472
    v_lshlrev_b32 v21, 4, v1
    s_cmp_lg_u32 s64, 1
    s_cbranch_scc1 L_nopoll
    v_mov_b32 v22, 163672
    ds_read_b32 v20, v22
    s_waitcnt lgkmcnt(0)
    v_cmp_ne_u32 vcc, 1, v20
    s_cbranch_vccnz L_zslow
L_zok:
    buffer_load_dword v20, v21, s[52:55], s92 offen sc1
L_nopoll:
    v_add_u32 v12, 0, v1
    v_mul_u32_u24 v13, 6554, v12
    v_lshrrev_b32 v13, 16, v13
    v_mul_u32_u24 v14, 10, v13
    v_sub_u32 v12, v12, v14
    v_lshlrev_b32 v12, 4, v12
    v_and_b32 v4, 0x13, v13
    v_bfe_u32 v14, v13, 2, 1
    v_lshl_or_b32 v4, v14, 3, v4
    v_bfe_u32 v14, v13, 3, 1
    v_lshl_or_b32 v4, v14, 2, v4
    v_mul_u32_u24 v4, 1280, v4
    v_add_u32 v4, v4, v12
    v_add_u32 v12, 64, v1
    v_mul_u32_u24 v13, 6554, v12
    v_lshrrev_b32 v13, 16, v13
    v_mul_u32_u24 v14, 10, v13
    v_sub_u32 v12, v12, v14
    v_lshlrev_b32 v12, 4, v12
    v_and_b32 v5, 0x13, v13
    v_bfe_u32 v14, v13, 2, 1
    v_lshl_or_b32 v5, v14, 3, v5
    v_bfe_u32 v14, v13, 3, 1
    v_lshl_or_b32 v5, v14, 2, v5
    v_mul_u32_u24 v5, 1280, v5
    v_add_u32 v5, v5, v12
    v_add_u32 v12, 128, v1
    v_mul_u32_u24 v13, 6554, v12
    v_lshrrev_b32 v13, 16, v13
    v_mul_u32_u24 v14, 10, v13
    v_sub_u32 v12, v12, v14
    v_lshlrev_b32 v12, 4, v12
    v_and_b32 v6, 0x13, v13
    v_bfe_u32 v14, v13, 2, 1
    v_lshl_or_b32 v6, v14, 3, v6
    v_bfe_u32 v14, v13, 3, 1
    v_lshl_or_b32 v6, v14, 2, v6
    v_mul_u32_u24 v6, 1280, v6
    v_add_u32 v6, v6, v12
    v_add_u32 v12, 192, v1
    v_mul_u32_u24 v13, 6554, v12
    v_lshrrev_b32 v13, 16, v13
    v_mul_u32_u24 v14, 10, v13
    v_sub_u32 v12, v12, v14
    v_lshlrev_b32 v12, 4, v12
    v_and_b32 v7, 0x13, v13
    v_bfe_u32 v14, v13, 2, 1
    v_lshl_or_b32 v7, v14, 3, v7
    v_bfe_u32 v14, v13, 3, 1
    v_lshl_or_b32 v7, v14, 2, v7
    v_mul_u32_u24 v7, 1280, v7
    v_add_u32 v7, v7, v12
    v_add_u32 v12, 256, v1
    v_mul_u32_u24 v13, 6554, v12
    v_lshrrev_b32 v13, 16, v13
    v_mul_u32_u24 v14, 10, v13
    v_sub_u32 v12, v12, v14
    v_lshlrev_b32 v12, 4, v12
    v_and_b32 v8, 0x13, v13
    v_bfe_u32 v14, v13, 2, 1
    v_lshl_or_b32 v8, v14, 3, v8
    v_bfe_u32 v14, v13, 3, 1
    v_lshl_or_b32 v8, v14, 2, v8
    v_mul_u32_u24 v8, 1280, v8
    v_add_u32 v8, v8, v12
    v_subrev_u32 v5, 1024, v5
    v_subrev_u32 v6, 2048, v6
    v_subrev_u32 v7, 3072, v7
    s_mov_b32 s40, s4
    s_mov_b32 s41, s5
    s_mov_b32 s42, 2621440
    s_mov_b32 s43, 0x20000
    s_and_b32 s70, s65, 1
    s_lshr_b32 s74, s65, 1
    s_mul_i32 s74, s74, 5
    s_mul_i32 s75, s66, 80
    s_add_u32 s74, s74, s75
    s_mul_i32 s75, s70, 3
    s_add_u32 s71, s74, s75
    s_add_u32 s72, s71, 1
    s_add_u32 s73, s74, 2
    s_mul_i32 s88, s64, 3
    s_min_u32 s88, s88, 18
    s_lshl_b32 s88, s88, 10
    s_lshr_b32 s98, s64, 2
    s_lshl_b32 s74, s98, 5
    v_add_u32 v255, s74, v10
    v_mul_u32_u24 v255, 160, v255
    s_mul_i32 s74, s67, 40
    s_add_u32 s74, s74, 128064
    v_add_u32 v255, s74, v255
    v_lshl_add_u32 v254, v11, 4, v255
    s_lshl_b32 s74, s64, 6
    v_add_u32 v12, s74, v1
    v_mul_u32_u24 v13, 13108, v12
    v_lshrrev_b32 v13, 16, v13
    v_mul_u32_u24 v14, 5, v13
    v_sub_u32 v12, v12, v14
    v_min_u32 v12, 3, v12
    v_lshlrev_b32 v12, 4, v12
    v_lshl_add_u32 v244, v13, 6, v12
    v_lshlrev_b32 v12, 3, v10
    v_add_u32 v12, 1024, v12
    v_mov_b32 v13, 1280
    v_cmp_eq_u32 vcc, 0, v11
    s_nop 1
    v_cndmask_b32 v12, v13, v12, vcc
    v_lshlrev_b32 v13, 4, v10
    v_mul_u32_u24 v14, 336, v11
    v_add3_u32 v13, v13, v14, 0
    v_add_u32 v245, 102400, v9
    v_add_u32 v248, 102400, v12
    v_add_u32 v251, 103744, v13
    v_add_u32 v246, 138304, v9
    v_add_u32 v249, 138304, v12
    v_add_u32 v252, 139648, v13
    v_add_u32 v247, 0, v9
    v_add_u32 v250, 0, v12
    v_add_u32 v253, 1344, v13
    s_mov_b32 s90, 0x001fffff
    s_mov_b32 s91, 0x001fffff
    s_mul_i32 s81, s64, 11
    s_lshr_b32 s81, s81, 5
    s_mul_i32 s74, s81, 3
    s_sub_u32 s82, s64, s74
    s_sub_u32 s74, s64, 5
    s_mul_i32 s74, s74, s70
    s_cmp_ge_u32 s64, 6
    s_cselect_b32 s82, s74, s82
    s_cmp_eq_u32 s81, 0
    s_cselect_b32 s83, s71, s73
    s_cmp_eq_u32 s81, 1
    s_cselect_b32 s83, s72, s83
    s_xor_b32 s74, s70, 1
    s_cmp_eq_u32 s64, 7
    s_cselect_b32 s84, s74, 0
    s_mov_b32 s94, -1
    s_mov_b32 s95, 0
    s_mov_b32 s89, 0
    s_mov_b32 s44, s30
    s_mov_b32 s45, s31
    s_mov_b32 s46, 819200
    s_mov_b32 s47, 0x20000
    s_mov_b32 s60, s20
    s_mov_b32 s61, s21
    s_mov_b32 s62, 1280
    s_mov_b32 s63, 0x20000
    s_cmp_lg_u32 s64, 1
    s_cbranch_scc1 L_x1
    s_mov_b32 s99, 0
L_poll1:
    s_waitcnt vmcnt(0)
    v_cmp_ne_u32 vcc, 1, v20
    s_cbranch_vccz L_poll1d
    buffer_load_dword v20, v21, s[52:55], s92 offen sc1
    s_add_u32 s99, s99, 1
    s_cmp_lt_u32 s99, 262144
    s_cbranch_scc1 L_poll1
L_poll1d:
    v_and_b32 v21, 15, v1
    v_bfe_u32 v20, v1, 4, 1
    v_lshl_add_u32 v21, v20, 5, v21
    v_lshlrev_b32 v21, 2, v21
    s_mov_b32 s75, 13893632
    buffer_load_dword v20, v21, s[52:55], s75 offen sc1
    v_mov_b32 v12, 163668
    s_mov_b32 s99, 0
L_g5p_132:
    ds_read_b32 v13, v12
    s_waitcnt lgkmcnt(0)
    v_readfirstlane_b32 s74, v13
    s_nop 0
    s_cmp_ge_u32 s74, 4
    s_cbranch_scc1 L_g5pd_133
    s_add_u32 s99, s99, 1
    s_cmp_lt_u32 s99, 2097152
    s_cbranch_scc1 L_g5p_132
L_g5pd_133:
    s_mov_b32 m0, 102400
    s_mov_b32 s75, 13631488
    buffer_load_dwordx4 v9, s[52:55], s75 offen offset:0 sc1 lds
    buffer_load_dwordx4 v9, s[52:55], s75 offen offset:1024 sc1 lds
    buffer_load_dwordx4 v9, s[52:55], s75 offen offset:2048 sc1 lds
    buffer_load_dwordx4 v9, s[52:55], s75 offen offset:3072 sc1 lds
    s_mov_b32 m0, 106496
    s_mov_b32 s75, 13635584
    buffer_load_dwordx4 v9, s[52:55], s75 offen offset:0 sc1 lds
    buffer_load_dwordx4 v9, s[52:55], s75 offen offset:1024 sc1 lds
    buffer_load_dwordx4 v9, s[52:55], s75 offen offset:2048 sc1 lds
    buffer_load_dwordx4 v9, s[52:55], s75 offen offset:3072 sc1 lds
    s_mov_b32 m0, 110592
    s_mov_b32 s75, 13639680
    buffer_load_dwordx4 v9, s[52:55], s75 offen offset:0 sc1 lds
    buffer_load_dwordx4 v9, s[52:55], s75 offen offset:1024 sc1 lds
    buffer_load_dwordx4 v9, s[52:55], s75 offen offset:2048 sc1 lds
    buffer_load_dwordx4 v9, s[52:55], s75 offen offset:3072 sc1 lds
    s_mov_b32 m0, 114688
    s_mov_b32 s75, 13643776
    buffer_load_dwordx4 v9, s[52:55], s75 offen offset:0 sc1 lds
    buffer_load_dwordx4 v9, s[52:55], s75 offen offset:1024 sc1 lds
    buffer_load_dwordx4 v9, s[52:55], s75 offen offset:2048 sc1 lds
    buffer_load_dwordx4 v9, s[52:55], s75 offen offset:3072 sc1 lds
    s_mov_b32 m0, 118784
    s_mov_b32 s75, 13647872
    buffer_load_dwordx4 v9, s[52:55], s75 offen offset:0 sc1 lds
    buffer_load_dwordx4 v9, s[52:55], s75 offen offset:1024 sc1 lds
    buffer_load_dwordx4 v9, s[52:55], s75 offen offset:2048 sc1 lds
    buffer_load_dwordx4 v9, s[52:55], s75 offen offset:3072 sc1 lds
    s_mov_b32 m0, 122880
    s_mov_b32 s75, 13651968
    buffer_load_dwordx4 v9, s[52:55], s75 offen offset:0 sc1 lds
    s_waitcnt vmcnt(21)
    v_max_u32_dpp v20, v20, v20 quad_perm:[1,0,3,2] row_mask:0xf bank_mask:0xf
    s_nop 1
    v_max_u32_dpp v20, v20, v20 quad_perm:[2,3,0,1] row_mask:0xf bank_mask:0xf
    s_nop 1
    v_max_u32_dpp v20, v20, v20 row_half_mirror row_mask:0xf bank_mask:0xf
    s_nop 1
    v_max_u32_dpp v20, v20, v20 row_mirror row_mask:0xf bank_mask:0xf
    v_mov_b32 v21, v20
    s_nop 1
    v_permlane16_swap_b32 v20, v21
    v_max_u32 v20, v20, v21
    v_mov_b32 v21, v20
    s_nop 1
    v_permlane32_swap_b32 v20, v21
    v_max_u32 v20, v20, v21
    v_mov_b32 v15, 124160
    s_mov_b64 exec, 1
    ds_write_b32 v15, v20
    s_mov_b64 exec, -1
    v_mov_b32 v12, 163676
    s_mov_b32 s99, 0
L_sdc_134:
    ds_read_b32 v13, v12
    s_waitcnt lgkmcnt(0)
    v_readfirstlane_b32 s74, v13
    s_nop 0
    s_cmp_ge_u32 s74, 3
    s_cbranch_scc1 L_sdcd_135
    s_add_u32 s99, s99, 1
    s_cmp_lt_u32 s99, 2097152
    s_cbranch_scc1 L_sdc_134
L_sdcd_135:
    s_lshl_b32 s74, s66, 7
    s_add_u32 s74, s74, 14049280
    v_mov_b32 v20, 0
    v_mov_b32 v21, 1
    s_mov_b64 exec, 1
    buffer_atomic_add v21, v20, s[52:55], s74 offen sc1
    s_mov_b64 exec, -1
    s_waitcnt vmcnt(1)
L_x1:
    s_setprio 0
    s_waitcnt lgkmcnt(0)
    s_barrier
    ds_read_b64 v[28:29], v254
    ds_read_b64 v[30:31], v254 offset:8
    ds_read_b64 v[32:33], v255 offset:32
    v_mov_b32 v12, 124160
    ds_read_b32 v26, v12
    s_lshl_b32 s74, s67, 6
    s_add_u32 s74, s74, 123904
    v_lshl_add_u32 v13, v3, 2, s74
    ds_read_b32 v223, v13
    ds_read_b128 v[112:115], v245
    ds_read_b64 v[116:117], v248
    ds_read_b128 v[120:123], v245 offset:2688
    ds_read_b64 v[124:125], v248 offset:2688
    v_mov_b32 v128, 0
    v_mov_b32 v129, 0
    v_mov_b32 v130, 0
    v_mov_b32 v131, 0
    v_mov_b32 v132, 0
    v_mov_b32 v133, 0
    v_mov_b32 v134, 0
    v_mov_b32 v135, 0
    v_mov_b32 v136, 0
    v_mov_b32 v137, 0
    v_mov_b32 v138, 0
    v_mov_b32 v139, 0
    v_mov_b32 v140, 0
    v_mov_b32 v141, 0
    v_mov_b32 v142, 0
    v_mov_b32 v143, 0
    s_mov_b64 exec, s[90:91]
    ds_read_b128 v[128:131], v251
    ds_read_b128 v[132:135], v251 offset:672
    s_mov_b64 exec, -1
    s_add_u32 m0, s88, 138304
    s_add_u32 s74, s88, 13674496
    buffer_load_dwordx4 v9, s[52:55], s74 offen offset:0 sc1 lds
    buffer_load_dwordx4 v9, s[52:55], s74 offen offset:1024 sc1 lds
    buffer_load_dwordx4 v9, s[52:55], s74 offen offset:2048 sc1 lds
    s_waitcnt lgkmcnt(6)
    v_mov_b32 v12, 0
    v_dot2_f32_bf16 v12, v28, v28, v12
    v_dot2_f32_bf16 v12, v29, v29, v12
    v_dot2_f32_bf16 v12, v30, v30, v12
    v_dot2_f32_bf16 v12, v31, v31, v12
    v_mov_b32 v13, 0
    v_dot2_f32_bf16 v13, v32, v32, v13
    v_dot2_f32_bf16 v13, v33, v33, v13
    v_cmp_eq_u32 vcc, 0, v11
    s_nop 1
    v_cndmask_b32 v13, 0, v13, vcc
    v_add_f32 v12, v12, v13
    v_mov_b32 v13, v12
    s_nop 1
    v_permlane32_swap_b32 v12, v13
    v_add_f32 v12, v12, v13
    v_mul_f32 v12, v12, v26
    v_sqrt_f32 v12, v12
    s_nop 0
    v_mul_f32 v39, 0x3f8147ae, v12
    v_xor_b32 v12, 0x80000000, v39
    v_and_b32 v13, 0xffff0000, v12
    v_sub_f32 v12, v12, v13
    v_and_b32 v14, 0xffff0000, v12
    v_sub_f32 v12, v12, v14
    v_lshrrev_b32 v13, 16, v13
    v_or_b32 v13, v13, v14
    v_lshrrev_b32 v12, 16, v12
    v_cmp_eq_u32 vcc, 0, v11
    s_nop 1
    v_cndmask_b32 v32, v13, v32, vcc
    v_cndmask_b32 v33, v12, v33, vcc
    s_waitcnt lgkmcnt(4)
    v_mfma_f32_32x32x16_bf16 v[40:55], v[112:115], v[28:31], 0
    v_mfma_f32_32x32x8bf16_1k v[40:55], v[116:117], v[32:33], v[40:55]
    s_waitcnt lgkmcnt(0)
    s_setprio 2
    ds_read_b128 v[112:115], v245 offset:5376
    ds_read_b64 v[116:117], v248 offset:5376
    s_nop 7
    v_exp_f32 v40, v40
    v_exp_f32 v41, v41
    v_exp_f32 v42, v42
    v_exp_f32 v43, v43
    v_mfma_f32_32x32x16_bf16 v[56:71], v[120:123], v[28:31], 0
    s_mov_b64 exec, s[90:91]
    ds_read_b128 v[136:139], v251 offset:2688
    ds_read_b128 v[140:143], v251 offset:3360
    s_mov_b64 exec, -1
    s_cmp_eq_u32 s67, 3
    s_cbranch_scc1 L_spd_137
    s_mul_i32 s78, s67, 24240
    s_add_u32 s78, s78, 21504
    v_mov_b32 v232, 0
    v_mov_b32 v233, 0
    v_mov_b32 v234, 0
    v_mov_b32 v235, 0
    s_cmp_ge_u32 s64, 4
    s_cbranch_scc1 L_sp_136
    v_min_u32 v12, 19, v1
    v_mul_u32_u24 v13, 52, v12
    v_lshrrev_b32 v13, 8, v13
    v_mul_u32_u24 v14, 5, v13
    v_sub_u32 v12, v12, v14
    v_mul_u32_u24 v13, 4160, v13
    v_lshl_add_u32 v12, v12, 4, v13
    v_add_u32 v12, s78, v12
    ds_write_b128 v12, v[232:235] offset:4080
    v_lshlrev_b32 v13, 2, v1
    v_add_u32 v224, s78, v13
    v_add_u32 v225, 4160, v224
    v_add_u32 v226, 8316, v224
    v_add_u32 v227, 12476, v224
    s_branch L_spd_137
L_sp_136:
    s_add_u32 s78, s78, 16640
    v_add_u32 v12, s78, v9
    ds_write_b128 v12, v[232:235]
    ds_write_b128 v12, v[232:235] offset:1024
    v_min_u32 v13, 416, v9
    v_add_u32 v13, s78, v13
    ds_write_b128 v13, v[232:235] offset:2048
L_spd_137:
    v_exp_f32 v44, v44
    v_exp_f32 v45, v45
    v_exp_f32 v46, v46
    v_exp_f32 v47, v47
    v_mfma_f32_32x32x8bf16_1k v[56:71], v[124:125], v[32:33], v[56:71]
    v_cvt_pk_bf16_f32 v72, v40, v41
    v_cvt_pk_bf16_f32 v73, v42, v43
    v_cvt_pk_bf16_f32 v74, v44, v45
    v_cvt_pk_bf16_f32 v75, v46, v47
    v_exp_f32 v48, v48
    v_exp_f32 v49, v49
    v_mfma_f32_32x32x16_bf16 v[80:95], v[128:131], v[72:75], 0
    s_cmp_lt_u32 s64, 3
    s_cbranch_scc0 L_kc_138
    ds_write2st64_b32 v224, v188, v189 offset0:0 offset1:1
    ds_write2st64_b32 v225, v204, v205 offset0:0 offset1:1
    ds_write2st64_b32 v226, v188, v189 offset0:0 offset1:1
    ds_write2st64_b32 v227, v204, v205 offset0:0 offset1:1
    ds_write2st64_b32 v224, v190, v191 offset0:2 offset1:3
    ds_write2st64_b32 v225, v206, v207 offset0:2 offset1:3
    ds_write2st64_b32 v226, v190, v191 offset0:2 offset1:3
    ds_write2st64_b32 v227, v206, v207 offset0:2 offset1:3
L_kc_138:
    v_exp_f32 v50, v50
    v_exp_f32 v51, v51
    v_exp_f32 v52, v52
    v_exp_f32 v53, v53
    v_exp_f32 v54, v54
    v_exp_f32 v55, v55
    v_cvt_pk_bf16_f32 v76, v48, v49
    v_cvt_pk_bf16_f32 v77, v50, v51
    v_cvt_pk_bf16_f32 v78, v52, v53
    v_cvt_pk_bf16_f32 v79, v54, v55
    s_cmp_lt_u32 s64, 3
    s_cbranch_scc0 L_kc_139
    ds_write2st64_b32 v224, v192, v193 offset0:4 offset1:5
    ds_write2st64_b32 v225, v208, v209 offset0:4 offset1:5
    ds_write2st64_b32 v226, v192, v193 offset0:4 offset1:5
    ds_write2st64_b32 v227, v208, v209 offset0:4 offset1:5
    ds_write2st64_b32 v224, v194, v195 offset0:6 offset1:7
    ds_write2st64_b32 v225, v210, v211 offset0:6 offset1:7
    ds_write2st64_b32 v226, v194, v195 offset0:6 offset1:7
    ds_write2st64_b32 v227, v210, v211 offset0:6 offset1:7
L_kc_139:
    s_waitcnt lgkmcnt(0)
    v_mfma_f32_32x32x16_bf16 v[80:95], v[132:135], v[76:79], v[80:95]
    ds_read_b128 v[120:123], v245 offset:8064
    ds_read_b64 v[124:125], v248 offset:8064
    v_exp_f32 v56, v56
    v_exp_f32 v57, v57
    v_exp_f32 v58, v58
    v_exp_f32 v59, v59
    v_mfma_f32_32x32x16_bf16 v[40:55], v[112:115], v[28:31], 0
    s_mov_b64 exec, s[90:91]
    ds_read_b128 v[128:131], v251 offset:5376
    ds_read_b128 v[132:135], v251 offset:6048
    s_mov_b64 exec, -1
    s_mul_i32 s76, s81, 24240
    s_add_u32 s76, s76, 21504
    s_cmp_eq_u32 s82, 2
    s_cselect_b32 s75, 2048, 0
    s_sub_u32 s75, s76, s75
    s_add_u32 s75, s75, 14584
    v_and_b32 v12, 3, v10
    v_mul_u32_u24 v12, 4160, v12
    v_lshrrev_b32 v13, 2, v10
    v_lshl_add_u32 v12, v13, 3, v12
    v_sub_u32 v12, s75, v12
    v_lshl_add_u32 v37, v11, 4, v12
    s_cmp_eq_u32 s82, 1
    s_cselect_b32 s75, 2560, 0
    s_add_u32 s75, s75, s76
    s_add_u32 s75, s75, 16640
    v_mul_u32_u24 v12, 80, v10
    v_lshl_add_u32 v12, v11, 4, v12
    v_add_u32 v38, s75, v12
    v_exp_f32 v60, v60
    v_exp_f32 v61, v61
    v_exp_f32 v62, v62
    v_exp_f32 v63, v63
    v_mfma_f32_32x32x8bf16_1k v[40:55], v[116:117], v[32:33], v[40:55]
    v_cvt_pk_bf16_f32 v72, v56, v57
    v_cvt_pk_bf16_f32 v73, v58, v59
    v_cvt_pk_bf16_f32 v74, v60, v61
    v_cvt_pk_bf16_f32 v75, v62, v63
    v_exp_f32 v64, v64
    v_exp_f32 v65, v65
    v_mfma_f32_32x32x16_bf16 v[80:95], v[136:139], v[72:75], v[80:95]
    s_cmp_lt_u32 s64, 3
    s_cbranch_scc0 L_kc_140
    ds_write2st64_b32 v224, v196, v197 offset0:8 offset1:9
    ds_write2st64_b32 v225, v212, v213 offset0:8 offset1:9
    ds_write2st64_b32 v226, v196, v197 offset0:8 offset1:9
    ds_write2st64_b32 v227, v212, v213 offset0:8 offset1:9
    ds_write2st64_b32 v224, v198, v199 offset0:10 offset1:11
    ds_write2st64_b32 v225, v214, v215 offset0:10 offset1:11
    ds_write2st64_b32 v226, v198, v199 offset0:10 offset1:11
    ds_write2st64_b32 v227, v214, v215 offset0:10 offset1:11
L_kc_140:
    v_exp_f32 v66, v66
    v_exp_f32 v67, v67
    v_exp_f32 v68, v68
    v_exp_f32 v69, v69
    v_exp_f32 v70, v70
    v_exp_f32 v71, v71
    v_cvt_pk_bf16_f32 v76, v64, v65
    v_cvt_pk_bf16_f32 v77, v66, v67
    v_cvt_pk_bf16_f32 v78, v68, v69
    v_cvt_pk_bf16_f32 v79, v70, v71
    s_cmp_lt_u32 s64, 3
    s_cbranch_scc0 L_kc_141
    ds_write2st64_b32 v224, v200, v201 offset0:12 offset1:13
    ds_write2st64_b32 v225, v216, v217 offset0:12 offset1:13
    ds_write2st64_b32 v226, v200, v201 offset0:12 offset1:13
    ds_write2st64_b32 v227, v216, v217 offset0:12 offset1:13
    ds_write2st64_b32 v224, v202, v203 offset0:14 offset1:15
    ds_write2st64_b32 v225, v218, v219 offset0:14 offset1:15
    ds_write2st64_b32 v226, v202, v203 offset0:14 offset1:15
    ds_write2st64_b32 v227, v218, v219 offset0:14 offset1:15
L_kc_141:
    s_waitcnt lgkmcnt(0)
    s_setprio 1
    v_mfma_f32_32x32x16_bf16 v[80:95], v[140:143], v[76:79], v[80:95]
    ds_read_b128 v[112:115], v245 offset:10752
    ds_read_b64 v[116:117], v248 offset:10752
    v_exp_f32 v40, v40
    v_exp_f32 v41, v41
    v_exp_f32 v42, v42
    v_exp_f32 v43, v43
    v_mfma_f32_32x32x16_bf16 v[56:71], v[120:123], v[28:31], 0
    s_mov_b64 exec, s[90:91]
    ds_read_b128 v[136:139], v251 offset:8064
    ds_read_b128 v[140:143], v251 offset:8736
    s_mov_b64 exec, -1
    v_exp_f32 v44, v44
    v_exp_f32 v45, v45
    v_exp_f32 v46, v46
    v_exp_f32 v47, v47
    v_mfma_f32_32x32x8bf16_1k v[56:71], v[124:125], v[32:33], v[56:71]
    v_cvt_pk_bf16_f32 v72, v40, v41
    v_cvt_pk_bf16_f32 v73, v42, v43
    v_cvt_pk_bf16_f32 v74, v44, v45
    v_cvt_pk_bf16_f32 v75, v46, v47
    v_exp_f32 v48, v48
    v_exp_f32 v49, v49
    v_mfma_f32_32x32x16_bf16 v[80:95], v[128:131], v[72:75], v[80:95]
    v_exp_f32 v50, v50
    v_exp_f32 v51, v51
    v_exp_f32 v52, v52
    v_exp_f32 v53, v53
    v_exp_f32 v54, v54
    v_exp_f32 v55, v55
    v_cvt_pk_bf16_f32 v76, v48, v49
    v_cvt_pk_bf16_f32 v77, v50, v51
    v_cvt_pk_bf16_f32 v78, v52, v53
    v_cvt_pk_bf16_f32 v79, v54, v55
    s_waitcnt lgkmcnt(0)
    s_nop 0
    v_mfma_f32_32x32x16_bf16 v[80:95], v[132:135], v[76:79], v[80:95]
    ds_read_b128 v[120:123], v245 offset:13440
    ds_read_b64 v[124:125], v248 offset:13440
    v_exp_f32 v56, v56
    v_exp_f32 v57, v57
    v_exp_f32 v58, v58
    v_exp_f32 v59, v59
    v_mfma_f32_32x32x16_bf16 v[40:55], v[112:115], v[28:31], 0
    s_mov_b64 exec, s[90:91]
    ds_read_b128 v[128:131], v251 offset:10752
    ds_read_b128 v[132:135], v251 offset:11424
    s_mov_b64 exec, -1
    s_cmp_lg_u32 s64, 3
    s_cbranch_scc1 L_f2p_142
    v_min_u32 v237, 7, v1
    v_lshlrev_b32 v237, 7, v237
    s_mov_b32 s74, 14049280
    buffer_load_dword v237, v237, s[52:55], s74 offen sc1
L_f2p_142:
    v_exp_f32 v60, v60
    v_exp_f32 v61, v61
    v_exp_f32 v62, v62
    v_exp_f32 v63, v63
    v_mfma_f32_32x32x8bf16_1k v[40:55], v[116:117], v[32:33], v[40:55]
    v_cvt_pk_bf16_f32 v72, v56, v57
    v_cvt_pk_bf16_f32 v73, v58, v59
    v_cvt_pk_bf16_f32 v74, v60, v61
    v_cvt_pk_bf16_f32 v75, v62, v63
    v_exp_f32 v64, v64
    v_exp_f32 v65, v65
    v_mfma_f32_32x32x16_bf16 v[80:95], v[136:139], v[72:75], v[80:95]
    v_exp_f32 v66, v66
    v_exp_f32 v67, v67
    v_exp_f32 v68, v68
    v_exp_f32 v69, v69
    v_exp_f32 v70, v70
    v_exp_f32 v71, v71
    v_cvt_pk_bf16_f32 v76, v64, v65
    v_cvt_pk_bf16_f32 v77, v66, v67
    v_cvt_pk_bf16_f32 v78, v68, v69
    v_cvt_pk_bf16_f32 v79, v70, v71
    s_waitcnt lgkmcnt(0)
    s_setprio 0
    v_mfma_f32_32x32x16_bf16 v[80:95], v[140:143], v[76:79], v[80:95]
    ds_read_b128 v[112:115], v245 offset:16128
    ds_read_b64 v[116:117], v248 offset:16128
    v_exp_f32 v40, v40
    v_exp_f32 v41, v41
    v_exp_f32 v42, v42
    v_exp_f32 v43, v43
    v_mfma_f32_32x32x16_bf16 v[56:71], v[120:123], v[28:31], 0
    s_mov_b64 exec, s[90:91]
    ds_read_b128 v[136:139], v251 offset:13440
    ds_read_b128 v[140:143], v251 offset:14112
    s_mov_b64 exec, -1
    v_exp_f32 v44, v44
    v_exp_f32 v45, v45
    v_exp_f32 v46, v46
    v_exp_f32 v47, v47
    v_mfma_f32_32x32x8bf16_1k v[56:71], v[124:125], v[32:33], v[56:71]
    v_cvt_pk_bf16_f32 v72, v40, v41
    v_cvt_pk_bf16_f32 v73, v42, v43
    v_cvt_pk_bf16_f32 v74, v44, v45
    v_cvt_pk_bf16_f32 v75, v46, v47
    v_exp_f32 v48, v48
    v_exp_f32 v49, v49
    v_mfma_f32_32x32x16_bf16 v[80:95], v[128:131], v[72:75], v[80:95]
    v_exp_f32 v50, v50
    v_exp_f32 v51, v51
    v_exp_f32 v52, v52
    v_exp_f32 v53, v53
    v_exp_f32 v54, v54
    v_exp_f32 v55, v55
    v_cvt_pk_bf16_f32 v76, v48, v49
    v_cvt_pk_bf16_f32 v77, v50, v51
    v_cvt_pk_bf16_f32 v78, v52, v53
    v_cvt_pk_bf16_f32 v79, v54, v55
    s_waitcnt lgkmcnt(0)
    s_nop 0
    v_mfma_f32_32x32x16_bf16 v[80:95], v[132:135], v[76:79], v[80:95]
    ds_read_b128 v[120:123], v245 offset:18816
    ds_read_b64 v[124:125], v248 offset:18816
    v_exp_f32 v56, v56
    v_exp_f32 v57, v57
    v_exp_f32 v58, v58
    v_exp_f32 v59, v59
    v_mfma_f32_32x32x16_bf16 v[40:55], v[112:115], v[28:31], 0
    s_mov_b64 exec, s[90:91]
    ds_read_b128 v[128:131], v251 offset:16128
    ds_read_b128 v[132:135], v251 offset:16800
    s_mov_b64 exec, -1
    v_exp_f32 v60, v60
    v_exp_f32 v61, v61
    v_exp_f32 v62, v62
    v_exp_f32 v63, v63
    v_mfma_f32_32x32x8bf16_1k v[40:55], v[116:117], v[32:33], v[40:55]
    v_cvt_pk_bf16_f32 v72, v56, v57
    v_cvt_pk_bf16_f32 v73, v58, v59
    v_cvt_pk_bf16_f32 v74, v60, v61
    v_cvt_pk_bf16_f32 v75, v62, v63
    v_exp_f32 v64, v64
    v_exp_f32 v65, v65
    v_mfma_f32_32x32x16_bf16 v[80:95], v[136:139], v[72:75], v[80:95]
    v_exp_f32 v66, v66
    v_exp_f32 v67, v67
    v_exp_f32 v68, v68
    v_exp_f32 v69, v69
    v_exp_f32 v70, v70
    v_exp_f32 v71, v71
    v_cvt_pk_bf16_f32 v76, v64, v65
    v_cvt_pk_bf16_f32 v77, v66, v67
    v_cvt_pk_bf16_f32 v78, v68, v69
    v_cvt_pk_bf16_f32 v79, v70, v71
    s_cmp_lg_u32 s64, 3
    s_cbranch_scc1 L_f2ok
    s_waitcnt vmcnt(0)
    v_cmp_ne_u32 vcc, 32, v237
    s_cbranch_vccnz L_f2wait
L_f2ok:
    s_waitcnt vmcnt(0) lgkmcnt(0)
    s_barrier
    s_setprio 3
    v_mfma_f32_32x32x16_bf16 v[80:95], v[140:143], v[76:79], v[80:95]
    ds_read_b128 v[112:115], v246 offset:0
    ds_read_b64 v[116:117], v249 offset:0
    v_exp_f32 v40, v40
    v_exp_f32 v41, v41
    v_exp_f32 v42, v42
    v_exp_f32 v43, v43
    v_mfma_f32_32x32x16_bf16 v[56:71], v[120:123], v[28:31], 0
    s_mov_b64 exec, s[90:91]
    ds_read_b128 v[136:139], v251 offset:18816
    ds_read_b128 v[140:143], v251 offset:19488
    s_mov_b64 exec, -1
    v_exp_f32 v44, v44
    v_exp_f32 v45, v45
    v_exp_f32 v46, v46
    v_exp_f32 v47, v47
    v_mfma_f32_32x32x8bf16_1k v[56:71], v[124:125], v[32:33], v[56:71]
    v_cvt_pk_bf16_f32 v72, v40, v41
    v_cvt_pk_bf16_f32 v73, v42, v43
    v_cvt_pk_bf16_f32 v74, v44, v45
    v_cvt_pk_bf16_f32 v75, v46, v47
    v_exp_f32 v48, v48
    v_exp_f32 v49, v49
    v_mfma_f32_32x32x16_bf16 v[80:95], v[128:131], v[72:75], v[80:95]
    s_add_u32 m0, s88, 0
    s_add_u32 s74, s88, 13717504
    buffer_load_dwordx4 v9, s[52:55], s74 offen offset:0 sc1 lds
    buffer_load_dwordx4 v9, s[52:55], s74 offen offset:1024 sc1 lds
    buffer_load_dwordx4 v9, s[52:55], s74 offen offset:2048 sc1 lds
    v_exp_f32 v50, v50
    v_exp_f32 v51, v51
    v_exp_f32 v52, v52
    v_exp_f32 v53, v53
    v_exp_f32 v54, v54
    v_exp_f32 v55, v55
    v_cvt_pk_bf16_f32 v76, v48, v49
    v_cvt_pk_bf16_f32 v77, v50, v51
    v_cvt_pk_bf16_f32 v78, v52, v53
    v_cvt_pk_bf16_f32 v79, v54, v55
    s_cmp_ge_u32 s64, 5
    s_cbranch_scc1 L_nout_143
    s_lshl_b32 s75, s64, 10
    s_lshl_b32 s74, s71, 12
    s_add_u32 s74, s74, 6291456
    s_add_u32 m0, s75, 40624
    s_nop 0
    buffer_load_dwordx4 v244, s[52:55], s74 offen sc1 lds
    s_lshl_b32 s74, s72, 12
    s_add_u32 s74, s74, 6291456
    s_add_u32 m0, s75, 64864
    s_nop 0
    buffer_load_dwordx4 v244, s[52:55], s74 offen sc1 lds
    s_lshl_b32 s74, s73, 12
    s_add_u32 s74, s74, 6291456
    s_add_u32 m0, s75, 89104
    s_nop 0
    buffer_load_dwordx4 v244, s[52:55], s74 offen sc1 lds
L_nout_143:
    s_waitcnt lgkmcnt(0)
    v_mfma_f32_32x32x16_bf16 v[80:95], v[132:135], v[76:79], v[80:95]
    ds_read_b128 v[120:123], v246 offset:2688
    ds_read_b64 v[124:125], v249 offset:2688
    v_exp_f32 v56, v56
    v_exp_f32 v57, v57
    v_exp_f32 v58, v58
    v_exp_f32 v59, v59
    v_mfma_f32_32x32x16_bf16 v[40:55], v[112:115], v[28:31], 0
    s_mov_b64 exec, s[90:91]
    ds_read_b128 v[128:131], v252 offset:0
    ds_read_b128 v[132:135], v252 offset:672
    s_mov_b64 exec, -1
    v_exp_f32 v60, v60
    v_exp_f32 v61, v61
    v_exp_f32 v62, v62
    v_exp_f32 v63, v63
    v_mfma_f32_32x32x8bf16_1k v[40:55], v[116:117], v[32:33], v[40:55]
    v_cvt_pk_bf16_f32 v72, v56, v57
    v_cvt_pk_bf16_f32 v73, v58, v59
    v_cvt_pk_bf16_f32 v74, v60, v61
    v_cvt_pk_bf16_f32 v75, v62, v63
    v_exp_f32 v64, v64
    v_exp_f32 v65, v65
    v_mfma_f32_32x32x16_bf16 v[80:95], v[136:139], v[72:75], v[80:95]
    s_and_b32 s75, s2, 0xc7
    s_lshl_b32 s75, s75, 2
    s_add_u32 s75, s75, 14045184
    v_and_b32 v237, 7, v1
    v_lshlrev_b32 v237, 5, v237
    buffer_load_dword v237, v237, s[52:55], s75 offen sc1
    v_exp_f32 v66, v66
    v_exp_f32 v67, v67
    v_exp_f32 v68, v68
    v_exp_f32 v69, v69
    v_exp_f32 v70, v70
    v_exp_f32 v71, v71
    v_cvt_pk_bf16_f32 v76, v64, v65
    v_cvt_pk_bf16_f32 v77, v66, v67
    v_cvt_pk_bf16_f32 v78, v68, v69
    v_cvt_pk_bf16_f32 v79, v70, v71
    s_waitcnt lgkmcnt(0)
    s_setprio 2
    v_mfma_f32_32x32x16_bf16 v[80:95], v[140:143], v[76:79], v[80:95]
    ds_read_b128 v[112:115], v246 offset:5376
    ds_read_b64 v[116:117], v249 offset:5376
    v_exp_f32 v40, v40
    v_exp_f32 v41, v41
    v_exp_f32 v42, v42
    v_exp_f32 v43, v43
    v_mfma_f32_32x32x16_bf16 v[56:71], v[120:123], v[28:31], 0
    s_mov_b64 exec, s[90:91]
    ds_read_b128 v[136:139], v252 offset:2688
    ds_read_b128 v[140:143], v252 offset:3360
    s_mov_b64 exec, -1
    v_exp_f32 v44, v44
    v_exp_f32 v45, v45
    v_exp_f32 v46, v46
    v_exp_f32 v47, v47
    v_mfma_f32_32x32x8bf16_1k v[56:71], v[124:125], v[32:33], v[56:71]
    v_cvt_pk_bf16_f32 v72, v40, v41
    v_cvt_pk_bf16_f32 v73, v42, v43
    v_cvt_pk_bf16_f32 v74, v44, v45
    v_cvt_pk_bf16_f32 v75, v46, v47
    v_exp_f32 v48, v48
    v_exp_f32 v49, v49
    v_mfma_f32_32x32x16_bf16 v[80:95], v[128:131], v[72:75], v[80:95]
    v_exp_f32 v50, v50
    v_exp_f32 v51, v51
    v_exp_f32 v52, v52
    v_exp_f32 v53, v53
    v_exp_f32 v54, v54
    v_exp_f32 v55, v55
    v_cvt_pk_bf16_f32 v76, v48, v49
    v_cvt_pk_bf16_f32 v77, v50, v51
    v_cvt_pk_bf16_f32 v78, v52, v53
    v_cvt_pk_bf16_f32 v79, v54, v55
    s_waitcnt lgkmcnt(0)
    s_nop 0
    v_mfma_f32_32x32x16_bf16 v[80:95], v[132:135], v[76:79], v[80:95]
    ds_read_b128 v[120:123], v246 offset:8064
    ds_read_b64 v[124:125], v249 offset:8064
    v_exp_f32 v56, v56
    v_exp_f32 v57, v57
    v_exp_f32 v58, v58
    v_exp_f32 v59, v59
    v_mfma_f32_32x32x16_bf16 v[40:55], v[112:115], v[28:31], 0
    s_mov_b64 exec, s[90:91]
    ds_read_b128 v[128:131], v252 offset:5376
    ds_read_b128 v[132:135], v252 offset:6048
    s_mov_b64 exec, -1
    v_exp_f32 v60, v60
    v_exp_f32 v61, v61
    v_exp_f32 v62, v62
    v_exp_f32 v63, v63
    v_mfma_f32_32x32x8bf16_1k v[40:55], v[116:117], v[32:33], v[40:55]
    v_cvt_pk_bf16_f32 v72, v56, v57
    v_cvt_pk_bf16_f32 v73, v58, v59
    v_cvt_pk_bf16_f32 v74, v60, v61
    v_cvt_pk_bf16_f32 v75, v62, v63
    v_exp_f32 v64, v64
    v_exp_f32 v65, v65
    v_mfma_f32_32x32x16_bf16 v[80:95], v[136:139], v[72:75], v[80:95]
    v_exp_f32 v66, v66
    v_exp_f32 v67, v67
    v_exp_f32 v68, v68
    v_exp_f32 v69, v69
    v_exp_f32 v70, v70
    v_exp_f32 v71, v71
    v_cvt_pk_bf16_f32 v76, v64, v65
    v_cvt_pk_bf16_f32 v77, v66, v67
    v_cvt_pk_bf16_f32 v78, v68, v69
    v_cvt_pk_bf16_f32 v79, v70, v71
    s_waitcnt vmcnt(0) lgkmcnt(0)
    s_barrier
    s_setprio 1
    v_mfma_f32_32x32x16_bf16 v[80:95], v[140:143], v[76:79], v[80:95]
    ds_read_b128 v[112:115], v246 offset:10752
    ds_read_b64 v[116:117], v249 offset:10752
    v_exp_f32 v40, v40
    v_exp_f32 v41, v41
    v_exp_f32 v42, v42
    v_exp_f32 v43, v43
    v_mfma_f32_32x32x16_bf16 v[56:71], v[120:123], v[28:31], 0
    s_mov_b64 exec, s[90:91]
    ds_read_b128 v[136:139], v252 offset:8064
    ds_read_b128 v[140:143], v252 offset:8736
    s_mov_b64 exec, -1
    s_getreg_b32 s75, hwreg(HW_REG_XCC_ID)
    s_add_u32 s75, s75, 1
    v_cmp_ne_u32 vcc, s75, v237
    s_nop 0
    s_cmp_eq_u64 vcc, 0
    s_cselect_b32 s80, 1, 0
    v_exp_f32 v44, v44
    v_exp_f32 v45, v45
    v_exp_f32 v46, v46
    v_exp_f32 v47, v47
    v_mfma_f32_32x32x8bf16_1k v[56:71], v[124:125], v[32:33], v[56:71]
    ds_read2_b64 v[144:147], v37 offset0:252 offset1:253
    ds_read_b128 v[148:151], v38 offset:2512
    v_cvt_pk_bf16_f32 v72, v40, v41
    v_cvt_pk_bf16_f32 v73, v42, v43
    v_cvt_pk_bf16_f32 v74, v44, v45
    v_cvt_pk_bf16_f32 v75, v46, v47
    v_exp_f32 v48, v48
    v_exp_f32 v49, v49
    v_mfma_f32_32x32x16_bf16 v[80:95], v[128:131], v[72:75], v[80:95]
    v_exp_f32 v50, v50
    v_exp_f32 v51, v51
    v_exp_f32 v52, v52
    v_exp_f32 v53, v53
    v_exp_f32 v54, v54
    v_exp_f32 v55, v55
    v_cvt_pk_bf16_f32 v76, v48, v49
    v_cvt_pk_bf16_f32 v77, v50, v51
    v_cvt_pk_bf16_f32 v78, v52, v53
    v_cvt_pk_bf16_f32 v79, v54, v55
    s_waitcnt lgkmcnt(0)
    s_nop 0
    v_mfma_f32_32x32x16_bf16 v[80:95], v[132:135], v[76:79], v[80:95]
    ds_read_b128 v[120:123], v246 offset:13440
    ds_read_b64 v[124:125], v249 offset:13440
    v_exp_f32 v56, v56
    v_exp_f32 v57, v57
    v_exp_f32 v58, v58
    v_exp_f32 v59, v59
    v_mfma_f32_32x32x16_bf16 v[40:55], v[112:115], v[28:31], 0
    s_mov_b64 exec, s[90:91]
    ds_read_b128 v[128:131], v252 offset:10752
    ds_read_b128 v[132:135], v252 offset:11424
    s_mov_b64 exec, -1
    v_exp_f32 v60, v60
    v_exp_f32 v61, v61
    v_exp_f32 v62, v62
    v_exp_f32 v63, v63
    v_mfma_f32_32x32x8bf16_1k v[40:55], v[116:117], v[32:33], v[40:55]
    ds_read2_b64 v[152:155], v37 offset0:248 offset1:249
    ds_read_b128 v[156:159], v38 offset:2480
    v_cvt_pk_bf16_f32 v72, v56, v57
    v_cvt_pk_bf16_f32 v73, v58, v59
    v_cvt_pk_bf16_f32 v74, v60, v61
    v_cvt_pk_bf16_f32 v75, v62, v63
    v_exp_f32 v64, v64
    v_exp_f32 v65, v65
    v_mfma_f32_32x32x16_bf16 v[80:95], v[136:139], v[72:75], v[80:95]
    ds_read2_b64 v[160:163], v37 offset0:244 offset1:245
    ds_read_b128 v[164:167], v38 offset:2432
    v_exp_f32 v66, v66
    v_exp_f32 v67, v67
    v_exp_f32 v68, v68
    v_exp_f32 v69, v69
    v_mfma_f32_32x32x16_bf16 v[96:111], v[144:147], v[148:151], 0
    v_exp_f32 v70, v70
    v_exp_f32 v71, v71
    v_cvt_pk_bf16_f32 v76, v64, v65
    v_cvt_pk_bf16_f32 v77, v66, v67
    v_cvt_pk_bf16_f32 v78, v68, v69
    v_cvt_pk_bf16_f32 v79, v70, v71
    v_mov_b32 v232, -1
    v_mov_b32 v233, -1
    v_mov_b32 v234, -1
    v_mov_b32 v235, -1
    s_lshl_b32 s76, s64, 6
    s_add_u32 s76, s76, 0
    v_add_u32 v12, s76, v1
    v_mul_u32_u24 v13, 410, v12
    v_lshrrev_b32 v13, 16, v13
    v_mul_u32_u24 v14, 160, v13
    v_sub_u32 v12, v12, v14
    v_mul_u32_u24 v13, 20480, v13
    v_lshl_add_u32 v12, v12, 4, v13
    s_mul_i32 s76, s65, 81920
    s_mul_i32 s77, s66, 2560
    s_add_u32 s76, s76, s77
    s_add_u32 s76, s76, 3145728
    buffer_store_dwordx4 v[232:235], v12, s[52:55], s76 offen sc1
    s_waitcnt lgkmcnt(0)
    s_setprio 0
    v_mfma_f32_32x32x16_bf16 v[80:95], v[140:143], v[76:79], v[80:95]
    ds_read_b128 v[112:115], v246 offset:16128
    ds_read_b64 v[116:117], v249 offset:16128
    v_exp_f32 v40, v40
    v_exp_f32 v41, v41
    v_exp_f32 v42, v42
    v_exp_f32 v43, v43
    v_mfma_f32_32x32x16_bf16 v[56:71], v[120:123], v[28:31], 0
    s_mov_b64 exec, s[90:91]
    ds_read_b128 v[136:139], v252 offset:13440
    ds_read_b128 v[140:143], v252 offset:14112
    s_mov_b64 exec, -1
    v_exp_f32 v44, v44
    v_exp_f32 v45, v45
    v_exp_f32 v46, v46
    v_exp_f32 v47, v47
    v_mfma_f32_32x32x8bf16_1k v[56:71], v[124:125], v[32:33], v[56:71]
    ds_read2_b64 v[168:171], v37 offset0:240 offset1:241
    ds_read_b128 v[172:175], v38 offset:2400
    v_cvt_pk_bf16_f32 v72, v40, v41
    v_cvt_pk_bf16_f32 v73, v42, v43
    v_cvt_pk_bf16_f32 v74, v44, v45
    v_cvt_pk_bf16_f32 v75, v46, v47
    v_exp_f32 v48, v48
    v_exp_f32 v49, v49
    v_mfma_f32_32x32x16_bf16 v[80:95], v[128:131], v[72:75], v[80:95]
    ds_read2_b64 v[144:147], v37 offset0:236 offset1:237
    ds_read_b128 v[148:151], v38 offset:2352
    v_exp_f32 v50, v50
    v_exp_f32 v51, v51
    v_exp_f32 v52, v52
    v_exp_f32 v53, v53
    v_mfma_f32_32x32x16_bf16 v[96:111], v[152:155], v[156:159], v[96:111]
    v_exp_f32 v54, v54
    v_exp_f32 v55, v55
    v_mfma_f32_32x32x16_bf16 v[96:111], v[160:163], v[164:167], v[96:111]
    v_cvt_pk_bf16_f32 v76, v48, v49
    v_cvt_pk_bf16_f32 v77, v50, v51
    v_cvt_pk_bf16_f32 v78, v52, v53
    v_cvt_pk_bf16_f32 v79, v54, v55
    v_mov_b32 v232, -1
    v_mov_b32 v233, -1
    v_mov_b32 v234, -1
    v_mov_b32 v235, -1
    s_cmp_ge_u32 s64, 2
    s_cbranch_scc1 L_fy_146
    s_lshl_b32 s76, s64, 6
    s_add_u32 s76, s76, 512
    v_add_u32 v12, s76, v1
    v_mul_u32_u24 v13, 410, v12
    v_lshrrev_b32 v13, 16, v13
    v_mul_u32_u24 v14, 160, v13
    v_sub_u32 v12, v12, v14
    v_mul_u32_u24 v13, 20480, v13
    v_lshl_add_u32 v12, v12, 4, v13
    s_mul_i32 s76, s65, 81920
    s_mul_i32 s77, s66, 2560
    s_add_u32 s76, s76, s77
    s_add_u32 s76, s76, 3145728
    buffer_store_dwordx4 v[232:235], v12, s[52:55], s76 offen sc1
    s_branch L_fd_147
L_fy_146:
    s_add_u32 s76, s64, 14
    s_sub_u32 s76, s76, 16
    s_min_u32 s76, s76, 9
    s_lshr_b32 s77, s76, 2
    s_cmp_eq_u32 s77, 0
    s_cselect_b32 s78, s71, s73
    s_cmp_eq_u32 s77, 1
    s_cselect_b32 s78, s72, s78
    s_lshl_b32 s78, s78, 12
    s_and_b32 s76, s76, 3
    s_lshl_b32 s79, s70, 1
    s_cmp_eq_u32 s77, 2
    s_cselect_b32 s79, s79, 0
    s_add_u32 s76, s76, s79
    s_lshl_b32 s76, s76, 10
    s_add_u32 s76, s76, s78
    s_add_u32 s76, s76, 10485760
    buffer_store_dwordx4 v[232:235], v9, s[52:55], s76 offen sc1
L_fd_147:
    s_waitcnt lgkmcnt(0)
    v_mfma_f32_32x32x16_bf16 v[80:95], v[132:135], v[76:79], v[80:95]
    ds_read_b128 v[120:123], v246 offset:18816
    ds_read_b64 v[124:125], v249 offset:18816
    v_exp_f32 v56, v56
    v_exp_f32 v57, v57
    v_exp_f32 v58, v58
    v_exp_f32 v59, v59
    v_mfma_f32_32x32x16_bf16 v[40:55], v[112:115], v[28:31], 0
    s_mov_b64 exec, s[90:91]
    ds_read_b128 v[128:131], v252 offset:16128
    ds_read_b128 v[132:135], v252 offset:16800
    s_mov_b64 exec, -1
    v_exp_f32 v60, v60
    v_exp_f32 v61, v61
    v_exp_f32 v62, v62
    v_exp_f32 v63, v63
    v_mfma_f32_32x32x8bf16_1k v[40:55], v[116:117], v[32:33], v[40:55]
    ds_read2_b64 v[152:155], v37 offset0:232 offset1:233
    ds_read_b128 v[156:159], v38 offset:2320
    v_cvt_pk_bf16_f32 v72, v56, v57
    v_cvt_pk_bf16_f32 v73, v58, v59
    v_cvt_pk_bf16_f32 v74, v60, v61
    v_cvt_pk_bf16_f32 v75, v62, v63
    v_exp_f32 v64, v64
    v_exp_f32 v65, v65
    v_mfma_f32_32x32x16_bf16 v[80:95], v[136:139], v[72:75], v[80:95]
    ds_read2_b64 v[160:163], v37 offset0:228 offset1:229
    ds_read_b128 v[164:167], v38 offset:2272
    v_exp_f32 v66, v66
    v_exp_f32 v67, v67
    v_exp_f32 v68, v68
    v_exp_f32 v69, v69
    v_mfma_f32_32x32x16_bf16 v[96:111], v[168:171], v[172:175], v[96:111]
    v_exp_f32 v70, v70
    v_exp_f32 v71, v71
    v_mfma_f32_32x32x16_bf16 v[96:111], v[144:147], v[148:151], v[96:111]
    v_cvt_pk_bf16_f32 v76, v64, v65
    v_cvt_pk_bf16_f32 v77, v66, v67
    v_cvt_pk_bf16_f32 v78, v68, v69
    v_cvt_pk_bf16_f32 v79, v70, v71
    v_mov_b32 v232, -1
    v_mov_b32 v233, -1
    v_mov_b32 v234, -1
    v_mov_b32 v235, -1
L_fy_148:
    s_add_u32 s76, s64, 22
    s_sub_u32 s76, s76, 16
    s_min_u32 s76, s76, 9
    s_lshr_b32 s77, s76, 2
    s_cmp_eq_u32 s77, 0
    s_cselect_b32 s78, s71, s73
    s_cmp_eq_u32 s77, 1
    s_cselect_b32 s78, s72, s78
    s_lshl_b32 s78, s78, 12
    s_and_b32 s76, s76, 3
    s_lshl_b32 s79, s70, 1
    s_cmp_eq_u32 s77, 2
    s_cselect_b32 s79, s79, 0
    s_add_u32 s76, s76, s79
    s_lshl_b32 s76, s76, 10
    s_add_u32 s76, s76, s78
    s_add_u32 s76, s76, 10485760
    buffer_store_dwordx4 v[232:235], v9, s[52:55], s76 offen sc1
L_fd_149:
    s_waitcnt vmcnt(3) lgkmcnt(0)
    s_barrier
    s_setprio 3
    v_mfma_f32_32x32x16_bf16 v[80:95], v[140:143], v[76:79], v[80:95]
    ds_read_b128 v[112:115], v247 offset:0
    ds_read_b64 v[116:117], v250 offset:0
    v_exp_f32 v40, v40
    v_exp_f32 v41, v41
    v_exp_f32 v42, v42
    v_exp_f32 v43, v43
    v_mfma_f32_32x32x16_bf16 v[56:71], v[120:123], v[28:31], 0
    s_mov_b64 exec, s[90:91]
    ds_read_b128 v[136:139], v252 offset:18816
    ds_read_b128 v[140:143], v252 offset:19488
    s_mov_b64 exec, -1
    v_exp_f32 v44, v44
    v_exp_f32 v45, v45
    v_exp_f32 v46, v46
    v_exp_f32 v47, v47
    v_mfma_f32_32x32x8bf16_1k v[56:71], v[124:125], v[32:33], v[56:71]
    ds_read2_b64 v[168:171], v37 offset0:224 offset1:225
    ds_read_b128 v[172:175], v38 offset:2240
    v_cvt_pk_bf16_f32 v72, v40, v41
    v_cvt_pk_bf16_f32 v73, v42, v43
    v_cvt_pk_bf16_f32 v74, v44, v45
    v_cvt_pk_bf16_f32 v75, v46, v47
    v_exp_f32 v48, v48
    v_exp_f32 v49, v49
    v_mfma_f32_32x32x16_bf16 v[80:95], v[128:131], v[72:75], v[80:95]
    s_add_u32 m0, s88, 102400
    s_add_u32 s74, s88, 13760512
    buffer_load_dwordx4 v9, s[52:55], s74 offen offset:0 sc1 lds
    buffer_load_dwordx4 v9, s[52:55], s74 offen offset:1024 sc1 lds
    buffer_load_dwordx4 v9, s[52:55], s74 offen offset:2048 sc1 lds
    ds_read2_b64 v[144:147], v37 offset0:220 offset1:221
    ds_read_b128 v[148:151], v38 offset:2192
    v_exp_f32 v50, v50
    v_exp_f32 v51, v51
    v_exp_f32 v52, v52
    v_exp_f32 v53, v53
    v_mfma_f32_32x32x16_bf16 v[96:111], v[152:155], v[156:159], v[96:111]
    v_exp_f32 v54, v54
    v_exp_f32 v55, v55
    v_mfma_f32_32x32x16_bf16 v[96:111], v[160:163], v[164:167], v[96:111]
    v_cvt_pk_bf16_f32 v76, v48, v49
    v_cvt_pk_bf16_f32 v77, v50, v51
    v_cvt_pk_bf16_f32 v78, v52, v53
    v_cvt_pk_bf16_f32 v79, v54, v55
    s_waitcnt lgkmcnt(0)
    s_nop 0
    v_mfma_f32_32x32x16_bf16 v[80:95], v[132:135], v[76:79], v[80:95]
    ds_read_b128 v[120:123], v247 offset:2688
    ds_read_b64 v[124:125], v250 offset:2688
    v_exp_f32 v56, v56
    v_exp_f32 v57, v57
    v_exp_f32 v58, v58
    v_exp_f32 v59, v59
    v_mfma_f32_32x32x16_bf16 v[40:55], v[112:115], v[28:31], 0
    s_mov_b64 exec, s[90:91]
    ds_read_b128 v[128:131], v253 offset:0
    ds_read_b128 v[132:135], v253 offset:672
    s_mov_b64 exec, -1
    v_exp_f32 v60, v60
    v_exp_f32 v61, v61
    v_exp_f32 v62, v62
    v_exp_f32 v63, v63
    v_mfma_f32_32x32x8bf16_1k v[40:55], v[116:117], v[32:33], v[40:55]
    ds_read2_b64 v[152:155], v37 offset0:216 offset1:217
    ds_read_b128 v[156:159], v38 offset:2160
    v_cvt_pk_bf16_f32 v72, v56, v57
    v_cvt_pk_bf16_f32 v73, v58, v59
    v_cvt_pk_bf16_f32 v74, v60, v61
    v_cvt_pk_bf16_f32 v75, v62, v63
    v_exp_f32 v64, v64
    v_exp_f32 v65, v65
    v_mfma_f32_32x32x16_bf16 v[80:95], v[136:139], v[72:75], v[80:95]
    ds_read2_b64 v[160:163], v37 offset0:212 offset1:213
    ds_read_b128 v[164:167], v38 offset:2112
    v_exp_f32 v66, v66
    v_exp_f32 v67, v67
    v_exp_f32 v68, v68
    v_exp_f32 v69, v69
    v_mfma_f32_32x32x16_bf16 v[96:111], v[168:171], v[172:175], v[96:111]
    v_exp_f32 v70, v70
    v_exp_f32 v71, v71
    v_mfma_f32_32x32x16_bf16 v[96:111], v[144:147], v[148:151], v[96:111]
    v_cvt_pk_bf16_f32 v76, v64, v65
    v_cvt_pk_bf16_f32 v77, v66, v67
    v_cvt_pk_bf16_f32 v78, v68, v69
    v_cvt_pk_bf16_f32 v79, v70, v71
    s_waitcnt lgkmcnt(0)
    s_setprio 2
    v_mfma_f32_32x32x16_bf16 v[80:95], v[140:143], v[76:79], v[80:95]
    ds_read_b128 v[112:115], v247 offset:5376
    ds_read_b64 v[116:117], v250 offset:5376
    v_exp_f32 v40, v40
    v_exp_f32 v41, v41
    v_exp_f32 v42, v42
    v_exp_f32 v43, v43
    v_mfma_f32_32x32x16_bf16 v[56:71], v[120:123], v[28:31], 0
    s_mov_b64 exec, s[90:91]
    ds_read_b128 v[136:139], v253 offset:2688
    ds_read_b128 v[140:143], v253 offset:3360
    s_mov_b64 exec, -1
    v_exp_f32 v44, v44
    v_exp_f32 v45, v45
    v_exp_f32 v46, v46
    v_exp_f32 v47, v47
    v_mfma_f32_32x32x8bf16_1k v[56:71], v[124:125], v[32:33], v[56:71]
    ds_read2_b64 v[168:171], v37 offset0:208 offset1:209
    ds_read_b128 v[172:175], v38 offset:2080
    v_cvt_pk_bf16_f32 v72, v40, v41
    v_cvt_pk_bf16_f32 v73, v42, v43
    v_cvt_pk_bf16_f32 v74, v44, v45
    v_cvt_pk_bf16_f32 v75, v46, v47
    v_exp_f32 v48, v48
    v_exp_f32 v49, v49
    v_mfma_f32_32x32x16_bf16 v[80:95], v[128:131], v[72:75], v[80:95]
    v_exp_f32 v50, v50
    v_exp_f32 v51, v51
    v_exp_f32 v52, v52
    v_exp_f32 v53, v53
    v_mfma_f32_32x32x16_bf16 v[96:111], v[152:155], v[156:159], v[96:111]
    v_exp_f32 v54, v54
    v_exp_f32 v55, v55
    v_mfma_f32_32x32x16_bf16 v[96:111], v[160:163], v[164:167], v[96:111]
    v_cvt_pk_bf16_f32 v76, v48, v49
    v_cvt_pk_bf16_f32 v77, v50, v51
    v_cvt_pk_bf16_f32 v78, v52, v53
    v_cvt_pk_bf16_f32 v79, v54, v55
    s_waitcnt lgkmcnt(0)
    s_nop 0
    v_mfma_f32_32x32x16_bf16 v[80:95], v[132:135], v[76:79], v[80:95]
    ds_read_b128 v[120:123], v247 offset:8064
    ds_read_b64 v[124:125], v250 offset:8064
    v_exp_f32 v56, v56
    v_exp_f32 v57, v57
    v_exp_f32 v58, v58
    v_exp_f32 v59, v59
    v_mfma_f32_32x32x16_bf16 v[40:55], v[112:115], v[28:31], 0
    s_mov_b64 exec, s[90:91]
    ds_read_b128 v[128:131], v253 offset:5376
    ds_read_b128 v[132:135], v253 offset:6048
    s_mov_b64 exec, -1
    v_exp_f32 v60, v60
    v_exp_f32 v61, v61
    v_exp_f32 v62, v62
    v_exp_f32 v63, v63
    v_mfma_f32_32x32x8bf16_1k v[40:55], v[116:117], v[32:33], v[40:55]
    ds_read2_b64 v[144:147], v37 offset0:204 offset1:205
    ds_read_b128 v[148:151], v38 offset:2032
    v_cvt_pk_bf16_f32 v72, v56, v57
    v_cvt_pk_bf16_f32 v73, v58, v59
    v_cvt_pk_bf16_f32 v74, v60, v61
    v_cvt_pk_bf16_f32 v75, v62, v63
    v_exp_f32 v64, v64
    v_exp_f32 v65, v65
    v_mfma_f32_32x32x16_bf16 v[80:95], v[136:139], v[72:75], v[80:95]
    ds_read2_b64 v[152:155], v37 offset0:200 offset1:201
    ds_read_b128 v[156:159], v38 offset:2000
    v_exp_f32 v66, v66
    v_exp_f32 v67, v67
    v_exp_f32 v68, v68
    v_exp_f32 v69, v69
    v_mfma_f32_32x32x16_bf16 v[96:111], v[168:171], v[172:175], v[96:111]
    v_exp_f32 v70, v70
    v_exp_f32 v71, v71
    v_cvt_pk_bf16_f32 v76, v64, v65
    v_cvt_pk_bf16_f32 v77, v66, v67
    v_cvt_pk_bf16_f32 v78, v68, v69
    v_cvt_pk_bf16_f32 v79, v70, v71
    s_waitcnt lgkmcnt(0)
    s_setprio 1
    v_mfma_f32_32x32x16_bf16 v[80:95], v[140:143], v[76:79], v[80:95]
    ds_read_b128 v[112:115], v247 offset:10752
    ds_read_b64 v[116:117], v250 offset:10752
    v_exp_f32 v40, v40
    v_exp_f32 v41, v41
    v_exp_f32 v42, v42
    v_exp_f32 v43, v43
    v_mfma_f32_32x32x16_bf16 v[56:71], v[120:123], v[28:31], 0
    s_mov_b64 exec, s[90:91]
    ds_read_b128 v[136:139], v253 offset:8064
    ds_read_b128 v[140:143], v253 offset:8736
    s_mov_b64 exec, -1
    v_exp_f32 v44, v44
    v_exp_f32 v45, v45
    v_exp_f32 v46, v46
    v_exp_f32 v47, v47
    v_mfma_f32_32x32x8bf16_1k v[56:71], v[124:125], v[32:33], v[56:71]
    ds_read2_b64 v[160:163], v37 offset0:196 offset1:197
    ds_read_b128 v[164:167], v38 offset:1952
    v_cvt_pk_bf16_f32 v72, v40, v41
    v_cvt_pk_bf16_f32 v73, v42, v43
    v_cvt_pk_bf16_f32 v74, v44, v45
    v_cvt_pk_bf16_f32 v75, v46, v47
    v_exp_f32 v48, v48
    v_exp_f32 v49, v49
    v_mfma_f32_32x32x16_bf16 v[80:95], v[128:131], v[72:75], v[80:95]
    ds_read2_b64 v[168:171], v37 offset0:192 offset1:193
    ds_read_b128 v[172:175], v38 offset:1920
    v_exp_f32 v50, v50
    v_exp_f32 v51, v51
    v_exp_f32 v52, v52
    v_exp_f32 v53, v53
    v_mfma_f32_32x32x16_bf16 v[96:111], v[144:147], v[148:151], v[96:111]
    v_exp_f32 v54, v54
    v_exp_f32 v55, v55
    v_mfma_f32_32x32x16_bf16 v[96:111], v[152:155], v[156:159], v[96:111]
    v_cvt_pk_bf16_f32 v76, v48, v49
    v_cvt_pk_bf16_f32 v77, v50, v51
    v_cvt_pk_bf16_f32 v78, v52, v53
    v_cvt_pk_bf16_f32 v79, v54, v55
    s_waitcnt lgkmcnt(0)
    s_nop 0
    v_mfma_f32_32x32x16_bf16 v[80:95], v[132:135], v[76:79], v[80:95]
    ds_read_b128 v[120:123], v247 offset:13440
    ds_read_b64 v[124:125], v250 offset:13440
    v_exp_f32 v56, v56
    v_exp_f32 v57, v57
    v_exp_f32 v58, v58
    v_exp_f32 v59, v59
    v_mfma_f32_32x32x16_bf16 v[40:55], v[112:115], v[28:31], 0
    s_mov_b64 exec, s[90:91]
    ds_read_b128 v[128:131], v253 offset:10752
    ds_read_b128 v[132:135], v253 offset:11424
    s_mov_b64 exec, -1
    v_exp_f32 v60, v60
    v_exp_f32 v61, v61
    v_exp_f32 v62, v62
    v_exp_f32 v63, v63
    v_mfma_f32_32x32x8bf16_1k v[40:55], v[116:117], v[32:33], v[40:55]
    ds_read2_b64 v[144:147], v37 offset0:188 offset1:189
    ds_read_b128 v[148:151], v38 offset:1872
    v_cvt_pk_bf16_f32 v72, v56, v57
    v_cvt_pk_bf16_f32 v73, v58, v59
    v_cvt_pk_bf16_f32 v74, v60, v61
    v_cvt_pk_bf16_f32 v75, v62, v63
    v_exp_f32 v64, v64
    v_exp_f32 v65, v65
    v_mfma_f32_32x32x16_bf16 v[80:95], v[136:139], v[72:75], v[80:95]
    ds_read2_b64 v[152:155], v37 offset0:184 offset1:185
    ds_read_b128 v[156:159], v38 offset:1840
    v_exp_f32 v66, v66
    v_exp_f32 v67, v67
    v_exp_f32 v68, v68
    v_exp_f32 v69, v69
    v_mfma_f32_32x32x16_bf16 v[96:111], v[160:163], v[164:167], v[96:111]
    v_exp_f32 v70, v70
    v_exp_f32 v71, v71
    v_mfma_f32_32x32x16_bf16 v[96:111], v[168:171], v[172:175], v[96:111]
    v_cvt_pk_bf16_f32 v76, v64, v65
    v_cvt_pk_bf16_f32 v77, v66, v67
    v_cvt_pk_bf16_f32 v78, v68, v69
    v_cvt_pk_bf16_f32 v79, v70, v71
    s_waitcnt lgkmcnt(0)
    s_setprio 0
    v_mfma_f32_32x32x16_bf16 v[80:95], v[140:143], v[76:79], v[80:95]
    ds_read_b128 v[112:115], v247 offset:16128
    ds_read_b64 v[116:117], v250 offset:16128
    v_exp_f32 v40, v40
    v_exp_f32 v41, v41
    v_exp_f32 v42, v42
    v_exp_f32 v43, v43
    v_mfma_f32_32x32x16_bf16 v[56:71], v[120:123], v[28:31], 0
    s_mov_b64 exec, s[90:91]
    ds_read_b128 v[136:139], v253 offset:13440
    ds_read_b128 v[140:143], v253 offset:14112
    s_mov_b64 exec, -1
    v_exp_f32 v44, v44
    v_exp_f32 v45, v45
    v_exp_f32 v46, v46
    v_exp_f32 v47, v47
    v_mfma_f32_32x32x8bf16_1k v[56:71], v[124:125], v[32:33], v[56:71]
    ds_read2_b64 v[160:163], v37 offset0:180 offset1:181
    ds_read_b128 v[164:167], v38 offset:1792
    v_cvt_pk_bf16_f32 v72, v40, v41
    v_cvt_pk_bf16_f32 v73, v42, v43
    v_cvt_pk_bf16_f32 v74, v44, v45
    v_cvt_pk_bf16_f32 v75, v46, v47
    v_exp_f32 v48, v48
    v_exp_f32 v49, v49
    v_mfma_f32_32x32x16_bf16 v[80:95], v[128:131], v[72:75], v[80:95]
    ds_read2_b64 v[168:171], v37 offset0:176 offset1:177
    ds_read_b128 v[172:175], v38 offset:1760
    v_exp_f32 v50, v50
    v_exp_f32 v51, v51
    v_exp_f32 v52, v52
    v_exp_f32 v53, v53
    v_mfma_f32_32x32x16_bf16 v[96:111], v[144:147], v[148:151], v[96:111]
    v_exp_f32 v54, v54
    v_exp_f32 v55, v55
    v_mfma_f32_32x32x16_bf16 v[96:111], v[152:155], v[156:159], v[96:111]
    v_cvt_pk_bf16_f32 v76, v48, v49
    v_cvt_pk_bf16_f32 v77, v50, v51
    v_cvt_pk_bf16_f32 v78, v52, v53
    v_cvt_pk_bf16_f32 v79, v54, v55
    s_waitcnt lgkmcnt(0)
    s_nop 0
    v_mfma_f32_32x32x16_bf16 v[80:95], v[132:135], v[76:79], v[80:95]
    ds_read_b128 v[120:123], v247 offset:18816
    ds_read_b64 v[124:125], v250 offset:18816
    v_exp_f32 v56, v56
    v_exp_f32 v57, v57
    v_exp_f32 v58, v58
    v_exp_f32 v59, v59
    v_mfma_f32_32x32x16_bf16 v[40:55], v[112:115], v[28:31], 0
    s_mov_b64 exec, s[90:91]
    ds_read_b128 v[128:131], v253 offset:16128
    ds_read_b128 v[132:135], v253 offset:16800
    s_mov_b64 exec, -1
    v_exp_f32 v60, v60
    v_exp_f32 v61, v61
    v_exp_f32 v62, v62
    v_exp_f32 v63, v63
    v_mfma_f32_32x32x8bf16_1k v[40:55], v[116:117], v[32:33], v[40:55]
    ds_read2_b64 v[144:147], v37 offset0:172 offset1:173
    ds_read_b128 v[148:151], v38 offset:1712
    v_cvt_pk_bf16_f32 v72, v56, v57
    v_cvt_pk_bf16_f32 v73, v58, v59
    v_cvt_pk_bf16_f32 v74, v60, v61
    v_cvt_pk_bf16_f32 v75, v62, v63
    v_exp_f32 v64, v64
    v_exp_f32 v65, v65
    v_mfma_f32_32x32x16_bf16 v[80:95], v[136:139], v[72:75], v[80:95]
    ds_read2_b64 v[152:155], v37 offset0:168 offset1:169
    ds_read_b128 v[156:159], v38 offset:1680
    v_exp_f32 v66, v66
    v_exp_f32 v67, v67
    v_exp_f32 v68, v68
    v_exp_f32 v69, v69
    v_mfma_f32_32x32x16_bf16 v[96:111], v[160:163], v[164:167], v[96:111]
    v_exp_f32 v70, v70
    v_exp_f32 v71, v71
    v_mfma_f32_32x32x16_bf16 v[96:111], v[168:171], v[172:175], v[96:111]
    v_cvt_pk_bf16_f32 v76, v64, v65
    v_cvt_pk_bf16_f32 v77, v66, v67
    v_cvt_pk_bf16_f32 v78, v68, v69
    v_cvt_pk_bf16_f32 v79, v70, v71
    s_waitcnt vmcnt(0) lgkmcnt(0)
    s_barrier
    s_setprio 3
    v_mfma_f32_32x32x16_bf16 v[80:95], v[140:143], v[76:79], v[80:95]
    ds_read_b128 v[112:115], v245 offset:0
    ds_read_b64 v[116:117], v248 offset:0
    v_exp_f32 v40, v40
    v_exp_f32 v41, v41
    v_exp_f32 v42, v42
    v_exp_f32 v43, v43
    v_mfma_f32_32x32x16_bf16 v[56:71], v[120:123], v[28:31], 0
    s_mov_b64 exec, s[90:91]
    ds_read_b128 v[136:139], v253 offset:18816
    ds_read_b128 v[140:143], v253 offset:19488
    s_mov_b64 exec, -1
    v_exp_f32 v44, v44
    v_exp_f32 v45, v45
    v_exp_f32 v46, v46
    v_exp_f32 v47, v47
    v_mfma_f32_32x32x8bf16_1k v[56:71], v[124:125], v[32:33], v[56:71]
    ds_read2_b64 v[160:163], v37 offset0:164 offset1:165
    ds_read_b128 v[164:167], v38 offset:1632
    v_cvt_pk_bf16_f32 v72, v40, v41
    v_cvt_pk_bf16_f32 v73, v42, v43
    v_cvt_pk_bf16_f32 v74, v44, v45
    v_cvt_pk_bf16_f32 v75, v46, v47
    v_exp_f32 v48, v48
    v_exp_f32 v49, v49
    v_mfma_f32_32x32x16_bf16 v[80:95], v[128:131], v[72:75], v[80:95]
    s_add_u32 m0, s88, 138304
    s_add_u32 s74, s88, 13652992
    buffer_load_dwordx4 v9, s[52:55], s74 offen offset:0 sc1 lds
    buffer_load_dwordx4 v9, s[52:55], s74 offen offset:1024 sc1 lds
    buffer_load_dwordx4 v9, s[52:55], s74 offen offset:2048 sc1 lds
    ds_read2_b64 v[168:171], v37 offset0:160 offset1:161
    ds_read_b128 v[172:175], v38 offset:1600
    v_exp_f32 v50, v50
    v_exp_f32 v51, v51
    v_exp_f32 v52, v52
    v_exp_f32 v53, v53
    v_mfma_f32_32x32x16_bf16 v[96:111], v[144:147], v[148:151], v[96:111]
    v_exp_f32 v54, v54
    v_exp_f32 v55, v55
    v_mfma_f32_32x32x16_bf16 v[96:111], v[152:155], v[156:159], v[96:111]
    v_cvt_pk_bf16_f32 v76, v48, v49
    v_cvt_pk_bf16_f32 v77, v50, v51
    v_cvt_pk_bf16_f32 v78, v52, v53
    v_cvt_pk_bf16_f32 v79, v54, v55
    s_waitcnt lgkmcnt(0)
    s_nop 0
    v_mfma_f32_32x32x16_bf16 v[80:95], v[132:135], v[76:79], v[80:95]
    ds_read_b128 v[120:123], v245 offset:2688
    ds_read_b64 v[124:125], v248 offset:2688
    v_exp_f32 v56, v56
    v_exp_f32 v57, v57
    v_exp_f32 v58, v58
    v_exp_f32 v59, v59
    v_mfma_f32_32x32x16_bf16 v[40:55], v[112:115], v[28:31], 0
    s_mov_b64 exec, s[90:91]
    ds_read_b128 v[128:131], v251 offset:0
    ds_read_b128 v[132:135], v251 offset:672
    s_mov_b64 exec, -1
    v_exp_f32 v60, v60
    v_exp_f32 v61, v61
    v_exp_f32 v62, v62
    v_exp_f32 v63, v63
    v_mfma_f32_32x32x8bf16_1k v[40:55], v[116:117], v[32:33], v[40:55]
    ds_read2_b64 v[144:147], v37 offset0:156 offset1:157
    ds_read_b128 v[148:151], v38 offset:1552
    v_cvt_pk_bf16_f32 v72, v56, v57
    v_cvt_pk_bf16_f32 v73, v58, v59
    v_cvt_pk_bf16_f32 v74, v60, v61
    v_cvt_pk_bf16_f32 v75, v62, v63
    v_exp_f32 v64, v64
    v_exp_f32 v65, v65
    v_mfma_f32_32x32x16_bf16 v[80:95], v[136:139], v[72:75], v[80:95]
    s_cmp_eq_u32 s64, 7
    s_cbranch_scc0 L_fa_150
    s_lshl_b32 s74, s66, 7
    s_add_u32 s74, s74, 14050304
    v_mov_b32 v12, 0
    v_mov_b32 v13, 1
    s_mov_b64 exec, 1
    buffer_atomic_add v13, v12, s[52:55], s74 offen sc1
    s_mov_b64 exec, -1
L_fa_150:
    ds_read2_b64 v[152:155], v37 offset0:152 offset1:153
    ds_read_b128 v[156:159], v38 offset:1520
    v_exp_f32 v66, v66
    v_exp_f32 v67, v67
    v_exp_f32 v68, v68
    v_exp_f32 v69, v69
    v_mfma_f32_32x32x16_bf16 v[96:111], v[160:163], v[164:167], v[96:111]
    v_exp_f32 v70, v70
    v_exp_f32 v71, v71
    v_mfma_f32_32x32x16_bf16 v[96:111], v[168:171], v[172:175], v[96:111]
    v_cvt_pk_bf16_f32 v76, v64, v65
    v_cvt_pk_bf16_f32 v77, v66, v67
    v_cvt_pk_bf16_f32 v78, v68, v69
    v_cvt_pk_bf16_f32 v79, v70, v71
    s_waitcnt lgkmcnt(0)
    s_setprio 2
    v_mfma_f32_32x32x16_bf16 v[80:95], v[140:143], v[76:79], v[80:95]
    ds_read_b128 v[112:115], v245 offset:5376
    ds_read_b64 v[116:117], v248 offset:5376
    v_exp_f32 v40, v40
    v_exp_f32 v41, v41
    v_exp_f32 v42, v42
    v_exp_f32 v43, v43
    v_mfma_f32_32x32x16_bf16 v[56:71], v[120:123], v[28:31], 0
    s_mov_b64 exec, s[90:91]
    ds_read_b128 v[136:139], v251 offset:2688
    ds_read_b128 v[140:143], v251 offset:3360
    s_mov_b64 exec, -1
    v_exp_f32 v44, v44
    v_exp_f32 v45, v45
    v_exp_f32 v46, v46
    v_exp_f32 v47, v47
    v_mfma_f32_32x32x8bf16_1k v[56:71], v[124:125], v[32:33], v[56:71]
    ds_read2_b64 v[160:163], v37 offset0:148 offset1:149
    ds_read_b128 v[164:167], v38 offset:1472
    v_cvt_pk_bf16_f32 v72, v40, v41
    v_cvt_pk_bf16_f32 v73, v42, v43
    v_cvt_pk_bf16_f32 v74, v44, v45
    v_cvt_pk_bf16_f32 v75, v46, v47
    v_exp_f32 v48, v48
    v_exp_f32 v49, v49
    v_mfma_f32_32x32x16_bf16 v[80:95], v[128:131], v[72:75], v[80:95]
    s_lshl_b32 s74, s65, 6
    s_lshl_b32 s75, s67, 4
    s_add_u32 s74, s74, s75
    v_add_u32 v12, s74, v3
    s_mul_i32 s97, s68, 48
    s_mul_i32 s74, s66, 80
    s_add_u32 s97, s97, s74
    s_lshl_b32 s74, s97, 1
    v_mul_u32_u24 v204, 1280, v12
    v_lshl_add_u32 v204, v2, 3, v204
    v_add_u32 v204, s74, v204
    v_lshlrev_b32 v207, 3, v2
    v_add_u32 v207, s74, v207
    buffer_load_dwordx2 v[176:177], v204, s[40:43], 0 offen offset:0
    buffer_load_dwordx2 v[182:183], v207, s[60:63], 0 offen offset:0
    buffer_load_dwordx2 v[178:179], v204, s[40:43], 0 offen offset:32
    buffer_load_dwordx2 v[184:185], v207, s[60:63], 0 offen offset:32
    buffer_load_dwordx2 v[180:181], v204, s[40:43], 0 offen offset:64
    buffer_load_dwordx2 v[186:187], v207, s[60:63], 0 offen offset:64
    ds_read2_b64 v[168:171], v37 offset0:144 offset1:145
    ds_read_b128 v[172:175], v38 offset:1440
    v_exp_f32 v50, v50
    v_exp_f32 v51, v51
    v_exp_f32 v52, v52
    v_exp_f32 v53, v53
    v_mfma_f32_32x32x16_bf16 v[96:111], v[144:147], v[148:151], v[96:111]
    v_exp_f32 v54, v54
    v_exp_f32 v55, v55
    v_mfma_f32_32x32x16_bf16 v[96:111], v[152:155], v[156:159], v[96:111]
    v_cvt_pk_bf16_f32 v76, v48, v49
    v_cvt_pk_bf16_f32 v77, v50, v51
    v_cvt_pk_bf16_f32 v78, v52, v53
    v_cvt_pk_bf16_f32 v79, v54, v55
    s_waitcnt lgkmcnt(0)
    s_nop 0
    v_mfma_f32_32x32x16_bf16 v[80:95], v[132:135], v[76:79], v[80:95]
    ds_read_b128 v[120:123], v245 offset:8064
    ds_read_b64 v[124:125], v248 offset:8064
    v_exp_f32 v56, v56
    v_exp_f32 v57, v57
    v_exp_f32 v58, v58
    v_exp_f32 v59, v59
    v_mfma_f32_32x32x16_bf16 v[40:55], v[112:115], v[28:31], 0
    s_mov_b64 exec, s[90:91]
    ds_read_b128 v[128:131], v251 offset:5376
    ds_read_b128 v[132:135], v251 offset:6048
    s_mov_b64 exec, -1
    v_exp_f32 v60, v60
    v_exp_f32 v61, v61
    v_exp_f32 v62, v62
    v_exp_f32 v63, v63
    v_mfma_f32_32x32x8bf16_1k v[40:55], v[116:117], v[32:33], v[40:55]
    ds_read2_b64 v[144:147], v37 offset0:140 offset1:141
    ds_read_b128 v[148:151], v38 offset:1392
    v_cvt_pk_bf16_f32 v72, v56, v57
    v_cvt_pk_bf16_f32 v73, v58, v59
    v_cvt_pk_bf16_f32 v74, v60, v61
    v_cvt_pk_bf16_f32 v75, v62, v63
    v_exp_f32 v64, v64
    v_exp_f32 v65, v65
    v_mfma_f32_32x32x16_bf16 v[80:95], v[136:139], v[72:75], v[80:95]
    ds_read2_b64 v[152:155], v37 offset0:136 offset1:137
    ds_read_b128 v[156:159], v38 offset:1360
    v_exp_f32 v66, v66
    v_exp_f32 v67, v67
    v_exp_f32 v68, v68
    v_exp_f32 v69, v69
    v_mfma_f32_32x32x16_bf16 v[96:111], v[160:163], v[164:167], v[96:111]
    v_exp_f32 v70, v70
    v_exp_f32 v71, v71
    v_mfma_f32_32x32x16_bf16 v[96:111], v[168:171], v[172:175], v[96:111]
    v_cvt_pk_bf16_f32 v76, v64, v65
    v_cvt_pk_bf16_f32 v77, v66, v67
    v_cvt_pk_bf16_f32 v78, v68, v69
    v_cvt_pk_bf16_f32 v79, v70, v71
    s_waitcnt lgkmcnt(0)
    s_setprio 1
    v_mfma_f32_32x32x16_bf16 v[80:95], v[140:143], v[76:79], v[80:95]
    ds_read_b128 v[112:115], v245 offset:10752
    ds_read_b64 v[116:117], v248 offset:10752
    v_exp_f32 v40, v40
    v_exp_f32 v41, v41
    v_exp_f32 v42, v42
    v_exp_f32 v43, v43
    v_mfma_f32_32x32x16_bf16 v[56:71], v[120:123], v[28:31], 0
    s_mov_b64 exec, s[90:91]
    ds_read_b128 v[136:139], v251 offset:8064
    ds_read_b128 v[140:143], v251 offset:8736
    s_mov_b64 exec, -1
    v_exp_f32 v44, v44
    v_exp_f32 v45, v45
    v_exp_f32 v46, v46
    v_exp_f32 v47, v47
    v_mfma_f32_32x32x8bf16_1k v[56:71], v[124:125], v[32:33], v[56:71]
    ds_read2_b64 v[160:163], v37 offset0:132 offset1:133
    ds_read_b128 v[164:167], v38 offset:1312
    v_cvt_pk_bf16_f32 v72, v40, v41
    v_cvt_pk_bf16_f32 v73, v42, v43
    v_cvt_pk_bf16_f32 v74, v44, v45
    v_cvt_pk_bf16_f32 v75, v46, v47
    v_exp_f32 v48, v48
    v_exp_f32 v49, v49
    v_mfma_f32_32x32x16_bf16 v[80:95], v[128:131], v[72:75], v[80:95]
    ds_read2_b64 v[168:171], v37 offset0:128 offset1:129
    ds_read_b128 v[172:175], v38 offset:1280
    v_exp_f32 v50, v50
    v_exp_f32 v51, v51
    v_exp_f32 v52, v52
    v_exp_f32 v53, v53
    v_mfma_f32_32x32x16_bf16 v[96:111], v[144:147], v[148:151], v[96:111]
    v_exp_f32 v54, v54
    v_exp_f32 v55, v55
    v_mfma_f32_32x32x16_bf16 v[96:111], v[152:155], v[156:159], v[96:111]
    v_cvt_pk_bf16_f32 v76, v48, v49
    v_cvt_pk_bf16_f32 v77, v50, v51
    v_cvt_pk_bf16_f32 v78, v52, v53
    v_cvt_pk_bf16_f32 v79, v54, v55
    s_waitcnt lgkmcnt(0)
    s_nop 0
    v_mfma_f32_32x32x16_bf16 v[80:95], v[132:135], v[76:79], v[80:95]
    ds_read_b128 v[120:123], v245 offset:13440
    ds_read_b64 v[124:125], v248 offset:13440
    v_exp_f32 v56, v56
    v_exp_f32 v57, v57
    v_exp_f32 v58, v58
    v_exp_f32 v59, v59
    v_mfma_f32_32x32x16_bf16 v[40:55], v[112:115], v[28:31], 0
    s_mov_b64 exec, s[90:91]
    ds_read_b128 v[128:131], v251 offset:10752
    ds_read_b128 v[132:135], v251 offset:11424
    s_mov_b64 exec, -1
    v_exp_f32 v60, v60
    v_exp_f32 v61, v61
    v_exp_f32 v62, v62
    v_exp_f32 v63, v63
    v_mfma_f32_32x32x8bf16_1k v[40:55], v[116:117], v[32:33], v[40:55]
    ds_read2_b64 v[144:147], v37 offset0:124 offset1:125
    ds_read_b128 v[148:151], v38 offset:1232
    v_cvt_pk_bf16_f32 v72, v56, v57
    v_cvt_pk_bf16_f32 v73, v58, v59
    v_cvt_pk_bf16_f32 v74, v60, v61
    v_cvt_pk_bf16_f32 v75, v62, v63
    v_exp_f32 v64, v64
    v_exp_f32 v65, v65
    v_mfma_f32_32x32x16_bf16 v[80:95], v[136:139], v[72:75], v[80:95]
    v_exp_f32 v66, v66
    v_exp_f32 v67, v67
    v_exp_f32 v68, v68
    v_exp_f32 v69, v69
    v_mfma_f32_32x32x16_bf16 v[96:111], v[160:163], v[164:167], v[96:111]
    v_exp_f32 v70, v70
    v_exp_f32 v71, v71
    v_mfma_f32_32x32x16_bf16 v[96:111], v[168:171], v[172:175], v[96:111]
    v_cvt_pk_bf16_f32 v76, v64, v65
    v_cvt_pk_bf16_f32 v77, v66, v67
    v_cvt_pk_bf16_f32 v78, v68, v69
    v_cvt_pk_bf16_f32 v79, v70, v71
    s_waitcnt lgkmcnt(0)
    s_setprio 0
    v_mfma_f32_32x32x16_bf16 v[80:95], v[140:143], v[76:79], v[80:95]
    ds_read_b128 v[112:115], v245 offset:16128
    ds_read_b64 v[116:117], v248 offset:16128
    v_exp_f32 v40, v40
    v_exp_f32 v41, v41
    v_exp_f32 v42, v42
    v_exp_f32 v43, v43
    v_mfma_f32_32x32x16_bf16 v[56:71], v[120:123], v[28:31], 0
    s_mov_b64 exec, s[90:91]
    ds_read_b128 v[136:139], v251 offset:13440
    ds_read_b128 v[140:143], v251 offset:14112
    s_mov_b64 exec, -1
    v_exp_f32 v44, v44
    v_exp_f32 v45, v45
    v_exp_f32 v46, v46
    v_exp_f32 v47, v47
    v_mfma_f32_32x32x8bf16_1k v[56:71], v[124:125], v[32:33], v[56:71]
    ds_read2_b64 v[152:155], v37 offset0:120 offset1:121
    ds_read_b128 v[156:159], v38 offset:1200
    v_cvt_pk_bf16_f32 v72, v40, v41
    v_cvt_pk_bf16_f32 v73, v42, v43
    v_cvt_pk_bf16_f32 v74, v44, v45
    v_cvt_pk_bf16_f32 v75, v46, v47
    v_exp_f32 v48, v48
    v_exp_f32 v49, v49
    v_mfma_f32_32x32x16_bf16 v[80:95], v[128:131], v[72:75], v[80:95]
    ds_read2_b64 v[160:163], v37 offset0:116 offset1:117
    ds_read_b128 v[164:167], v38 offset:1152
    v_exp_f32 v50, v50
    v_exp_f32 v51, v51
    v_exp_f32 v52, v52
    v_exp_f32 v53, v53
    v_mfma_f32_32x32x16_bf16 v[96:111], v[144:147], v[148:151], v[96:111]
    v_exp_f32 v54, v54
    v_exp_f32 v55, v55
    v_cvt_pk_bf16_f32 v76, v48, v49
    v_cvt_pk_bf16_f32 v77, v50, v51
    v_cvt_pk_bf16_f32 v78, v52, v53
    v_cvt_pk_bf16_f32 v79, v54, v55
    s_waitcnt lgkmcnt(0)
    s_nop 0
    v_mfma_f32_32x32x16_bf16 v[80:95], v[132:135], v[76:79], v[80:95]
    ds_read_b128 v[120:123], v245 offset:18816
    ds_read_b64 v[124:125], v248 offset:18816
    v_exp_f32 v56, v56
    v_exp_f32 v57, v57
    v_exp_f32 v58, v58
    v_exp_f32 v59, v59
    v_mfma_f32_32x32x16_bf16 v[40:55], v[112:115], v[28:31], 0
    s_mov_b64 exec, s[90:91]
    ds_read_b128 v[128:131], v251 offset:16128
    ds_read_b128 v[132:135], v251 offset:16800
    s_mov_b64 exec, -1
    v_exp_f32 v60, v60
    v_exp_f32 v61, v61
    v_exp_f32 v62, v62
    v_exp_f32 v63, v63
    v_mfma_f32_32x32x8bf16_1k v[40:55], v[116:117], v[32:33], v[40:55]
    ds_read2_b64 v[168:171], v37 offset0:112 offset1:113
    ds_read_b128 v[172:175], v38 offset:1120
    v_cvt_pk_bf16_f32 v72, v56, v57
    v_cvt_pk_bf16_f32 v73, v58, v59
    v_cvt_pk_bf16_f32 v74, v60, v61
    v_cvt_pk_bf16_f32 v75, v62, v63
    v_exp_f32 v64, v64
    v_exp_f32 v65, v65
    v_mfma_f32_32x32x16_bf16 v[80:95], v[136:139], v[72:75], v[80:95]
    ds_read2_b64 v[144:147], v37 offset0:108 offset1:109
    ds_read_b128 v[148:151], v38 offset:1072
    v_exp_f32 v66, v66
    v_exp_f32 v67, v67
    v_exp_f32 v68, v68
    v_exp_f32 v69, v69
    v_mfma_f32_32x32x16_bf16 v[96:111], v[152:155], v[156:159], v[96:111]
    v_exp_f32 v70, v70
    v_exp_f32 v71, v71
    v_mfma_f32_32x32x16_bf16 v[96:111], v[160:163], v[164:167], v[96:111]
    v_cvt_pk_bf16_f32 v76, v64, v65
    v_cvt_pk_bf16_f32 v77, v66, v67
    v_cvt_pk_bf16_f32 v78, v68, v69
    v_cvt_pk_bf16_f32 v79, v70, v71
    s_waitcnt vmcnt(0) lgkmcnt(0)
    s_barrier
    s_setprio 3
    v_mfma_f32_32x32x16_bf16 v[80:95], v[140:143], v[76:79], v[80:95]
    ds_read_b128 v[112:115], v246 offset:0
    ds_read_b64 v[116:117], v249 offset:0
    v_exp_f32 v40, v40
    v_exp_f32 v41, v41
    v_exp_f32 v42, v42
    v_exp_f32 v43, v43
    v_mfma_f32_32x32x16_bf16 v[56:71], v[120:123], v[28:31], 0
    s_mov_b64 exec, s[90:91]
    ds_read_b128 v[136:139], v251 offset:18816
    ds_read_b128 v[140:143], v251 offset:19488
    s_mov_b64 exec, -1
    v_exp_f32 v44, v44
    v_exp_f32 v45, v45
    v_exp_f32 v46, v46
    v_exp_f32 v47, v47
    v_mfma_f32_32x32x8bf16_1k v[56:71], v[124:125], v[32:33], v[56:71]
    ds_read2_b64 v[152:155], v37 offset0:104 offset1:105
    ds_read_b128 v[156:159], v38 offset:1040
    v_cvt_pk_bf16_f32 v72, v40, v41
    v_cvt_pk_bf16_f32 v73, v42, v43
    v_cvt_pk_bf16_f32 v74, v44, v45
    v_cvt_pk_bf16_f32 v75, v46, v47
    v_exp_f32 v48, v48
    v_exp_f32 v49, v49
    v_mfma_f32_32x32x16_bf16 v[80:95], v[128:131], v[72:75], v[80:95]
    s_add_u32 m0, s88, 0
    s_add_u32 s74, s88, 13696000
    buffer_load_dwordx4 v9, s[52:55], s74 offen offset:0 sc1 lds
    buffer_load_dwordx4 v9, s[52:55], s74 offen offset:1024 sc1 lds
    buffer_load_dwordx4 v9, s[52:55], s74 offen offset:2048 sc1 lds
    ds_read2_b64 v[160:163], v37 offset0:100 offset1:101
    ds_read_b128 v[164:167], v38 offset:992
    v_exp_f32 v50, v50
    v_exp_f32 v51, v51
    v_exp_f32 v52, v52
    v_exp_f32 v53, v53
    v_mfma_f32_32x32x16_bf16 v[96:111], v[168:171], v[172:175], v[96:111]
    v_exp_f32 v54, v54
    v_exp_f32 v55, v55
    v_mfma_f32_32x32x16_bf16 v[96:111], v[144:147], v[148:151], v[96:111]
    v_cvt_pk_bf16_f32 v76, v48, v49
    v_cvt_pk_bf16_f32 v77, v50, v51
    v_cvt_pk_bf16_f32 v78, v52, v53
    v_cvt_pk_bf16_f32 v79, v54, v55
    s_waitcnt lgkmcnt(0)
    s_nop 0
    v_mfma_f32_32x32x16_bf16 v[80:95], v[132:135], v[76:79], v[80:95]
    ds_read_b128 v[120:123], v246 offset:2688
    ds_read_b64 v[124:125], v249 offset:2688
    v_exp_f32 v56, v56
    v_exp_f32 v57, v57
    v_exp_f32 v58, v58
    v_exp_f32 v59, v59
    v_mfma_f32_32x32x16_bf16 v[40:55], v[112:115], v[28:31], 0
    s_mov_b64 exec, s[90:91]
    ds_read_b128 v[128:131], v252 offset:0
    ds_read_b128 v[132:135], v252 offset:672
    s_mov_b64 exec, -1
    v_exp_f32 v60, v60
    v_exp_f32 v61, v61
    v_exp_f32 v62, v62
    v_exp_f32 v63, v63
    v_mfma_f32_32x32x8bf16_1k v[40:55], v[116:117], v[32:33], v[40:55]
    ds_read2_b64 v[168:171], v37 offset0:96 offset1:97
    ds_read_b128 v[172:175], v38 offset:960
    v_cvt_pk_bf16_f32 v72, v56, v57
    v_cvt_pk_bf16_f32 v73, v58, v59
    v_cvt_pk_bf16_f32 v74, v60, v61
    v_cvt_pk_bf16_f32 v75, v62, v63
    v_exp_f32 v64, v64
    v_exp_f32 v65, v65
    v_mfma_f32_32x32x16_bf16 v[80:95], v[136:139], v[72:75], v[80:95]
    ds_read2_b64 v[144:147], v37 offset0:92 offset1:93
    ds_read_b128 v[148:151], v38 offset:912
    v_exp_f32 v66, v66
    v_exp_f32 v67, v67
    v_exp_f32 v68, v68
    v_exp_f32 v69, v69
    v_mfma_f32_32x32x16_bf16 v[96:111], v[152:155], v[156:159], v[96:111]
    v_exp_f32 v70, v70
    v_exp_f32 v71, v71
    v_mfma_f32_32x32x16_bf16 v[96:111], v[160:163], v[164:167], v[96:111]
    v_cvt_pk_bf16_f32 v76, v64, v65
    v_cvt_pk_bf16_f32 v77, v66, v67
    v_cvt_pk_bf16_f32 v78, v68, v69
    v_cvt_pk_bf16_f32 v79, v70, v71
    s_waitcnt lgkmcnt(0)
    s_setprio 2
    v_mfma_f32_32x32x16_bf16 v[80:95], v[140:143], v[76:79], v[80:95]
    ds_read_b128 v[112:115], v246 offset:5376
    ds_read_b64 v[116:117], v249 offset:5376
    v_exp_f32 v40, v40
    v_exp_f32 v41, v41
    v_exp_f32 v42, v42
    v_exp_f32 v43, v43
    v_mfma_f32_32x32x16_bf16 v[56:71], v[120:123], v[28:31], 0
    s_mov_b64 exec, s[90:91]
    ds_read_b128 v[136:139], v252 offset:2688
    ds_read_b128 v[140:143], v252 offset:3360
    s_mov_b64 exec, -1
    v_exp_f32 v44, v44
    v_exp_f32 v45, v45
    v_exp_f32 v46, v46
    v_exp_f32 v47, v47
    v_mfma_f32_32x32x8bf16_1k v[56:71], v[124:125], v[32:33], v[56:71]
    ds_read2_b64 v[152:155], v37 offset0:88 offset1:89
    ds_read_b128 v[156:159], v38 offset:880
    v_cvt_pk_bf16_f32 v72, v40, v41
    v_cvt_pk_bf16_f32 v73, v42, v43
    v_cvt_pk_bf16_f32 v74, v44, v45
    v_cvt_pk_bf16_f32 v75, v46, v47
    v_exp_f32 v48, v48
    v_exp_f32 v49, v49
    v_mfma_f32_32x32x16_bf16 v[80:95], v[128:131], v[72:75], v[80:95]
    s_lshr_b32 s76, s2, 3
    s_mul_i32 s76, s76, 400
    s_mul_i32 s77, s64, 50
    s_add_u32 s76, s76, s77
    s_lshl_b32 s76, s76, 6
    v_min_u32 v221, 49, v1
    v_lshlrev_b32 v221, 6, v221
    buffer_load_dword v222, v221, s[44:47], s76 offen
    ds_read2_b64 v[160:163], v37 offset0:84 offset1:85
    ds_read_b128 v[164:167], v38 offset:832
    v_exp_f32 v50, v50
    v_exp_f32 v51, v51
    v_exp_f32 v52, v52
    v_exp_f32 v53, v53
    v_mfma_f32_32x32x16_bf16 v[96:111], v[168:171], v[172:175], v[96:111]
    v_exp_f32 v54, v54
    v_exp_f32 v55, v55
    v_mfma_f32_32x32x16_bf16 v[96:111], v[144:147], v[148:151], v[96:111]
    v_cvt_pk_bf16_f32 v76, v48, v49
    v_cvt_pk_bf16_f32 v77, v50, v51
    v_cvt_pk_bf16_f32 v78, v52, v53
    v_cvt_pk_bf16_f32 v79, v54, v55
    s_waitcnt lgkmcnt(0)
    s_nop 0
    v_mfma_f32_32x32x16_bf16 v[80:95], v[132:135], v[76:79], v[80:95]
    ds_read_b128 v[120:123], v246 offset:8064
    ds_read_b64 v[124:125], v249 offset:8064
    v_exp_f32 v56, v56
    v_exp_f32 v57, v57
    v_exp_f32 v58, v58
    v_exp_f32 v59, v59
    v_mfma_f32_32x32x16_bf16 v[40:55], v[112:115], v[28:31], 0
    s_mov_b64 exec, s[90:91]
    ds_read_b128 v[128:131], v252 offset:5376
    ds_read_b128 v[132:135], v252 offset:6048
    s_mov_b64 exec, -1
    v_exp_f32 v60, v60
    v_exp_f32 v61, v61
    v_exp_f32 v62, v62
    v_exp_f32 v63, v63
    v_mfma_f32_32x32x8bf16_1k v[40:55], v[116:117], v[32:33], v[40:55]
    ds_read2_b64 v[168:171], v37 offset0:80 offset1:81
    ds_read_b128 v[172:175], v38 offset:800
    v_cvt_pk_bf16_f32 v72, v56, v57
    v_cvt_pk_bf16_f32 v73, v58, v59
    v_cvt_pk_bf16_f32 v74, v60, v61
    v_cvt_pk_bf16_f32 v75, v62, v63
    v_exp_f32 v64, v64
    v_exp_f32 v65, v65
    v_mfma_f32_32x32x16_bf16 v[80:95], v[136:139], v[72:75], v[80:95]
    ds_read2_b64 v[144:147], v37 offset0:76 offset1:77
    ds_read_b128 v[148:151], v38 offset:752
    v_exp_f32 v66, v66
    v_exp_f32 v67, v67
    v_exp_f32 v68, v68
    v_exp_f32 v69, v69
    v_mfma_f32_32x32x16_bf16 v[96:111], v[152:155], v[156:159], v[96:111]
    v_exp_f32 v70, v70
    v_exp_f32 v71, v71
    v_mfma_f32_32x32x16_bf16 v[96:111], v[160:163], v[164:167], v[96:111]
    v_cvt_pk_bf16_f32 v76, v64, v65
    v_cvt_pk_bf16_f32 v77, v66, v67
    v_cvt_pk_bf16_f32 v78, v68, v69
    v_cvt_pk_bf16_f32 v79, v70, v71
    s_waitcnt lgkmcnt(0)
    s_setprio 1
    v_mfma_f32_32x32x16_bf16 v[80:95], v[140:143], v[76:79], v[80:95]
    ds_read_b128 v[112:115], v246 offset:10752
    ds_read_b64 v[116:117], v249 offset:10752
    v_exp_f32 v40, v40
    v_exp_f32 v41, v41
    v_exp_f32 v42, v42
    v_exp_f32 v43, v43
    v_mfma_f32_32x32x16_bf16 v[56:71], v[120:123], v[28:31], 0
    s_mov_b64 exec, s[90:91]
    ds_read_b128 v[136:139], v252 offset:8064
    ds_read_b128 v[140:143], v252 offset:8736
    s_mov_b64 exec, -1
    v_exp_f32 v44, v44
    v_exp_f32 v45, v45
    v_exp_f32 v46, v46
    v_exp_f32 v47, v47
    v_mfma_f32_32x32x8bf16_1k v[56:71], v[124:125], v[32:33], v[56:71]
    ds_read2_b64 v[152:155], v37 offset0:72 offset1:73
    ds_read_b128 v[156:159], v38 offset:720
    v_cvt_pk_bf16_f32 v72, v40, v41
    v_cvt_pk_bf16_f32 v73, v42, v43
    v_cvt_pk_bf16_f32 v74, v44, v45
    v_cvt_pk_bf16_f32 v75, v46, v47
    v_exp_f32 v48, v48
    v_exp_f32 v49, v49
    v_mfma_f32_32x32x16_bf16 v[80:95], v[128:131], v[72:75], v[80:95]
    ds_read2_b64 v[160:163], v37 offset0:68 offset1:69
    ds_read_b128 v[164:167], v38 offset:672
    v_exp_f32 v50, v50
    v_exp_f32 v51, v51
    v_exp_f32 v52, v52
    v_exp_f32 v53, v53
    v_mfma_f32_32x32x16_bf16 v[96:111], v[168:171], v[172:175], v[96:111]
    v_exp_f32 v54, v54
    v_exp_f32 v55, v55
    v_mfma_f32_32x32x16_bf16 v[96:111], v[144:147], v[148:151], v[96:111]
    v_cvt_pk_bf16_f32 v76, v48, v49
    v_cvt_pk_bf16_f32 v77, v50, v51
    v_cvt_pk_bf16_f32 v78, v52, v53
    v_cvt_pk_bf16_f32 v79, v54, v55
    s_waitcnt lgkmcnt(0)
    s_nop 0
    v_mfma_f32_32x32x16_bf16 v[80:95], v[132:135], v[76:79], v[80:95]
    ds_read_b128 v[120:123], v246 offset:13440
    ds_read_b64 v[124:125], v249 offset:13440
    v_exp_f32 v56, v56
    v_exp_f32 v57, v57
    v_exp_f32 v58, v58
    v_exp_f32 v59, v59
    v_mfma_f32_32x32x16_bf16 v[40:55], v[112:115], v[28:31], 0
    s_mov_b64 exec, s[90:91]
    ds_read_b128 v[128:131], v252 offset:10752
    ds_read_b128 v[132:135], v252 offset:11424
    s_mov_b64 exec, -1
    v_exp_f32 v60, v60
    v_exp_f32 v61, v61
    v_exp_f32 v62, v62
    v_exp_f32 v63, v63
    v_mfma_f32_32x32x8bf16_1k v[40:55], v[116:117], v[32:33], v[40:55]
    ds_read2_b64 v[168:171], v37 offset0:64 offset1:65
    ds_read_b128 v[172:175], v38 offset:640
    v_cvt_pk_bf16_f32 v72, v56, v57
    v_cvt_pk_bf16_f32 v73, v58, v59
    v_cvt_pk_bf16_f32 v74, v60, v61
    v_cvt_pk_bf16_f32 v75, v62, v63
    v_exp_f32 v64, v64
    v_exp_f32 v65, v65
    v_mfma_f32_32x32x16_bf16 v[80:95], v[136:139], v[72:75], v[80:95]
    ds_read2_b64 v[144:147], v37 offset0:60 offset1:61
    ds_read_b128 v[148:151], v38 offset:592
    v_exp_f32 v66, v66
    v_exp_f32 v67, v67
    v_exp_f32 v68, v68
    v_exp_f32 v69, v69
    v_mfma_f32_32x32x16_bf16 v[96:111], v[152:155], v[156:159], v[96:111]
    v_exp_f32 v70, v70
    v_exp_f32 v71, v71
    v_mfma_f32_32x32x16_bf16 v[96:111], v[160:163], v[164:167], v[96:111]
    v_cvt_pk_bf16_f32 v76, v64, v65
    v_cvt_pk_bf16_f32 v77, v66, v67
    v_cvt_pk_bf16_f32 v78, v68, v69
    v_cvt_pk_bf16_f32 v79, v70, v71
    s_waitcnt lgkmcnt(0)
    s_setprio 0
    v_mfma_f32_32x32x16_bf16 v[80:95], v[140:143], v[76:79], v[80:95]
    ds_read_b128 v[112:115], v246 offset:16128
    ds_read_b64 v[116:117], v249 offset:16128
    v_exp_f32 v40, v40
    v_exp_f32 v41, v41
    v_exp_f32 v42, v42
    v_exp_f32 v43, v43
    v_mfma_f32_32x32x16_bf16 v[56:71], v[120:123], v[28:31], 0
    s_mov_b64 exec, s[90:91]
    ds_read_b128 v[136:139], v252 offset:13440
    ds_read_b128 v[140:143], v252 offset:14112
    s_mov_b64 exec, -1
    v_exp_f32 v44, v44
    v_exp_f32 v45, v45
    v_exp_f32 v46, v46
    v_exp_f32 v47, v47
    v_mfma_f32_32x32x8bf16_1k v[56:71], v[124:125], v[32:33], v[56:71]
    ds_read2_b64 v[152:155], v37 offset0:56 offset1:57
    ds_read_b128 v[156:159], v38 offset:560
    v_cvt_pk_bf16_f32 v72, v40, v41
    v_cvt_pk_bf16_f32 v73, v42, v43
    v_cvt_pk_bf16_f32 v74, v44, v45
    v_cvt_pk_bf16_f32 v75, v46, v47
    v_exp_f32 v48, v48
    v_exp_f32 v49, v49
    v_mfma_f32_32x32x16_bf16 v[80:95], v[128:131], v[72:75], v[80:95]
    ds_read2_b64 v[160:163], v37 offset0:52 offset1:53
    ds_read_b128 v[164:167], v38 offset:512
    v_exp_f32 v50, v50
    v_exp_f32 v51, v51
    v_exp_f32 v52, v52
    v_exp_f32 v53, v53
    v_mfma_f32_32x32x16_bf16 v[96:111], v[168:171], v[172:175], v[96:111]
    v_exp_f32 v54, v54
    v_exp_f32 v55, v55
    v_mfma_f32_32x32x16_bf16 v[96:111], v[144:147], v[148:151], v[96:111]
    v_cvt_pk_bf16_f32 v76, v48, v49
    v_cvt_pk_bf16_f32 v77, v50, v51
    v_cvt_pk_bf16_f32 v78, v52, v53
    v_cvt_pk_bf16_f32 v79, v54, v55
    s_waitcnt lgkmcnt(0)
    s_nop 0
    v_mfma_f32_32x32x16_bf16 v[80:95], v[132:135], v[76:79], v[80:95]
    ds_read_b128 v[120:123], v246 offset:18816
    ds_read_b64 v[124:125], v249 offset:18816
    v_exp_f32 v56, v56
    v_exp_f32 v57, v57
    v_exp_f32 v58, v58
    v_exp_f32 v59, v59
    v_mfma_f32_32x32x16_bf16 v[40:55], v[112:115], v[28:31], 0
    s_mov_b64 exec, s[90:91]
    ds_read_b128 v[128:131], v252 offset:16128
    ds_read_b128 v[132:135], v252 offset:16800
    s_mov_b64 exec, -1
    v_exp_f32 v60, v60
    v_exp_f32 v61, v61
    v_exp_f32 v62, v62
    v_exp_f32 v63, v63
    v_mfma_f32_32x32x8bf16_1k v[40:55], v[116:117], v[32:33], v[40:55]
    ds_read2_b64 v[168:171], v37 offset0:48 offset1:49
    ds_read_b128 v[172:175], v38 offset:480
    v_cvt_pk_bf16_f32 v72, v56, v57
    v_cvt_pk_bf16_f32 v73, v58, v59
    v_cvt_pk_bf16_f32 v74, v60, v61
    v_cvt_pk_bf16_f32 v75, v62, v63
    v_exp_f32 v64, v64
    v_exp_f32 v65, v65
    v_mfma_f32_32x32x16_bf16 v[80:95], v[136:139], v[72:75], v[80:95]
    ds_read2_b64 v[144:147], v37 offset0:44 offset1:45
    ds_read_b128 v[148:151], v38 offset:432
    v_exp_f32 v66, v66
    v_exp_f32 v67, v67
    v_exp_f32 v68, v68
    v_exp_f32 v69, v69
    v_mfma_f32_32x32x16_bf16 v[96:111], v[152:155], v[156:159], v[96:111]
    v_exp_f32 v70, v70
    v_exp_f32 v71, v71
    v_mfma_f32_32x32x16_bf16 v[96:111], v[160:163], v[164:167], v[96:111]
    v_cvt_pk_bf16_f32 v76, v64, v65
    v_cvt_pk_bf16_f32 v77, v66, v67
    v_cvt_pk_bf16_f32 v78, v68, v69
    v_cvt_pk_bf16_f32 v79, v70, v71
    s_waitcnt vmcnt(0) lgkmcnt(0)
    s_barrier
    s_setprio 3
    v_mfma_f32_32x32x16_bf16 v[80:95], v[140:143], v[76:79], v[80:95]
    ds_read_b128 v[112:115], v247 offset:0
    ds_read_b64 v[116:117], v250 offset:0
    v_exp_f32 v40, v40
    v_exp_f32 v41, v41
    v_exp_f32 v42, v42
    v_exp_f32 v43, v43
    v_mfma_f32_32x32x16_bf16 v[56:71], v[120:123], v[28:31], 0
    s_mov_b64 exec, s[90:91]
    ds_read_b128 v[136:139], v252 offset:18816
    ds_read_b128 v[140:143], v252 offset:19488
    s_mov_b64 exec, -1
    v_exp_f32 v44, v44
    v_exp_f32 v45, v45
    v_exp_f32 v46, v46
    v_exp_f32 v47, v47
    v_mfma_f32_32x32x8bf16_1k v[56:71], v[124:125], v[32:33], v[56:71]
    ds_read2_b64 v[152:155], v37 offset0:40 offset1:41
    ds_read_b128 v[156:159], v38 offset:400
    v_cvt_pk_bf16_f32 v72, v40, v41
    v_cvt_pk_bf16_f32 v73, v42, v43
    v_cvt_pk_bf16_f32 v74, v44, v45
    v_cvt_pk_bf16_f32 v75, v46, v47
    v_exp_f32 v48, v48
    v_exp_f32 v49, v49
    v_mfma_f32_32x32x16_bf16 v[80:95], v[128:131], v[72:75], v[80:95]
    s_add_u32 m0, s88, 102400
    s_add_u32 s74, s88, 13739008
    buffer_load_dwordx4 v9, s[52:55], s74 offen offset:0 sc1 lds
    buffer_load_dwordx4 v9, s[52:55], s74 offen offset:1024 sc1 lds
    buffer_load_dwordx4 v9, s[52:55], s74 offen offset:2048 sc1 lds
    v_exp_f32 v50, v50
    v_exp_f32 v51, v51
    v_exp_f32 v52, v52
    v_exp_f32 v53, v53
    v_mfma_f32_32x32x16_bf16 v[96:111], v[168:171], v[172:175], v[96:111]
    v_exp_f32 v54, v54
    v_exp_f32 v55, v55
    v_mfma_f32_32x32x16_bf16 v[96:111], v[144:147], v[148:151], v[96:111]
    v_cvt_pk_bf16_f32 v76, v48, v49
    v_cvt_pk_bf16_f32 v77, v50, v51
    v_cvt_pk_bf16_f32 v78, v52, v53
    v_cvt_pk_bf16_f32 v79, v54, v55
    s_waitcnt lgkmcnt(0)
    s_nop 0
    v_mfma_f32_32x32x16_bf16 v[80:95], v[132:135], v[76:79], v[80:95]
    ds_read_b128 v[120:123], v247 offset:2688
    ds_read_b64 v[124:125], v250 offset:2688
    v_exp_f32 v56, v56
    v_exp_f32 v57, v57
    v_exp_f32 v58, v58
    v_exp_f32 v59, v59
    v_mfma_f32_32x32x16_bf16 v[40:55], v[112:115], v[28:31], 0
    s_mov_b64 exec, s[90:91]
    ds_read_b128 v[128:131], v253 offset:0
    ds_read_b128 v[132:135], v253 offset:672
    s_mov_b64 exec, -1
    v_exp_f32 v60, v60
    v_exp_f32 v61, v61
    v_exp_f32 v62, v62
    v_exp_f32 v63, v63
    v_mfma_f32_32x32x8bf16_1k v[40:55], v[116:117], v[32:33], v[40:55]
    ds_read2_b64 v[160:163], v37 offset0:36 offset1:37
    ds_read_b128 v[164:167], v38 offset:352
    v_cvt_pk_bf16_f32 v72, v56, v57
    v_cvt_pk_bf16_f32 v73, v58, v59
    v_cvt_pk_bf16_f32 v74, v60, v61
    v_cvt_pk_bf16_f32 v75, v62, v63
    v_exp_f32 v64, v64
    v_exp_f32 v65, v65
    v_mfma_f32_32x32x16_bf16 v[80:95], v[136:139], v[72:75], v[80:95]
    ds_read2_b64 v[168:171], v37 offset0:32 offset1:33
    ds_read_b128 v[172:175], v38 offset:320
    v_exp_f32 v66, v66
    v_exp_f32 v67, v67
    v_exp_f32 v68, v68
    v_exp_f32 v69, v69
    v_mfma_f32_32x32x16_bf16 v[96:111], v[152:155], v[156:159], v[96:111]
    v_exp_f32 v70, v70
    v_exp_f32 v71, v71
    v_cvt_pk_bf16_f32 v76, v64, v65
    v_cvt_pk_bf16_f32 v77, v66, v67
    v_cvt_pk_bf16_f32 v78, v68, v69
    v_cvt_pk_bf16_f32 v79, v70, v71
    s_waitcnt lgkmcnt(0)
    s_setprio 2
    v_mfma_f32_32x32x16_bf16 v[80:95], v[140:143], v[76:79], v[80:95]
    ds_read_b128 v[112:115], v247 offset:5376
    ds_read_b64 v[116:117], v250 offset:5376
    v_exp_f32 v40, v40
    v_exp_f32 v41, v41
    v_exp_f32 v42, v42
    v_exp_f32 v43, v43
    v_mfma_f32_32x32x16_bf16 v[56:71], v[120:123], v[28:31], 0
    s_mov_b64 exec, s[90:91]
    ds_read_b128 v[136:139], v253 offset:2688
    ds_read_b128 v[140:143], v253 offset:3360
    s_mov_b64 exec, -1
    v_exp_f32 v44, v44
    v_exp_f32 v45, v45
    v_exp_f32 v46, v46
    v_exp_f32 v47, v47
    v_mfma_f32_32x32x8bf16_1k v[56:71], v[124:125], v[32:33], v[56:71]
    ds_read2_b64 v[144:147], v37 offset0:28 offset1:29
    ds_read_b128 v[148:151], v38 offset:272
    v_cvt_pk_bf16_f32 v72, v40, v41
    v_cvt_pk_bf16_f32 v73, v42, v43
    v_cvt_pk_bf16_f32 v74, v44, v45
    v_cvt_pk_bf16_f32 v75, v46, v47
    v_exp_f32 v48, v48
    v_exp_f32 v49, v49
    v_mfma_f32_32x32x16_bf16 v[80:95], v[128:131], v[72:75], v[80:95]
    ds_read2_b64 v[152:155], v37 offset0:24 offset1:25
    ds_read_b128 v[156:159], v38 offset:240
    v_exp_f32 v50, v50
    v_exp_f32 v51, v51
    v_exp_f32 v52, v52
    v_exp_f32 v53, v53
    v_mfma_f32_32x32x16_bf16 v[96:111], v[160:163], v[164:167], v[96:111]
    v_exp_f32 v54, v54
    v_exp_f32 v55, v55
    v_mfma_f32_32x32x16_bf16 v[96:111], v[168:171], v[172:175], v[96:111]
    v_cvt_pk_bf16_f32 v76, v48, v49
    v_cvt_pk_bf16_f32 v77, v50, v51
    v_cvt_pk_bf16_f32 v78, v52, v53
    v_cvt_pk_bf16_f32 v79, v54, v55
    s_waitcnt lgkmcnt(0)
    s_nop 0
    v_mfma_f32_32x32x16_bf16 v[80:95], v[132:135], v[76:79], v[80:95]
    ds_read_b128 v[120:123], v247 offset:8064
    ds_read_b64 v[124:125], v250 offset:8064
    v_exp_f32 v56, v56
    v_exp_f32 v57, v57
    v_exp_f32 v58, v58
    v_exp_f32 v59, v59
    v_mfma_f32_32x32x16_bf16 v[40:55], v[112:115], v[28:31], 0
    s_mov_b64 exec, s[90:91]
    ds_read_b128 v[128:131], v253 offset:5376
    ds_read_b128 v[132:135], v253 offset:6048
    s_mov_b64 exec, -1
    v_exp_f32 v60, v60
    v_exp_f32 v61, v61
    v_exp_f32 v62, v62
    v_exp_f32 v63, v63
    v_mfma_f32_32x32x8bf16_1k v[40:55], v[116:117], v[32:33], v[40:55]
    ds_read2_b64 v[160:163], v37 offset0:20 offset1:21
    ds_read_b128 v[164:167], v38 offset:192
    v_cvt_pk_bf16_f32 v72, v56, v57
    v_cvt_pk_bf16_f32 v73, v58, v59
    v_cvt_pk_bf16_f32 v74, v60, v61
    v_cvt_pk_bf16_f32 v75, v62, v63
    v_exp_f32 v64, v64
    v_exp_f32 v65, v65
    v_mfma_f32_32x32x16_bf16 v[80:95], v[136:139], v[72:75], v[80:95]
    ds_read2_b64 v[168:171], v37 offset0:16 offset1:17
    ds_read_b128 v[172:175], v38 offset:160
    v_exp_f32 v66, v66
    v_exp_f32 v67, v67
    v_exp_f32 v68, v68
    v_exp_f32 v69, v69
    v_mfma_f32_32x32x16_bf16 v[96:111], v[144:147], v[148:151], v[96:111]
    v_exp_f32 v70, v70
    v_exp_f32 v71, v71
    v_mfma_f32_32x32x16_bf16 v[96:111], v[152:155], v[156:159], v[96:111]
    v_cvt_pk_bf16_f32 v76, v64, v65
    v_cvt_pk_bf16_f32 v77, v66, v67
    v_cvt_pk_bf16_f32 v78, v68, v69
    v_cvt_pk_bf16_f32 v79, v70, v71
    s_waitcnt lgkmcnt(0)
    s_setprio 1
    v_mfma_f32_32x32x16_bf16 v[80:95], v[140:143], v[76:79], v[80:95]
    ds_read_b128 v[112:115], v247 offset:10752
    ds_read_b64 v[116:117], v250 offset:10752
    v_exp_f32 v40, v40
    v_exp_f32 v41, v41
    v_exp_f32 v42, v42
    v_exp_f32 v43, v43
    v_mfma_f32_32x32x16_bf16 v[56:71], v[120:123], v[28:31], 0
    s_mov_b64 exec, s[90:91]
    ds_read_b128 v[136:139], v253 offset:8064
    ds_read_b128 v[140:143], v253 offset:8736
    s_mov_b64 exec, -1
    v_exp_f32 v44, v44
    v_exp_f32 v45, v45
    v_exp_f32 v46, v46
    v_exp_f32 v47, v47
    v_mfma_f32_32x32x8bf16_1k v[56:71], v[124:125], v[32:33], v[56:71]
    ds_read2_b64 v[144:147], v37 offset0:12 offset1:13
    ds_read_b128 v[148:151], v38 offset:112
    v_cvt_pk_bf16_f32 v72, v40, v41
    v_cvt_pk_bf16_f32 v73, v42, v43
    v_cvt_pk_bf16_f32 v74, v44, v45
    v_cvt_pk_bf16_f32 v75, v46, v47
    v_exp_f32 v48, v48
    v_exp_f32 v49, v49
    v_mfma_f32_32x32x16_bf16 v[80:95], v[128:131], v[72:75], v[80:95]
    ds_read2_b64 v[152:155], v37 offset0:8 offset1:9
    ds_read_b128 v[156:159], v38 offset:80
    v_exp_f32 v50, v50
    v_exp_f32 v51, v51
    v_exp_f32 v52, v52
    v_exp_f32 v53, v53
    v_mfma_f32_32x32x16_bf16 v[96:111], v[160:163], v[164:167], v[96:111]
    v_exp_f32 v54, v54
    v_exp_f32 v55, v55
    v_mfma_f32_32x32x16_bf16 v[96:111], v[168:171], v[172:175], v[96:111]
    v_cvt_pk_bf16_f32 v76, v48, v49
    v_cvt_pk_bf16_f32 v77, v50, v51
    v_cvt_pk_bf16_f32 v78, v52, v53
    v_cvt_pk_bf16_f32 v79, v54, v55
    s_waitcnt lgkmcnt(0)
    s_nop 0
    v_mfma_f32_32x32x16_bf16 v[80:95], v[132:135], v[76:79], v[80:95]
    ds_read_b128 v[120:123], v247 offset:13440
    ds_read_b64 v[124:125], v250 offset:13440
    v_exp_f32 v56, v56
    v_exp_f32 v57, v57
    v_exp_f32 v58, v58
    v_exp_f32 v59, v59
    v_mfma_f32_32x32x16_bf16 v[40:55], v[112:115], v[28:31], 0
    s_mov_b64 exec, s[90:91]
    ds_read_b128 v[128:131], v253 offset:10752
    ds_read_b128 v[132:135], v253 offset:11424
    s_mov_b64 exec, -1
    v_exp_f32 v60, v60
    v_exp_f32 v61, v61
    v_exp_f32 v62, v62
    v_exp_f32 v63, v63
    v_mfma_f32_32x32x8bf16_1k v[40:55], v[116:117], v[32:33], v[40:55]
    ds_read2_b64 v[160:163], v37 offset0:4 offset1:5
    ds_read_b128 v[164:167], v38 offset:32
    v_cvt_pk_bf16_f32 v72, v56, v57
    v_cvt_pk_bf16_f32 v73, v58, v59
    v_cvt_pk_bf16_f32 v74, v60, v61
    v_cvt_pk_bf16_f32 v75, v62, v63
    v_exp_f32 v64, v64
    v_exp_f32 v65, v65
    v_mfma_f32_32x32x16_bf16 v[80:95], v[136:139], v[72:75], v[80:95]
    ds_read2_b64 v[168:171], v37 offset0:0 offset1:1
    ds_read_b128 v[172:175], v38 offset:0
    v_exp_f32 v66, v66
    v_exp_f32 v67, v67
    v_exp_f32 v68, v68
    v_exp_f32 v69, v69
    v_mfma_f32_32x32x16_bf16 v[96:111], v[144:147], v[148:151], v[96:111]
    v_exp_f32 v70, v70
    v_exp_f32 v71, v71
    v_mfma_f32_32x32x16_bf16 v[96:111], v[152:155], v[156:159], v[96:111]
    v_cvt_pk_bf16_f32 v76, v64, v65
    v_cvt_pk_bf16_f32 v77, v66, v67
    v_cvt_pk_bf16_f32 v78, v68, v69
    v_cvt_pk_bf16_f32 v79, v70, v71
    s_waitcnt lgkmcnt(0)
    s_setprio 0
    v_mfma_f32_32x32x16_bf16 v[80:95], v[140:143], v[76:79], v[80:95]
    ds_read_b128 v[112:115], v247 offset:16128
    ds_read_b64 v[116:117], v250 offset:16128
    v_exp_f32 v40, v40
    v_exp_f32 v41, v41
    v_exp_f32 v42, v42
    v_exp_f32 v43, v43
    v_mfma_f32_32x32x16_bf16 v[56:71], v[120:123], v[28:31], 0
    s_mov_b64 exec, s[90:91]
    ds_read_b128 v[136:139], v253 offset:13440
    ds_read_b128 v[140:143], v253 offset:14112
    s_mov_b64 exec, -1
    v_exp_f32 v44, v44
    v_exp_f32 v45, v45
    v_exp_f32 v46, v46
    v_exp_f32 v47, v47
    v_mfma_f32_32x32x8bf16_1k v[56:71], v[124:125], v[32:33], v[56:71]
    v_cvt_pk_bf16_f32 v72, v40, v41
    v_cvt_pk_bf16_f32 v73, v42, v43
    v_cvt_pk_bf16_f32 v74, v44, v45
    v_cvt_pk_bf16_f32 v75, v46, v47
    v_exp_f32 v48, v48
    v_exp_f32 v49, v49
    v_mfma_f32_32x32x16_bf16 v[80:95], v[128:131], v[72:75], v[80:95]
    v_exp_f32 v50, v50
    v_exp_f32 v51, v51
    v_exp_f32 v52, v52
    v_exp_f32 v53, v53
    v_mfma_f32_32x32x16_bf16 v[96:111], v[160:163], v[164:167], v[96:111]
    v_exp_f32 v54, v54
    v_exp_f32 v55, v55
    v_mfma_f32_32x32x16_bf16 v[96:111], v[168:171], v[172:175], v[96:111]
    v_cvt_pk_bf16_f32 v76, v48, v49
    v_cvt_pk_bf16_f32 v77, v50, v51
    v_cvt_pk_bf16_f32 v78, v52, v53
    v_cvt_pk_bf16_f32 v79, v54, v55
    s_waitcnt lgkmcnt(0)
    s_nop 0
    v_mfma_f32_32x32x16_bf16 v[80:95], v[132:135], v[76:79], v[80:95]
    ds_read_b128 v[120:123], v247 offset:18816
    ds_read_b64 v[124:125], v250 offset:18816
    v_exp_f32 v56, v56
    v_exp_f32 v57, v57
    v_exp_f32 v58, v58
    v_exp_f32 v59, v59
    v_mfma_f32_32x32x16_bf16 v[40:55], v[112:115], v[28:31], 0
    s_mov_b64 exec, s[90:91]
    ds_read_b128 v[128:131], v253 offset:16128
    ds_read_b128 v[132:135], v253 offset:16800
    s_mov_b64 exec, -1
    v_exp_f32 v60, v60
    v_exp_f32 v61, v61
    v_exp_f32 v62, v62
    v_exp_f32 v63, v63
    v_mfma_f32_32x32x8bf16_1k v[40:55], v[116:117], v[32:33], v[40:55]
    v_cvt_pk_bf16_f32 v72, v56, v57
    v_cvt_pk_bf16_f32 v73, v58, v59
    v_cvt_pk_bf16_f32 v74, v60, v61
    v_cvt_pk_bf16_f32 v75, v62, v63
    v_exp_f32 v64, v64
    v_exp_f32 v65, v65
    v_mfma_f32_32x32x16_bf16 v[80:95], v[136:139], v[72:75], v[80:95]
    s_waitcnt vmcnt(0)
    s_cmp_eq_u32 s82, 1
    s_cbranch_scc1 L_y0d_152
    s_cmp_eq_u32 s82, 2
    s_cbranch_scc0 L_y0_151
    s_lshl_b32 s74, s81, 12
    s_add_u32 s74, s74, 123904
    v_add_u32 v12, s74, v9
    ds_write_b128 v12, v[96:99] offset:0
    ds_write_b128 v12, v[100:103] offset:1024
    ds_write_b128 v12, v[104:107] offset:2048
    ds_write_b128 v12, v[108:111] offset:3072
    s_branch L_y0d_152
L_y0_151:
    s_cmp_lg_u32 s84, 0
    s_cbranch_scc1 L_y0d_152
    v_cvt_pk_bf16_f32 v96, v96, v97
    v_cvt_pk_bf16_f32 v97, v98, v99
    v_cvt_pk_bf16_f32 v98, v100, v101
    v_cvt_pk_bf16_f32 v99, v102, v103
    v_cvt_pk_bf16_f32 v100, v104, v105
    v_cvt_pk_bf16_f32 v101, v106, v107
    v_cvt_pk_bf16_f32 v102, v108, v109
    v_cvt_pk_bf16_f32 v103, v110, v111
    v_permlane32_swap_b32 v96, v98
    v_permlane32_swap_b32 v97, v99
    v_permlane32_swap_b32 v100, v102
    v_permlane32_swap_b32 v101, v103
    v_lshlrev_b32 v12, 6, v10
    v_lshl_add_u32 v12, v11, 4, v12
    s_lshl_b32 s74, s83, 12
    s_lshl_b32 s75, s82, 11
    s_add_u32 s74, s74, s75
    s_add_u32 s74, s74, 10485760
    buffer_store_dwordx4 v[96:99], v12, s[52:55], s74 offen sc1
    buffer_store_dwordx4 v[100:103], v12, s[52:55], s74 offen offset:32 sc1
L_y0d_152:
    v_exp_f32 v66, v66
    v_exp_f32 v67, v67
    v_exp_f32 v68, v68
    v_exp_f32 v69, v69
    v_exp_f32 v70, v70
    v_exp_f32 v71, v71
    v_cvt_pk_bf16_f32 v76, v64, v65
    v_cvt_pk_bf16_f32 v77, v66, v67
    v_cvt_pk_bf16_f32 v78, v68, v69
    v_cvt_pk_bf16_f32 v79, v70, v71
    s_waitcnt vmcnt(63) lgkmcnt(0)
    s_barrier
    s_setprio 3
    v_mfma_f32_32x32x16_bf16 v[80:95], v[140:143], v[76:79], v[80:95]
    ds_read_b128 v[112:115], v245 offset:0
    ds_read_b64 v[116:117], v248 offset:0
    v_exp_f32 v40, v40
    v_exp_f32 v41, v41
    v_exp_f32 v42, v42
    v_exp_f32 v43, v43
    v_mfma_f32_32x32x16_bf16 v[56:71], v[120:123], v[28:31], 0
    s_mov_b64 exec, s[90:91]
    ds_read_b128 v[136:139], v253 offset:18816
    ds_read_b128 v[140:143], v253 offset:19488
    s_mov_b64 exec, -1
    v_min_u32 v237, 7, v1
    v_lshlrev_b32 v237, 7, v237
    s_mov_b32 s74, 14050304
    buffer_load_dword v237, v237, s[52:55], s74 offen sc1
    v_exp_f32 v44, v44
    v_exp_f32 v45, v45
    v_exp_f32 v46, v46
    v_exp_f32 v47, v47
    v_mfma_f32_32x32x8bf16_1k v[56:71], v[124:125], v[32:33], v[56:71]
    v_cvt_pk_bf16_f32 v72, v40, v41
    v_cvt_pk_bf16_f32 v73, v42, v43
    v_cvt_pk_bf16_f32 v74, v44, v45
    v_cvt_pk_bf16_f32 v75, v46, v47
    v_exp_f32 v48, v48
    v_exp_f32 v49, v49
    v_mfma_f32_32x32x16_bf16 v[80:95], v[128:131], v[72:75], v[80:95]
    s_add_u32 m0, s88, 138304
    s_add_u32 s74, s88, 13782016
    buffer_load_dwordx4 v9, s[52:55], s74 offen offset:0 sc1 lds
    buffer_load_dwordx4 v9, s[52:55], s74 offen offset:1024 sc1 lds
    buffer_load_dwordx4 v9, s[52:55], s74 offen offset:2048 sc1 lds
    s_cmp_eq_u32 s82, 1
    s_cbranch_scc0 L_y1r_153
    s_lshl_b32 s74, s81, 12
    s_add_u32 s74, s74, 123904
    v_add_u32 v12, s74, v9
    ds_read_b128 v[144:147], v12 offset:0
    ds_read_b128 v[148:151], v12 offset:1024
    ds_read_b128 v[152:155], v12 offset:2048
    ds_read_b128 v[156:159], v12 offset:3072
L_y1r_153:
    v_exp_f32 v50, v50
    v_exp_f32 v51, v51
    v_exp_f32 v52, v52
    v_exp_f32 v53, v53
    v_exp_f32 v54, v54
    v_exp_f32 v55, v55
    v_cvt_pk_bf16_f32 v76, v48, v49
    v_cvt_pk_bf16_f32 v77, v50, v51
    v_cvt_pk_bf16_f32 v78, v52, v53
    v_cvt_pk_bf16_f32 v79, v54, v55
    s_mul_i32 s78, s64, 40960
    s_add_u32 s78, s78, s96
    s_mul_i32 s79, s64, 5120
    s_lshl_b32 s93, s68, 10
    s_cmp_eq_u32 s68, 0
    s_cselect_b64 vcc, -1, 0
    v_add_u32 v12, 1024, v5
    v_cndmask_b32 v238, v12, v4, vcc
    v_add_u32 v12, 3072, v7
    v_add_u32 v13, 2048, v6
    v_cndmask_b32 v239, v12, v13, vcc
    s_waitcnt lgkmcnt(0)
    v_mfma_f32_32x32x16_bf16 v[80:95], v[132:135], v[76:79], v[80:95]
    ds_read_b128 v[120:123], v245 offset:2688
    ds_read_b64 v[124:125], v248 offset:2688
    v_exp_f32 v56, v56
    v_exp_f32 v57, v57
    v_exp_f32 v58, v58
    v_exp_f32 v59, v59
    v_mfma_f32_32x32x16_bf16 v[40:55], v[112:115], v[28:31], 0
    s_mov_b64 exec, s[90:91]
    ds_read_b128 v[128:131], v251 offset:0
    ds_read_b128 v[132:135], v251 offset:672
    s_mov_b64 exec, -1
    v_exp_f32 v60, v60
    v_exp_f32 v61, v61
    v_exp_f32 v62, v62
    v_exp_f32 v63, v63
    v_mfma_f32_32x32x8bf16_1k v[40:55], v[116:117], v[32:33], v[40:55]
    v_cvt_pk_bf16_f32 v72, v56, v57
    v_cvt_pk_bf16_f32 v73, v58, v59
    v_cvt_pk_bf16_f32 v74, v60, v61
    v_cvt_pk_bf16_f32 v75, v62, v63
    v_exp_f32 v64, v64
    v_exp_f32 v65, v65
    v_mfma_f32_32x32x16_bf16 v[80:95], v[136:139], v[72:75], v[80:95]
    s_cmp_eq_u32 s82, 1
    s_cbranch_scc0 L_y1s_154
    v_pk_add_f32 v[96:97], v[96:97], v[144:145]
    v_pk_add_f32 v[98:99], v[98:99], v[146:147]
    v_pk_add_f32 v[100:101], v[100:101], v[148:149]
    v_pk_add_f32 v[102:103], v[102:103], v[150:151]
    v_pk_add_f32 v[104:105], v[104:105], v[152:153]
    v_pk_add_f32 v[106:107], v[106:107], v[154:155]
    v_pk_add_f32 v[108:109], v[108:109], v[156:157]
    v_pk_add_f32 v[110:111], v[110:111], v[158:159]
    v_cvt_pk_bf16_f32 v96, v96, v97
    v_cvt_pk_bf16_f32 v97, v98, v99
    v_cvt_pk_bf16_f32 v98, v100, v101
    v_cvt_pk_bf16_f32 v99, v102, v103
    v_cvt_pk_bf16_f32 v100, v104, v105
    v_cvt_pk_bf16_f32 v101, v106, v107
    v_cvt_pk_bf16_f32 v102, v108, v109
    v_cvt_pk_bf16_f32 v103, v110, v111
    v_permlane32_swap_b32 v96, v98
    v_permlane32_swap_b32 v97, v99
    v_permlane32_swap_b32 v100, v102
    v_permlane32_swap_b32 v101, v103
    v_lshlrev_b32 v12, 6, v10
    v_lshl_add_u32 v12, v11, 4, v12
    s_lshl_b32 s74, s83, 12
    s_lshl_b32 s75, s82, 11
    s_add_u32 s74, s74, s75
    s_add_u32 s74, s74, 10485760
    buffer_store_dwordx4 v[96:99], v12, s[52:55], s74 offen sc1
    buffer_store_dwordx4 v[100:103], v12, s[52:55], s74 offen offset:32 sc1
L_y1s_154:
    v_exp_f32 v66, v66
    v_exp_f32 v67, v67
    v_exp_f32 v68, v68
    v_exp_f32 v69, v69
    v_exp_f32 v70, v70
    v_exp_f32 v71, v71
    v_cvt_pk_bf16_f32 v76, v64, v65
    v_cvt_pk_bf16_f32 v77, v66, v67
    v_cvt_pk_bf16_f32 v78, v68, v69
    v_cvt_pk_bf16_f32 v79, v70, v71
    s_add_u32 m0, s79, 40960
    s_add_u32 s76, s78, 327680
    buffer_load_dwordx4 v4, s[44:47], s76 offen offset:0 lds
    s_waitcnt lgkmcnt(0)
    s_setprio 2
    v_mfma_f32_32x32x16_bf16 v[80:95], v[140:143], v[76:79], v[80:95]
    ds_read_b128 v[112:115], v245 offset:5376
    ds_read_b64 v[116:117], v248 offset:5376
    v_exp_f32 v40, v40
    v_exp_f32 v41, v41
    v_exp_f32 v42, v42
    v_exp_f32 v43, v43
    v_mfma_f32_32x32x16_bf16 v[56:71], v[120:123], v[28:31], 0
    s_mov_b64 exec, s[90:91]
    ds_read_b128 v[136:139], v251 offset:2688
    ds_read_b128 v[140:143], v251 offset:3360
    s_mov_b64 exec, -1
    v_exp_f32 v44, v44
    v_exp_f32 v45, v45
    v_exp_f32 v46, v46
    v_exp_f32 v47, v47
    v_mfma_f32_32x32x8bf16_1k v[56:71], v[124:125], v[32:33], v[56:71]
    v_cvt_pk_bf16_f32 v72, v40, v41
    v_cvt_pk_bf16_f32 v73, v42, v43
    v_cvt_pk_bf16_f32 v74, v44, v45
    v_cvt_pk_bf16_f32 v75, v46, v47
    v_exp_f32 v48, v48
    v_exp_f32 v49, v49
    v_mfma_f32_32x32x16_bf16 v[80:95], v[128:131], v[72:75], v[80:95]
    v_lshrrev_b32 v240, 4, v10
    v_mul_u32_u24 v240, 20480, v240
    v_lshl_add_u32 v240, v3, 4, v240
    v_lshl_add_u32 v241, v11, 8, v240
    s_lshl_b32 s74, s65, 2
    s_lshl_b32 s75, s98, 1
    s_add_u32 s74, s74, s75
    s_mul_i32 s74, s74, 20480
    s_mul_i32 s75, s66, 2560
    s_add_u32 s74, s74, s75
    s_mul_i32 s75, s67, 20
    s_lshr_b32 s75, s75, 3
    s_lshl_b32 s75, s75, 8
    s_add_u32 s74, s74, s75
    s_add_u32 s81, s74, 3145728
    s_lshl_b32 s74, s65, 2
    s_add_u32 s74, s74, s67
    s_mul_i32 s74, s74, 20480
    s_mul_i32 s75, s68, 10240
    s_add_u32 s74, s74, s75
    s_add_u32 s82, s74, 3145728
    s_add_u32 s83, s82, 4096
    s_add_u32 s84, s82, 8192
    s_mov_b32 s48, s34
    s_mov_b32 s49, s35
    s_mov_b32 s50, 2621440
    s_mov_b32 s51, 0x20000
    v_exp_f32 v50, v50
    v_exp_f32 v51, v51
    v_exp_f32 v52, v52
    v_exp_f32 v53, v53
    v_exp_f32 v54, v54
    v_exp_f32 v55, v55
    v_cvt_pk_bf16_f32 v76, v48, v49
    v_cvt_pk_bf16_f32 v77, v50, v51
    v_cvt_pk_bf16_f32 v78, v52, v53
    v_cvt_pk_bf16_f32 v79, v54, v55
    s_add_u32 m0, s79, 40960
    s_add_u32 s76, s78, 327680
    buffer_load_dwordx4 v5, s[44:47], s76 offen offset:1024 lds
    s_waitcnt lgkmcnt(0)
    v_mfma_f32_32x32x16_bf16 v[80:95], v[132:135], v[76:79], v[80:95]
    ds_read_b128 v[120:123], v245 offset:8064
    ds_read_b64 v[124:125], v248 offset:8064
    v_exp_f32 v56, v56
    v_exp_f32 v57, v57
    v_exp_f32 v58, v58
    v_exp_f32 v59, v59
    v_mfma_f32_32x32x16_bf16 v[40:55], v[112:115], v[28:31], 0
    s_mov_b64 exec, s[90:91]
    ds_read_b128 v[128:131], v251 offset:5376
    ds_read_b128 v[132:135], v251 offset:6048
    s_mov_b64 exec, -1
    v_exp_f32 v60, v60
    v_exp_f32 v61, v61
    v_exp_f32 v62, v62
    v_exp_f32 v63, v63
    v_mfma_f32_32x32x8bf16_1k v[40:55], v[116:117], v[32:33], v[40:55]
    v_cvt_pk_bf16_f32 v72, v56, v57
    v_cvt_pk_bf16_f32 v73, v58, v59
    v_cvt_pk_bf16_f32 v74, v60, v61
    v_cvt_pk_bf16_f32 v75, v62, v63
    v_exp_f32 v64, v64
    v_exp_f32 v65, v65
    v_mfma_f32_32x32x16_bf16 v[80:95], v[136:139], v[72:75], v[80:95]
    v_bfe_u32 v12, v1, 2, 3
    v_lshrrev_b32 v14, 5, v1
    v_lshl_or_b32 v12, v14, 4, v12
    v_mul_u32_u24 v12, 160, v12
    v_and_b32 v14, 3, v1
    v_lshl_add_u32 v216, v14, 3, v12
    s_mul_i32 s74, s68, 51200
    v_add_u32 v216, s74, v216
    v_sub_f32 v206, 1.0, v223
    v_cvt_pk_bf16_f32 v206, v206, v206
    v_lshlrev_b32 v206, 16, v206
    v_exp_f32 v66, v66
    v_exp_f32 v67, v67
    v_exp_f32 v68, v68
    v_exp_f32 v69, v69
    v_exp_f32 v70, v70
    v_exp_f32 v71, v71
    v_cvt_pk_bf16_f32 v76, v64, v65
    v_cvt_pk_bf16_f32 v77, v66, v67
    v_cvt_pk_bf16_f32 v78, v68, v69
    v_cvt_pk_bf16_f32 v79, v70, v71
    s_add_u32 m0, s79, 40960
    s_add_u32 s76, s78, 327680
    buffer_load_dwordx4 v6, s[44:47], s76 offen offset:2048 lds
    s_waitcnt lgkmcnt(0)
    s_setprio 1
    v_mfma_f32_32x32x16_bf16 v[80:95], v[140:143], v[76:79], v[80:95]
    ds_read_b128 v[112:115], v245 offset:10752
    ds_read_b64 v[116:117], v248 offset:10752
    v_exp_f32 v40, v40
    v_exp_f32 v41, v41
    v_exp_f32 v42, v42
    v_exp_f32 v43, v43
    v_mfma_f32_32x32x16_bf16 v[56:71], v[120:123], v[28:31], 0
    s_mov_b64 exec, s[90:91]
    ds_read_b128 v[136:139], v251 offset:8064
    ds_read_b128 v[140:143], v251 offset:8736
    s_mov_b64 exec, -1
    v_exp_f32 v44, v44
    v_exp_f32 v45, v45
    v_exp_f32 v46, v46
    v_exp_f32 v47, v47
    v_mfma_f32_32x32x8bf16_1k v[56:71], v[124:125], v[32:33], v[56:71]
    v_cvt_pk_bf16_f32 v72, v40, v41
    v_cvt_pk_bf16_f32 v73, v42, v43
    v_cvt_pk_bf16_f32 v74, v44, v45
    v_cvt_pk_bf16_f32 v75, v46, v47
    v_exp_f32 v48, v48
    v_exp_f32 v49, v49
    v_mfma_f32_32x32x16_bf16 v[80:95], v[128:131], v[72:75], v[80:95]
    v_lshrrev_b32 v217, 2, v1
    v_lshlrev_b32 v217, 7, v217
    v_and_b32 v12, 3, v1
    v_lshl_add_u32 v217, v12, 3, v217
    s_mul_i32 s75, s68, 6144
    s_lshl_b32 s74, s67, 5
    s_add_u32 s75, s75, s74
    s_add_u32 s75, s75, 123904
    v_add_u32 v217, s75, v217
    s_mul_i32 s74, s67, 5120
    s_add_u32 s74, s74, 138304
    v_add_u32 v218, s74, v9
    v_exp_f32 v50, v50
    v_exp_f32 v51, v51
    v_exp_f32 v52, v52
    v_exp_f32 v53, v53
    v_exp_f32 v54, v54
    v_exp_f32 v55, v55
    v_cvt_pk_bf16_f32 v76, v48, v49
    v_cvt_pk_bf16_f32 v77, v50, v51
    v_cvt_pk_bf16_f32 v78, v52, v53
    v_cvt_pk_bf16_f32 v79, v54, v55
    s_add_u32 m0, s79, 40960
    s_add_u32 s76, s78, 327680
    buffer_load_dwordx4 v7, s[44:47], s76 offen offset:3072 lds
    s_waitcnt lgkmcnt(0)
    v_mfma_f32_32x32x16_bf16 v[80:95], v[132:135], v[76:79], v[80:95]
    ds_read_b128 v[120:123], v245 offset:13440
    ds_read_b64 v[124:125], v248 offset:13440
    v_exp_f32 v56, v56
    v_exp_f32 v57, v57
    v_exp_f32 v58, v58
    v_exp_f32 v59, v59
    v_mfma_f32_32x32x16_bf16 v[40:55], v[112:115], v[28:31], 0
    s_mov_b64 exec, s[90:91]
    ds_read_b128 v[128:131], v251 offset:10752
    ds_read_b128 v[132:135], v251 offset:11424
    s_mov_b64 exec, -1
    v_exp_f32 v60, v60
    v_exp_f32 v61, v61
    v_exp_f32 v62, v62
    v_exp_f32 v63, v63
    v_mfma_f32_32x32x8bf16_1k v[40:55], v[116:117], v[32:33], v[40:55]
    v_cvt_pk_bf16_f32 v72, v56, v57
    v_cvt_pk_bf16_f32 v73, v58, v59
    v_cvt_pk_bf16_f32 v74, v60, v61
    v_cvt_pk_bf16_f32 v75, v62, v63
    v_exp_f32 v64, v64
    v_exp_f32 v65, v65
    v_mfma_f32_32x32x16_bf16 v[80:95], v[136:139], v[72:75], v[80:95]
    v_exp_f32 v66, v66
    v_exp_f32 v67, v67
    v_exp_f32 v68, v68
    v_exp_f32 v69, v69
    v_exp_f32 v70, v70
    v_exp_f32 v71, v71
    v_cvt_pk_bf16_f32 v76, v64, v65
    v_cvt_pk_bf16_f32 v77, v66, v67
    v_cvt_pk_bf16_f32 v78, v68, v69
    v_cvt_pk_bf16_f32 v79, v70, v71
    s_add_u32 m0, s79, 45056
    s_add_u32 s76, s78, 327680
    buffer_load_dwordx4 v8, s[44:47], s76 offen lds
    s_waitcnt lgkmcnt(0)
    s_setprio 0
    v_mfma_f32_32x32x16_bf16 v[80:95], v[140:143], v[76:79], v[80:95]
    ds_read_b128 v[112:115], v245 offset:16128
    ds_read_b64 v[116:117], v248 offset:16128
    v_exp_f32 v40, v40
    v_exp_f32 v41, v41
    v_exp_f32 v42, v42
    v_exp_f32 v43, v43
    v_mfma_f32_32x32x16_bf16 v[56:71], v[120:123], v[28:31], 0
    s_mov_b64 exec, s[90:91]
    ds_read_b128 v[136:139], v251 offset:13440
    ds_read_b128 v[140:143], v251 offset:14112
    s_mov_b64 exec, -1
    v_exp_f32 v44, v44
    v_exp_f32 v45, v45
    v_exp_f32 v46, v46
    v_exp_f32 v47, v47
    v_mfma_f32_32x32x8bf16_1k v[56:71], v[124:125], v[32:33], v[56:71]
    v_cvt_pk_bf16_f32 v72, v40, v41
    v_cvt_pk_bf16_f32 v73, v42, v43
    v_cvt_pk_bf16_f32 v74, v44, v45
    v_cvt_pk_bf16_f32 v75, v46, v47
    v_exp_f32 v48, v48
    v_exp_f32 v49, v49
    v_mfma_f32_32x32x16_bf16 v[80:95], v[128:131], v[72:75], v[80:95]
    s_mul_i32 s76, s67, 5120
    s_add_u32 s76, s76, s93
    s_add_u32 m0, s76, 81920
    s_mul_i32 s76, s67, 40960
    s_add_u32 s76, s76, s96
    s_add_u32 s76, s76, 655360
    buffer_load_dwordx4 v238, s[44:47], s76 offen lds
    v_exp_f32 v50, v50
    v_exp_f32 v51, v51
    v_exp_f32 v52, v52
    v_exp_f32 v53, v53
    v_exp_f32 v54, v54
    v_exp_f32 v55, v55
    v_cvt_pk_bf16_f32 v76, v48, v49
    v_cvt_pk_bf16_f32 v77, v50, v51
    v_cvt_pk_bf16_f32 v78, v52, v53
    v_cvt_pk_bf16_f32 v79, v54, v55
    s_mul_i32 s76, s67, 5120
    s_add_u32 s76, s76, s93
    s_add_u32 m0, s76, 83968
    s_mul_i32 s76, s67, 40960
    s_add_u32 s76, s76, s96
    s_add_u32 s76, s76, 655360
    buffer_load_dwordx4 v239, s[44:47], s76 offen lds
    s_waitcnt lgkmcnt(0)
    v_mfma_f32_32x32x16_bf16 v[80:95], v[132:135], v[76:79], v[80:95]
    ds_read_b128 v[120:123], v245 offset:18816
    ds_read_b64 v[124:125], v248 offset:18816
    v_exp_f32 v56, v56
    v_exp_f32 v57, v57
    v_exp_f32 v58, v58
    v_exp_f32 v59, v59
    v_mfma_f32_32x32x16_bf16 v[40:55], v[112:115], v[28:31], 0
    s_mov_b64 exec, s[90:91]
    ds_read_b128 v[128:131], v251 offset:16128
    ds_read_b128 v[132:135], v251 offset:16800
    s_mov_b64 exec, -1
    v_exp_f32 v60, v60
    v_exp_f32 v61, v61
    v_exp_f32 v62, v62
    v_exp_f32 v63, v63
    v_mfma_f32_32x32x8bf16_1k v[40:55], v[116:117], v[32:33], v[40:55]
    v_cvt_pk_bf16_f32 v72, v56, v57
    v_cvt_pk_bf16_f32 v73, v58, v59
    v_cvt_pk_bf16_f32 v74, v60, v61
    v_cvt_pk_bf16_f32 v75, v62, v63
    v_exp_f32 v64, v64
    v_exp_f32 v65, v65
    v_mfma_f32_32x32x16_bf16 v[80:95], v[136:139], v[72:75], v[80:95]
    v_exp_f32 v66, v66
    v_exp_f32 v67, v67
    v_exp_f32 v68, v68
    v_exp_f32 v69, v69
    v_exp_f32 v70, v70
    v_exp_f32 v71, v71
    v_cvt_pk_bf16_f32 v76, v64, v65
    v_cvt_pk_bf16_f32 v77, v66, v67
    v_cvt_pk_bf16_f32 v78, v68, v69
    v_cvt_pk_bf16_f32 v79, v70, v71
    s_mul_i32 s76, s67, 5120
    s_add_u32 m0, s76, 86016
    s_mul_i32 s76, s67, 40960
    s_add_u32 s76, s76, s96
    s_add_u32 s76, s76, 655360
    buffer_load_dwordx4 v8, s[44:47], s76 offen lds
    s_waitcnt vmcnt(8) lgkmcnt(0)
    s_barrier
    s_setprio 3
    v_mfma_f32_32x32x16_bf16 v[80:95], v[140:143], v[76:79], v[80:95]
    ds_read_b128 v[112:115], v246 offset:0
    ds_read_b64 v[116:117], v249 offset:0
    v_exp_f32 v40, v40
    v_exp_f32 v41, v41
    v_exp_f32 v42, v42
    v_exp_f32 v43, v43
    v_mfma_f32_32x32x16_bf16 v[56:71], v[120:123], v[28:31], 0
    s_mov_b64 exec, s[90:91]
    ds_read_b128 v[136:139], v251 offset:18816
    ds_read_b128 v[140:143], v251 offset:19488
    s_mov_b64 exec, -1
    v_cmp_ne_u32 vcc, 32, v237
    s_cbranch_vccnz L_fcwait
L_fcok:
    v_exp_f32 v44, v44
    v_exp_f32 v45, v45
    v_exp_f32 v46, v46
    v_exp_f32 v47, v47
    v_mfma_f32_32x32x8bf16_1k v[56:71], v[124:125], v[32:33], v[56:71]
    v_cvt_pk_bf16_f32 v72, v40, v41
    v_cvt_pk_bf16_f32 v73, v42, v43
    v_cvt_pk_bf16_f32 v74, v44, v45
    v_cvt_pk_bf16_f32 v75, v46, v47
    v_exp_f32 v48, v48
    v_exp_f32 v49, v49
    v_mfma_f32_32x32x16_bf16 v[80:95], v[128:131], v[72:75], v[80:95]
    v_exp_f32 v50, v50
    v_exp_f32 v51, v51
    v_exp_f32 v52, v52
    v_exp_f32 v53, v53
    v_exp_f32 v54, v54
    v_exp_f32 v55, v55
    v_cvt_pk_bf16_f32 v76, v48, v49
    v_cvt_pk_bf16_f32 v77, v50, v51
    v_cvt_pk_bf16_f32 v78, v52, v53
    v_cvt_pk_bf16_f32 v79, v54, v55
    s_add_u32 m0, s79, 0
    s_add_u32 s76, s78, 0
    buffer_load_dwordx4 v4, s[44:47], s76 offen offset:0 lds
    s_waitcnt lgkmcnt(0)
    v_mfma_f32_32x32x16_bf16 v[80:95], v[132:135], v[76:79], v[80:95]
    ds_read_b128 v[120:123], v246 offset:2688
    ds_read_b64 v[124:125], v249 offset:2688
    v_exp_f32 v56, v56
    v_exp_f32 v57, v57
    v_exp_f32 v58, v58
    v_exp_f32 v59, v59
    v_mfma_f32_32x32x16_bf16 v[40:55], v[112:115], v[28:31], 0
    s_mov_b64 exec, s[90:91]
    ds_read_b128 v[128:131], v252 offset:0
    ds_read_b128 v[132:135], v252 offset:672
    s_mov_b64 exec, -1
    v_exp_f32 v60, v60
    v_exp_f32 v61, v61
    v_exp_f32 v62, v62
    v_exp_f32 v63, v63
    v_mfma_f32_32x32x8bf16_1k v[40:55], v[116:117], v[32:33], v[40:55]
    v_cvt_pk_bf16_f32 v72, v56, v57
    v_cvt_pk_bf16_f32 v73, v58, v59
    v_cvt_pk_bf16_f32 v74, v60, v61
    v_cvt_pk_bf16_f32 v75, v62, v63
    v_exp_f32 v64, v64
    v_exp_f32 v65, v65
    v_mfma_f32_32x32x16_bf16 v[80:95], v[136:139], v[72:75], v[80:95]
    s_add_u32 m0, s79, 0
    s_add_u32 s76, s78, 0
    buffer_load_dwordx4 v5, s[44:47], s76 offen offset:1024 lds
    v_exp_f32 v66, v66
    v_exp_f32 v67, v67
    v_exp_f32 v68, v68
    v_exp_f32 v69, v69
    v_exp_f32 v70, v70
    v_exp_f32 v71, v71
    v_cvt_pk_bf16_f32 v76, v64, v65
    v_cvt_pk_bf16_f32 v77, v66, v67
    v_cvt_pk_bf16_f32 v78, v68, v69
    v_cvt_pk_bf16_f32 v79, v70, v71
    s_add_u32 m0, s79, 0
    s_add_u32 s76, s78, 0
    buffer_load_dwordx4 v6, s[44:47], s76 offen offset:2048 lds
    s_waitcnt lgkmcnt(0)
    s_setprio 2
    v_mfma_f32_32x32x16_bf16 v[80:95], v[140:143], v[76:79], v[80:95]
    ds_read_b128 v[112:115], v246 offset:5376
    ds_read_b64 v[116:117], v249 offset:5376
    v_exp_f32 v40, v40
    v_exp_f32 v41, v41
    v_exp_f32 v42, v42
    v_exp_f32 v43, v43
    v_mfma_f32_32x32x16_bf16 v[56:71], v[120:123], v[28:31], 0
    s_mov_b64 exec, s[90:91]
    ds_read_b128 v[136:139], v252 offset:2688
    ds_read_b128 v[140:143], v252 offset:3360
    s_mov_b64 exec, -1
    v_exp_f32 v44, v44
    v_exp_f32 v45, v45
    v_exp_f32 v46, v46
    v_exp_f32 v47, v47
    v_mfma_f32_32x32x8bf16_1k v[56:71], v[124:125], v[32:33], v[56:71]
    v_cvt_pk_bf16_f32 v72, v40, v41
    v_cvt_pk_bf16_f32 v73, v42, v43
    v_cvt_pk_bf16_f32 v74, v44, v45
    v_cvt_pk_bf16_f32 v75, v46, v47
    v_exp_f32 v48, v48
    v_exp_f32 v49, v49
    v_mfma_f32_32x32x16_bf16 v[80:95], v[128:131], v[72:75], v[80:95]
    s_add_u32 m0, s79, 0
    s_add_u32 s76, s78, 0
    buffer_load_dwordx4 v7, s[44:47], s76 offen offset:3072 lds
    v_exp_f32 v50, v50
    v_exp_f32 v51, v51
    v_exp_f32 v52, v52
    v_exp_f32 v53, v53
    v_exp_f32 v54, v54
    v_exp_f32 v55, v55
    v_cvt_pk_bf16_f32 v76, v48, v49
    v_cvt_pk_bf16_f32 v77, v50, v51
    v_cvt_pk_bf16_f32 v78, v52, v53
    v_cvt_pk_bf16_f32 v79, v54, v55
    s_add_u32 m0, s79, 4096
    s_add_u32 s76, s78, 0
    buffer_load_dwordx4 v8, s[44:47], s76 offen lds
    s_waitcnt lgkmcnt(0)
    v_mfma_f32_32x32x16_bf16 v[80:95], v[132:135], v[76:79], v[80:95]
    ds_read_b128 v[120:123], v246 offset:8064
    ds_read_b64 v[124:125], v249 offset:8064
    v_exp_f32 v56, v56
    v_exp_f32 v57, v57
    v_exp_f32 v58, v58
    v_exp_f32 v59, v59
    v_mfma_f32_32x32x16_bf16 v[40:55], v[112:115], v[28:31], 0
    s_mov_b64 exec, s[90:91]
    ds_read_b128 v[128:131], v252 offset:5376
    ds_read_b128 v[132:135], v252 offset:6048
    s_mov_b64 exec, -1
    v_exp_f32 v60, v60
    v_exp_f32 v61, v61
    v_exp_f32 v62, v62
    v_exp_f32 v63, v63
    v_mfma_f32_32x32x8bf16_1k v[40:55], v[116:117], v[32:33], v[40:55]
    v_cvt_pk_bf16_f32 v72, v56, v57
    v_cvt_pk_bf16_f32 v73, v58, v59
    v_cvt_pk_bf16_f32 v74, v60, v61
    v_cvt_pk_bf16_f32 v75, v62, v63
    v_exp_f32 v64, v64
    v_exp_f32 v65, v65
    v_mfma_f32_32x32x16_bf16 v[80:95], v[136:139], v[72:75], v[80:95]
    v_lshrrev_b32 v236, 3, v1
    v_lshlrev_b32 v236, 12, v236
    v_and_b32 v12, 7, v1
    v_lshl_add_u32 v236, v12, 4, v236
    s_mul_i32 s76, s66, 80
    s_lshl_b32 s77, s64, 3
    s_add_u32 s76, s76, s77
    s_lshl_b32 s76, s76, 12
    s_lshl_b32 s77, s65, 7
    s_add_u32 s76, s76, s77
    s_add_u32 s86, s76, 10485760
    s_add_u32 s87, s86, 262144
    buffer_load_dwordx4 v[208:211], v236, s[52:55], s86 offen sc1
    s_cmp_ge_u32 s64, 2
    s_cbranch_scc1 L_yl_155
    buffer_load_dwordx4 v[212:215], v236, s[52:55], s87 offen sc1
L_yl_155:
    v_exp_f32 v66, v66
    v_exp_f32 v67, v67
    v_exp_f32 v68, v68
    v_exp_f32 v69, v69
    v_exp_f32 v70, v70
    v_exp_f32 v71, v71
    v_cvt_pk_bf16_f32 v76, v64, v65
    v_cvt_pk_bf16_f32 v77, v66, v67
    v_cvt_pk_bf16_f32 v78, v68, v69
    v_cvt_pk_bf16_f32 v79, v70, v71
    s_waitcnt lgkmcnt(0)
    s_setprio 1
    v_mfma_f32_32x32x16_bf16 v[80:95], v[140:143], v[76:79], v[80:95]
    ds_read_b128 v[112:115], v246 offset:10752
    ds_read_b64 v[116:117], v249 offset:10752
    v_exp_f32 v40, v40
    v_exp_f32 v41, v41
    v_exp_f32 v42, v42
    v_exp_f32 v43, v43
    v_mfma_f32_32x32x16_bf16 v[56:71], v[120:123], v[28:31], 0
    s_mov_b64 exec, s[90:91]
    ds_read_b128 v[136:139], v252 offset:8064
    ds_read_b128 v[140:143], v252 offset:8736
    s_mov_b64 exec, -1
    v_exp_f32 v44, v44
    v_exp_f32 v45, v45
    v_exp_f32 v46, v46
    v_exp_f32 v47, v47
    v_mfma_f32_32x32x8bf16_1k v[56:71], v[124:125], v[32:33], v[56:71]
    v_cvt_pk_bf16_f32 v72, v40, v41
    v_cvt_pk_bf16_f32 v73, v42, v43
    v_cvt_pk_bf16_f32 v74, v44, v45
    v_cvt_pk_bf16_f32 v75, v46, v47
    v_exp_f32 v48, v48
    v_exp_f32 v49, v49
    v_mfma_f32_32x32x16_bf16 v[80:95], v[128:131], v[72:75], v[80:95]
    v_exp_f32 v50, v50
    v_exp_f32 v51, v51
    v_exp_f32 v52, v52
    v_exp_f32 v53, v53
    v_exp_f32 v54, v54
    v_exp_f32 v55, v55
    v_cvt_pk_bf16_f32 v76, v48, v49
    v_cvt_pk_bf16_f32 v77, v50, v51
    v_cvt_pk_bf16_f32 v78, v52, v53
    v_cvt_pk_bf16_f32 v79, v54, v55
    s_waitcnt lgkmcnt(0)
    s_nop 0
    v_mfma_f32_32x32x16_bf16 v[80:95], v[132:135], v[76:79], v[80:95]
    ds_read_b128 v[120:123], v246 offset:13440
    ds_read_b64 v[124:125], v249 offset:13440
    v_exp_f32 v56, v56
    v_exp_f32 v57, v57
    v_exp_f32 v58, v58
    v_exp_f32 v59, v59
    v_mfma_f32_32x32x16_bf16 v[40:55], v[112:115], v[28:31], 0
    s_mov_b64 exec, s[90:91]
    ds_read_b128 v[128:131], v252 offset:10752
    ds_read_b128 v[132:135], v252 offset:11424
    s_mov_b64 exec, -1
    v_exp_f32 v60, v60
    v_exp_f32 v61, v61
    v_exp_f32 v62, v62
    v_exp_f32 v63, v63
    v_mfma_f32_32x32x8bf16_1k v[40:55], v[116:117], v[32:33], v[40:55]
    v_cvt_pk_bf16_f32 v72, v56, v57
    v_cvt_pk_bf16_f32 v73, v58, v59
    v_cvt_pk_bf16_f32 v74, v60, v61
    v_cvt_pk_bf16_f32 v75, v62, v63
    v_exp_f32 v64, v64
    v_exp_f32 v65, v65
    v_mfma_f32_32x32x16_bf16 v[80:95], v[136:139], v[72:75], v[80:95]
    v_exp_f32 v66, v66
    v_exp_f32 v67, v67
    v_exp_f32 v68, v68
    v_exp_f32 v69, v69
    v_exp_f32 v70, v70
    v_exp_f32 v71, v71
    v_cvt_pk_bf16_f32 v76, v64, v65
    v_cvt_pk_bf16_f32 v77, v66, v67
    v_cvt_pk_bf16_f32 v78, v68, v69
    v_cvt_pk_bf16_f32 v79, v70, v71
    s_waitcnt lgkmcnt(0)
    s_setprio 0
    v_mfma_f32_32x32x16_bf16 v[80:95], v[140:143], v[76:79], v[80:95]
    ds_read_b128 v[112:115], v246 offset:16128
    ds_read_b64 v[116:117], v249 offset:16128
    v_exp_f32 v40, v40
    v_exp_f32 v41, v41
    v_exp_f32 v42, v42
    v_exp_f32 v43, v43
    v_mfma_f32_32x32x16_bf16 v[56:71], v[120:123], v[28:31], 0
    s_mov_b64 exec, s[90:91]
    ds_read_b128 v[136:139], v252 offset:13440
    ds_read_b128 v[140:143], v252 offset:14112
    s_mov_b64 exec, -1
    v_exp_f32 v44, v44
    v_exp_f32 v45, v45
    v_exp_f32 v46, v46
    v_exp_f32 v47, v47
    v_mfma_f32_32x32x8bf16_1k v[56:71], v[124:125], v[32:33], v[56:71]
    v_cvt_pk_bf16_f32 v72, v40, v41
    v_cvt_pk_bf16_f32 v73, v42, v43
    v_cvt_pk_bf16_f32 v74, v44, v45
    v_cvt_pk_bf16_f32 v75, v46, v47
    v_exp_f32 v48, v48
    v_exp_f32 v49, v49
    v_mfma_f32_32x32x16_bf16 v[80:95], v[128:131], v[72:75], v[80:95]
    s_waitcnt vmcnt(0)
    s_lshl_b32 s75, s64, 10
    s_add_u32 s75, s75, 123904
    v_max3_u32 v16, v208, v209, v210
    v_max_u32 v16, v16, v211
    v_cmp_eq_u32 vcc, -1, v16
    v_add_u32 v12, s75, v9
    s_cbranch_vccnz L_yre0
L_yok0:
    ds_write_b128 v12, v[208:211]
    s_cmp_ge_u32 s64, 2
    s_cbranch_scc1 L_yok1b
    v_max3_u32 v16, v212, v213, v214
    v_max_u32 v16, v16, v215
    v_cmp_eq_u32 vcc, -1, v16
    s_cbranch_vccnz L_yre1
L_yok1:
    ds_write_b128 v12, v[212:215] offset:8192
L_yok1b:
    v_exp_f32 v50, v50
    v_exp_f32 v51, v51
    v_exp_f32 v52, v52
    v_exp_f32 v53, v53
    v_exp_f32 v54, v54
    v_exp_f32 v55, v55
    v_cvt_pk_bf16_f32 v76, v48, v49
    v_cvt_pk_bf16_f32 v77, v50, v51
    v_cvt_pk_bf16_f32 v78, v52, v53
    v_cvt_pk_bf16_f32 v79, v54, v55
    s_waitcnt lgkmcnt(0)
    s_nop 0
    v_mfma_f32_32x32x16_bf16 v[80:95], v[132:135], v[76:79], v[80:95]
    ds_read_b128 v[120:123], v246 offset:18816
    ds_read_b64 v[124:125], v249 offset:18816
    v_exp_f32 v56, v56
    v_exp_f32 v57, v57
    v_exp_f32 v58, v58
    v_exp_f32 v59, v59
    v_mfma_f32_32x32x16_bf16 v[40:55], v[112:115], v[28:31], 0
    s_mov_b64 exec, s[90:91]
    ds_read_b128 v[128:131], v252 offset:16128
    ds_read_b128 v[132:135], v252 offset:16800
    s_mov_b64 exec, -1
    v_exp_f32 v60, v60
    v_exp_f32 v61, v61
    v_exp_f32 v62, v62
    v_exp_f32 v63, v63
    v_mfma_f32_32x32x8bf16_1k v[40:55], v[116:117], v[32:33], v[40:55]
    v_cvt_pk_bf16_f32 v72, v56, v57
    v_cvt_pk_bf16_f32 v73, v58, v59
    v_cvt_pk_bf16_f32 v74, v60, v61
    v_cvt_pk_bf16_f32 v75, v62, v63
    v_exp_f32 v64, v64
    v_exp_f32 v65, v65
    v_mfma_f32_32x32x16_bf16 v[80:95], v[136:139], v[72:75], v[80:95]
    v_exp_f32 v66, v66
    v_exp_f32 v67, v67
    v_exp_f32 v68, v68
    v_exp_f32 v69, v69
    v_exp_f32 v70, v70
    v_exp_f32 v71, v71
    v_cvt_pk_bf16_f32 v76, v64, v65
    v_cvt_pk_bf16_f32 v77, v66, v67
    v_cvt_pk_bf16_f32 v78, v68, v69
    v_cvt_pk_bf16_f32 v79, v70, v71
    s_waitcnt vmcnt(63) lgkmcnt(0)
    s_barrier
    s_setprio 3
    v_mfma_f32_32x32x16_bf16 v[80:95], v[140:143], v[76:79], v[80:95]
    v_exp_f32 v40, v40
    v_exp_f32 v41, v41
    v_exp_f32 v42, v42
    v_exp_f32 v43, v43
    v_mfma_f32_32x32x16_bf16 v[56:71], v[120:123], v[28:31], 0
    s_mov_b64 exec, s[90:91]
    ds_read_b128 v[136:139], v252 offset:18816
    ds_read_b128 v[140:143], v252 offset:19488
    s_mov_b64 exec, -1
    v_exp_f32 v44, v44
    v_exp_f32 v45, v45
    v_exp_f32 v46, v46
    v_exp_f32 v47, v47
    v_mfma_f32_32x32x8bf16_1k v[56:71], v[124:125], v[32:33], v[56:71]
    v_cvt_pk_bf16_f32 v72, v40, v41
    v_cvt_pk_bf16_f32 v73, v42, v43
    v_cvt_pk_bf16_f32 v74, v44, v45
    v_cvt_pk_bf16_f32 v75, v46, v47
    v_exp_f32 v48, v48
    v_exp_f32 v49, v49
    v_mfma_f32_32x32x16_bf16 v[80:95], v[128:131], v[72:75], v[80:95]
    v_exp_f32 v50, v50
    v_exp_f32 v51, v51
    v_exp_f32 v52, v52
    v_exp_f32 v53, v53
    v_exp_f32 v54, v54
    v_exp_f32 v55, v55
    v_cvt_pk_bf16_f32 v76, v48, v49
    v_cvt_pk_bf16_f32 v77, v50, v51
    v_cvt_pk_bf16_f32 v78, v52, v53
    v_cvt_pk_bf16_f32 v79, v54, v55
    s_waitcnt lgkmcnt(0)
    s_nop 0
    v_mfma_f32_32x32x16_bf16 v[80:95], v[132:135], v[76:79], v[80:95]
    v_exp_f32 v56, v56
    v_exp_f32 v57, v57
    v_exp_f32 v58, v58
    v_exp_f32 v59, v59
    v_exp_f32 v60, v60
    v_exp_f32 v61, v61
    v_exp_f32 v62, v62
    v_exp_f32 v63, v63
    v_cvt_pk_bf16_f32 v72, v56, v57
    v_cvt_pk_bf16_f32 v73, v58, v59
    v_cvt_pk_bf16_f32 v74, v60, v61
    v_cvt_pk_bf16_f32 v75, v62, v63
    v_exp_f32 v64, v64
    v_exp_f32 v65, v65
    v_mfma_f32_32x32x16_bf16 v[80:95], v[136:139], v[72:75], v[80:95]
    v_exp_f32 v66, v66
    v_exp_f32 v67, v67
    v_exp_f32 v68, v68
    v_exp_f32 v69, v69
    v_exp_f32 v70, v70
    v_exp_f32 v71, v71
    v_cvt_pk_bf16_f32 v76, v64, v65
    v_cvt_pk_bf16_f32 v77, v66, v67
    v_cvt_pk_bf16_f32 v78, v68, v69
    v_cvt_pk_bf16_f32 v79, v70, v71
    s_setprio 0
    s_nop 0
    v_mfma_f32_32x32x16_bf16 v[80:95], v[140:143], v[76:79], v[80:95]
L_oepi:
    s_nop 11
    v_mov_b32 v13, v88
    v_mov_b32 v14, v88
    s_nop 1
    v_permlane32_swap_b32 v13, v14
    s_cmp_lg_u32 s89, 0
    s_cbranch_scc1 L_nochk
    v_mov_b32 v15, 0x1f800000
    v_cmp_nge_f32 vcc, v14, v15
    s_cbranch_vccnz L_fallback
    v_mov_b32 v15, 0x4b800000
    v_cmp_nle_f32 vcc, v14, v15
    s_cbranch_vccnz L_fallback
L_nochk:
    v_rcp_f32 v14, v14
    s_nop 0
    v_pk_mul_f32 v[80:81], v[80:81], v[14:15] op_sel_hi:[1,0]
    v_pk_mul_f32 v[82:83], v[82:83], v[14:15] op_sel_hi:[1,0]
    v_pk_mul_f32 v[84:85], v[84:85], v[14:15] op_sel_hi:[1,0]
    v_pk_mul_f32 v[86:87], v[86:87], v[14:15] op_sel_hi:[1,0]
    v_pk_mul_f32 v[88:89], v[88:89], v[14:15] op_sel_hi:[1,0]
    v_pk_mul_f32 v[90:91], v[90:91], v[14:15] op_sel_hi:[1,0]
    v_cvt_pk_bf16_f32 v42, v80, v81
    v_cvt_pk_bf16_f32 v43, v82, v83
    v_cvt_pk_bf16_f32 v44, v84, v85
    v_cvt_pk_bf16_f32 v45, v86, v87
    v_cvt_pk_bf16_f32 v46, v88, v89
    v_cvt_pk_bf16_f32 v47, v90, v91
    s_bitcmp1_b32 s64, 0
    s_cbranch_scc1 L_oodd
    v_permlane32_swap_b32 v42, v44
    v_permlane32_swap_b32 v43, v45
    s_cmp_eq_u32 s80, 1
    s_cbranch_scc0 L_orem_156
    buffer_store_dwordx4 v[42:45], v241, s[52:55], s81 offen
    s_mov_b64 exec, s[94:95]
    buffer_store_dwordx2 v[46:47], v240, s[52:55], s81 offen offset:512
    s_mov_b64 exec, -1
    s_branch L_odone
L_orem_156:
    buffer_store_dwordx4 v[42:45], v241, s[52:55], s81 offen sc1
    s_mov_b64 exec, s[94:95]
    buffer_store_dwordx2 v[46:47], v240, s[52:55], s81 offen offset:512 sc1
    s_mov_b64 exec, -1
    s_branch L_odone
L_oodd:
    v_mov_b32 v48, v44
    v_mov_b32 v49, v45
    s_nop 0
    v_permlane32_swap_b32 v42, v48
    v_permlane32_swap_b32 v43, v49
    v_permlane32_swap_b32 v44, v46
    v_permlane32_swap_b32 v45, v47
    v_mov_b32 v50, v44
    v_mov_b32 v51, v45
    s_cmp_eq_u32 s80, 1
    s_cbranch_scc0 L_orem_157
    buffer_store_dwordx4 v[48:51], v241, s[52:55], s81 offen offset:256
    s_mov_b64 exec, s[94:95]
    buffer_store_dwordx2 v[42:43], v240, s[52:55], s81 offen offset:8
    s_mov_b64 exec, -1
    s_branch L_odone
L_orem_157:
    buffer_store_dwordx4 v[48:51], v241, s[52:55], s81 offen offset:256 sc1
    s_mov_b64 exec, s[94:95]
    buffer_store_dwordx2 v[42:43], v240, s[52:55], s81 offen offset:8 sc1
    s_mov_b64 exec, -1
L_odone:
    s_barrier
    buffer_load_dwordx4 v[20:23], v9, s[52:55], s82 offen offset:0 sc1
    buffer_load_dwordx4 v[24:27], v9, s[52:55], s82 offen offset:1024 sc1
    buffer_load_dwordx4 v[28:31], v9, s[52:55], s82 offen offset:2048 sc1
    buffer_load_dwordx4 v[32:35], v9, s[52:55], s82 offen offset:3072 sc1
    buffer_load_dwordx4 v[36:39], v9, s[52:55], s83 offen offset:0 sc1
    ds_read_b64_tr_b16 v[208:209], v217 offset:0
    ds_read_b64_tr_b16 v[210:211], v217 offset:2048
    ds_read_b64_tr_b16 v[212:213], v217 offset:4096
    ds_read_b64_tr_b16 v[100:101], v216 offset:0
    ds_read_b64_tr_b16 v[102:103], v216 offset:1280
    ds_read_b64_tr_b16 v[104:105], v216 offset:32
    ds_read_b64_tr_b16 v[106:107], v216 offset:1312
    ds_read_b64_tr_b16 v[108:109], v216 offset:64
    ds_read_b64_tr_b16 v[110:111], v216 offset:1344
    ds_read_b64_tr_b16 v[112:113], v216 offset:96
    ds_read_b64_tr_b16 v[114:115], v216 offset:1376
    ds_read_b64_tr_b16 v[116:117], v216 offset:128
    ds_read_b64_tr_b16 v[118:119], v216 offset:1408
    ds_read_b64_tr_b16 v[120:121], v216 offset:5120
    ds_read_b64_tr_b16 v[122:123], v216 offset:6400
    ds_read_b64_tr_b16 v[124:125], v216 offset:5152
    ds_read_b64_tr_b16 v[126:127], v216 offset:6432
    ds_read_b64_tr_b16 v[128:129], v216 offset:5184
    ds_read_b64_tr_b16 v[130:131], v216 offset:6464
    ds_read_b64_tr_b16 v[132:133], v216 offset:5216
    ds_read_b64_tr_b16 v[134:135], v216 offset:6496
    ds_read_b64_tr_b16 v[136:137], v216 offset:5248
    ds_read_b64_tr_b16 v[138:139], v216 offset:6528
    ds_read_b64_tr_b16 v[140:141], v216 offset:10240
    ds_read_b64_tr_b16 v[142:143], v216 offset:11520
    ds_read_b64_tr_b16 v[144:145], v216 offset:10272
    ds_read_b64_tr_b16 v[146:147], v216 offset:11552
    ds_read_b64_tr_b16 v[148:149], v216 offset:10304
    ds_read_b64_tr_b16 v[150:151], v216 offset:11584
    ds_read_b64_tr_b16 v[152:153], v216 offset:10336
    ds_read_b64_tr_b16 v[154:155], v216 offset:11616
    ds_read_b64_tr_b16 v[156:157], v216 offset:10368
    ds_read_b64_tr_b16 v[158:159], v216 offset:11648
    buffer_load_dwordx4 v[40:43], v9, s[52:55], s83 offen offset:1024 sc1
    buffer_load_dwordx4 v[44:47], v9, s[52:55], s83 offen offset:2048 sc1
    buffer_load_dwordx4 v[48:51], v9, s[52:55], s83 offen offset:3072 sc1
    buffer_load_dwordx4 v[52:55], v9, s[52:55], s84 offen offset:0 sc1
    buffer_load_dwordx4 v[56:59], v9, s[52:55], s84 offen offset:1024 sc1
    s_waitcnt lgkmcnt(14)
    v_lshlrev_b32 v192, 16, v176
    v_and_b32 v193, 0xffff0000, v176
    v_lshlrev_b32 v194, 16, v177
    v_and_b32 v195, 0xffff0000, v177
    v_lshlrev_b32 v196, 16, v182
    v_and_b32 v197, 0xffff0000, v182
    v_lshlrev_b32 v198, 16, v183
    v_and_b32 v199, 0xffff0000, v183
    v_pk_mul_f32 v[192:193], v[192:193], v[196:197]
    v_pk_mul_f32 v[194:195], v[194:195], v[198:199]
    v_cvt_pk_bf16_f32 v200, v192, v193
    v_cvt_pk_bf16_f32 v201, v194, v195
    v_lshlrev_b32 v192, 16, v200
    v_and_b32 v193, 0xffff0000, v200
    v_lshlrev_b32 v194, 16, v201
    v_and_b32 v195, 0xffff0000, v201
    v_lshlrev_b32 v196, 16, v208
    v_and_b32 v197, 0xffff0000, v208
    v_lshlrev_b32 v198, 16, v209
    v_and_b32 v199, 0xffff0000, v209
    v_pk_add_f32 v[192:193], v[192:193], v[196:197]
    v_pk_add_f32 v[194:195], v[194:195], v[198:199]
    v_cvt_pk_bf16_f32 v200, v192, v193
    v_cvt_pk_bf16_f32 v201, v194, v195
    v_lshlrev_b32 v192, 16, v200
    v_and_b32 v193, 0xffff0000, v200
    v_lshlrev_b32 v194, 16, v201
    v_and_b32 v195, 0xffff0000, v201
    v_pk_mul_f32 v[192:193], v[192:193], v[222:223] op_sel:[0,1] op_sel_hi:[1,1]
    v_pk_mul_f32 v[194:195], v[194:195], v[222:223] op_sel:[0,1] op_sel_hi:[1,1]
    v_cvt_pk_bf16_f32 v200, v192, v193
    v_cvt_pk_bf16_f32 v201, v194, v195
    v_lshlrev_b32 v160, 16, v200
    v_and_b32 v161, 0xffff0000, v200
    v_lshlrev_b32 v162, 16, v201
    v_and_b32 v163, 0xffff0000, v201
    v_lshlrev_b32 v192, 16, v178
    v_and_b32 v193, 0xffff0000, v178
    v_lshlrev_b32 v194, 16, v179
    v_and_b32 v195, 0xffff0000, v179
    v_lshlrev_b32 v196, 16, v184
    v_and_b32 v197, 0xffff0000, v184
    v_lshlrev_b32 v198, 16, v185
    v_and_b32 v199, 0xffff0000, v185
    v_pk_mul_f32 v[192:193], v[192:193], v[196:197]
    v_pk_mul_f32 v[194:195], v[194:195], v[198:199]
    v_cvt_pk_bf16_f32 v200, v192, v193
    v_cvt_pk_bf16_f32 v201, v194, v195
    v_lshlrev_b32 v192, 16, v200
    v_and_b32 v193, 0xffff0000, v200
    v_lshlrev_b32 v194, 16, v201
    v_and_b32 v195, 0xffff0000, v201
    v_lshlrev_b32 v196, 16, v210
    v_and_b32 v197, 0xffff0000, v210
    v_lshlrev_b32 v198, 16, v211
    v_and_b32 v199, 0xffff0000, v211
    v_pk_add_f32 v[192:193], v[192:193], v[196:197]
    v_pk_add_f32 v[194:195], v[194:195], v[198:199]
    v_cvt_pk_bf16_f32 v200, v192, v193
    v_cvt_pk_bf16_f32 v201, v194, v195
    v_lshlrev_b32 v192, 16, v200
    v_and_b32 v193, 0xffff0000, v200
    v_lshlrev_b32 v194, 16, v201
    v_and_b32 v195, 0xffff0000, v201
    v_pk_mul_f32 v[192:193], v[192:193], v[222:223] op_sel:[0,1] op_sel_hi:[1,1]
    v_pk_mul_f32 v[194:195], v[194:195], v[222:223] op_sel:[0,1] op_sel_hi:[1,1]
    v_cvt_pk_bf16_f32 v200, v192, v193
    v_cvt_pk_bf16_f32 v201, v194, v195
    v_lshlrev_b32 v164, 16, v200
    v_and_b32 v165, 0xffff0000, v200
    v_lshlrev_b32 v166, 16, v201
    v_and_b32 v167, 0xffff0000, v201
    s_cmp_eq_u32 s68, 0
    s_cbranch_scc0 L_g2
    v_lshlrev_b32 v192, 16, v180
    v_and_b32 v193, 0xffff0000, v180
    v_lshlrev_b32 v194, 16, v181
    v_and_b32 v195, 0xffff0000, v181
    v_lshlrev_b32 v196, 16, v186
    v_and_b32 v197, 0xffff0000, v186
    v_lshlrev_b32 v198, 16, v187
    v_and_b32 v199, 0xffff0000, v187
    v_pk_mul_f32 v[192:193], v[192:193], v[196:197]
    v_pk_mul_f32 v[194:195], v[194:195], v[198:199]
    v_cvt_pk_bf16_f32 v200, v192, v193
    v_cvt_pk_bf16_f32 v201, v194, v195
    v_lshlrev_b32 v192, 16, v200
    v_and_b32 v193, 0xffff0000, v200
    v_lshlrev_b32 v194, 16, v201
    v_and_b32 v195, 0xffff0000, v201
    v_lshlrev_b32 v196, 16, v212
    v_and_b32 v197, 0xffff0000, v212
    v_lshlrev_b32 v198, 16, v213
    v_and_b32 v199, 0xffff0000, v213
    v_pk_add_f32 v[192:193], v[192:193], v[196:197]
    v_pk_add_f32 v[194:195], v[194:195], v[198:199]
    v_cvt_pk_bf16_f32 v200, v192, v193
    v_cvt_pk_bf16_f32 v201, v194, v195
    v_lshlrev_b32 v192, 16, v200
    v_and_b32 v193, 0xffff0000, v200
    v_lshlrev_b32 v194, 16, v201
    v_and_b32 v195, 0xffff0000, v201
    v_pk_mul_f32 v[192:193], v[192:193], v[222:223] op_sel:[0,1] op_sel_hi:[1,1]
    v_pk_mul_f32 v[194:195], v[194:195], v[222:223] op_sel:[0,1] op_sel_hi:[1,1]
    v_cvt_pk_bf16_f32 v200, v192, v193
    v_cvt_pk_bf16_f32 v201, v194, v195
    v_lshlrev_b32 v168, 16, v200
    v_and_b32 v169, 0xffff0000, v200
    v_lshlrev_b32 v170, 16, v201
    v_and_b32 v171, 0xffff0000, v201
L_g2:
    s_waitcnt vmcnt(9)
    v_max3_u32 v16, v20, v21, v22
    v_max_u32 v16, v16, v23
    v_cmp_eq_u32 vcc, -1, v16
    s_cbranch_vccnz L_oslow_0
L_oback_0:
    s_waitcnt lgkmcnt(14)
    v_mfma_f32_16x16x32_bf16 v[60:63], v[100:103], v[20:23], 0
    ds_read_b64_tr_b16 v[100:101], v216 offset:15360
    ds_read_b64_tr_b16 v[102:103], v216 offset:16640
    v_mfma_f32_16x16x32_bf16 v[64:67], v[104:107], v[20:23], 0
    ds_read_b64_tr_b16 v[104:105], v216 offset:15392
    ds_read_b64_tr_b16 v[106:107], v216 offset:16672
    v_mfma_f32_16x16x32_bf16 v[68:71], v[108:111], v[20:23], 0
    ds_read_b64_tr_b16 v[108:109], v216 offset:15424
    ds_read_b64_tr_b16 v[110:111], v216 offset:16704
    v_mfma_f32_16x16x32_bf16 v[72:75], v[112:115], v[20:23], 0
    ds_read_b64_tr_b16 v[112:113], v216 offset:15456
    ds_read_b64_tr_b16 v[114:115], v216 offset:16736
    v_mfma_f32_16x16x32_bf16 v[76:79], v[116:119], v[20:23], 0
    ds_read_b64_tr_b16 v[116:117], v216 offset:15488
    ds_read_b64_tr_b16 v[118:119], v216 offset:16768
    s_waitcnt vmcnt(8)
    v_max3_u32 v16, v24, v25, v26
    v_max_u32 v16, v16, v27
    v_cmp_eq_u32 vcc, -1, v16
    s_cbranch_vccnz L_oslow_1
L_oback_1:
    s_waitcnt lgkmcnt(14)
    v_mfma_f32_16x16x32_bf16 v[60:63], v[120:123], v[24:27], v[60:63]
    ds_read_b64_tr_b16 v[120:121], v216 offset:20480
    ds_read_b64_tr_b16 v[122:123], v216 offset:21760
    v_mfma_f32_16x16x32_bf16 v[64:67], v[124:127], v[24:27], v[64:67]
    ds_read_b64_tr_b16 v[124:125], v216 offset:20512
    ds_read_b64_tr_b16 v[126:127], v216 offset:21792
    v_mfma_f32_16x16x32_bf16 v[68:71], v[128:131], v[24:27], v[68:71]
    ds_read_b64_tr_b16 v[128:129], v216 offset:20544
    ds_read_b64_tr_b16 v[130:131], v216 offset:21824
    v_mfma_f32_16x16x32_bf16 v[72:75], v[132:135], v[24:27], v[72:75]
    ds_read_b64_tr_b16 v[132:133], v216 offset:20576
    ds_read_b64_tr_b16 v[134:135], v216 offset:21856
    v_mfma_f32_16x16x32_bf16 v[76:79], v[136:139], v[24:27], v[76:79]
    ds_read_b64_tr_b16 v[136:137], v216 offset:20608
    ds_read_b64_tr_b16 v[138:139], v216 offset:21888
    s_waitcnt vmcnt(7)
    v_max3_u32 v16, v28, v29, v30
    v_max_u32 v16, v16, v31
    v_cmp_eq_u32 vcc, -1, v16
    s_cbranch_vccnz L_oslow_2
L_oback_2:
    s_waitcnt lgkmcnt(14)
    v_mfma_f32_16x16x32_bf16 v[60:63], v[140:143], v[28:31], v[60:63]
    ds_read_b64_tr_b16 v[140:141], v216 offset:25600
    ds_read_b64_tr_b16 v[142:143], v216 offset:26880
    v_mfma_f32_16x16x32_bf16 v[64:67], v[144:147], v[28:31], v[64:67]
    ds_read_b64_tr_b16 v[144:145], v216 offset:25632
    ds_read_b64_tr_b16 v[146:147], v216 offset:26912
    v_mfma_f32_16x16x32_bf16 v[68:71], v[148:151], v[28:31], v[68:71]
    ds_read_b64_tr_b16 v[148:149], v216 offset:25664
    ds_read_b64_tr_b16 v[150:151], v216 offset:26944
    v_mfma_f32_16x16x32_bf16 v[72:75], v[152:155], v[28:31], v[72:75]
    ds_read_b64_tr_b16 v[152:153], v216 offset:25696
    ds_read_b64_tr_b16 v[154:155], v216 offset:26976
    v_mfma_f32_16x16x32_bf16 v[76:79], v[156:159], v[28:31], v[76:79]
    ds_read_b64_tr_b16 v[156:157], v216 offset:25728
    ds_read_b64_tr_b16 v[158:159], v216 offset:27008
    s_waitcnt vmcnt(6)
    v_max3_u32 v16, v32, v33, v34
    v_max_u32 v16, v16, v35
    v_cmp_eq_u32 vcc, -1, v16
    s_cbranch_vccnz L_oslow_3
L_oback_3:
    s_waitcnt lgkmcnt(14)
    v_mfma_f32_16x16x32_bf16 v[60:63], v[100:103], v[32:35], v[60:63]
    ds_read_b64_tr_b16 v[100:101], v216 offset:30720
    ds_read_b64_tr_b16 v[102:103], v216 offset:32000
    v_mfma_f32_16x16x32_bf16 v[64:67], v[104:107], v[32:35], v[64:67]
    ds_read_b64_tr_b16 v[104:105], v216 offset:30752
    ds_read_b64_tr_b16 v[106:107], v216 offset:32032
    v_mfma_f32_16x16x32_bf16 v[68:71], v[108:111], v[32:35], v[68:71]
    ds_read_b64_tr_b16 v[108:109], v216 offset:30784
    ds_read_b64_tr_b16 v[110:111], v216 offset:32064
    v_mfma_f32_16x16x32_bf16 v[72:75], v[112:115], v[32:35], v[72:75]
    ds_read_b64_tr_b16 v[112:113], v216 offset:30816
    ds_read_b64_tr_b16 v[114:115], v216 offset:32096
    v_mfma_f32_16x16x32_bf16 v[76:79], v[116:119], v[32:35], v[76:79]
    ds_read_b64_tr_b16 v[116:117], v216 offset:30848
    ds_read_b64_tr_b16 v[118:119], v216 offset:32128
    s_waitcnt vmcnt(5)
    v_max3_u32 v16, v36, v37, v38
    v_max_u32 v16, v16, v39
    v_cmp_eq_u32 vcc, -1, v16
    s_cbranch_vccnz L_oslow_4
L_oback_4:
    s_waitcnt lgkmcnt(14)
    v_mfma_f32_16x16x32_bf16 v[60:63], v[120:123], v[36:39], v[60:63]
    ds_read_b64_tr_b16 v[120:121], v216 offset:35840
    ds_read_b64_tr_b16 v[122:123], v216 offset:37120
    v_mfma_f32_16x16x32_bf16 v[64:67], v[124:127], v[36:39], v[64:67]
    ds_read_b64_tr_b16 v[124:125], v216 offset:35872
    ds_read_b64_tr_b16 v[126:127], v216 offset:37152
    v_mfma_f32_16x16x32_bf16 v[68:71], v[128:131], v[36:39], v[68:71]
    ds_read_b64_tr_b16 v[128:129], v216 offset:35904
    ds_read_b64_tr_b16 v[130:131], v216 offset:37184
    v_mfma_f32_16x16x32_bf16 v[72:75], v[132:135], v[36:39], v[72:75]
    ds_read_b64_tr_b16 v[132:133], v216 offset:35936
    ds_read_b64_tr_b16 v[134:135], v216 offset:37216
    v_mfma_f32_16x16x32_bf16 v[76:79], v[136:139], v[36:39], v[76:79]
    ds_read_b64_tr_b16 v[136:137], v216 offset:35968
    ds_read_b64_tr_b16 v[138:139], v216 offset:37248
    s_waitcnt vmcnt(4)
    v_max3_u32 v16, v40, v41, v42
    v_max_u32 v16, v16, v43
    v_cmp_eq_u32 vcc, -1, v16
    s_cbranch_vccnz L_oslow_5
L_oback_5:
    s_waitcnt lgkmcnt(14)
    v_mfma_f32_16x16x32_bf16 v[60:63], v[140:143], v[40:43], v[60:63]
    ds_read_b64_tr_b16 v[140:141], v216 offset:40960
    ds_read_b64_tr_b16 v[142:143], v216 offset:42240
    v_mfma_f32_16x16x32_bf16 v[64:67], v[144:147], v[40:43], v[64:67]
    ds_read_b64_tr_b16 v[144:145], v216 offset:40992
    ds_read_b64_tr_b16 v[146:147], v216 offset:42272
    v_mfma_f32_16x16x32_bf16 v[68:71], v[148:151], v[40:43], v[68:71]
    ds_read_b64_tr_b16 v[148:149], v216 offset:41024
    ds_read_b64_tr_b16 v[150:151], v216 offset:42304
    v_mfma_f32_16x16x32_bf16 v[72:75], v[152:155], v[40:43], v[72:75]
    ds_read_b64_tr_b16 v[152:153], v216 offset:41056
    ds_read_b64_tr_b16 v[154:155], v216 offset:42336
    v_mfma_f32_16x16x32_bf16 v[76:79], v[156:159], v[40:43], v[76:79]
    ds_read_b64_tr_b16 v[156:157], v216 offset:41088
    ds_read_b64_tr_b16 v[158:159], v216 offset:42368
    s_waitcnt vmcnt(3)
    v_max3_u32 v16, v44, v45, v46
    v_max_u32 v16, v16, v47
    v_cmp_eq_u32 vcc, -1, v16
    s_cbranch_vccnz L_oslow_6
L_oback_6:
    s_waitcnt lgkmcnt(14)
    v_mfma_f32_16x16x32_bf16 v[60:63], v[100:103], v[44:47], v[60:63]
    ds_read_b64_tr_b16 v[100:101], v216 offset:46080
    ds_read_b64_tr_b16 v[102:103], v216 offset:47360
    v_mfma_f32_16x16x32_bf16 v[64:67], v[104:107], v[44:47], v[64:67]
    ds_read_b64_tr_b16 v[104:105], v216 offset:46112
    ds_read_b64_tr_b16 v[106:107], v216 offset:47392
    v_mfma_f32_16x16x32_bf16 v[68:71], v[108:111], v[44:47], v[68:71]
    ds_read_b64_tr_b16 v[108:109], v216 offset:46144
    ds_read_b64_tr_b16 v[110:111], v216 offset:47424
    v_mfma_f32_16x16x32_bf16 v[72:75], v[112:115], v[44:47], v[72:75]
    ds_read_b64_tr_b16 v[112:113], v216 offset:46176
    ds_read_b64_tr_b16 v[114:115], v216 offset:47456
    v_mfma_f32_16x16x32_bf16 v[76:79], v[116:119], v[44:47], v[76:79]
    ds_read_b64_tr_b16 v[116:117], v216 offset:46208
    ds_read_b64_tr_b16 v[118:119], v216 offset:47488
    s_waitcnt vmcnt(2)
    v_max3_u32 v16, v48, v49, v50
    v_max_u32 v16, v16, v51
    v_cmp_eq_u32 vcc, -1, v16
    s_cbranch_vccnz L_oslow_7
L_oback_7:
    s_waitcnt lgkmcnt(14)
    v_mfma_f32_16x16x32_bf16 v[60:63], v[120:123], v[48:51], v[60:63]
    v_mfma_f32_16x16x32_bf16 v[64:67], v[124:127], v[48:51], v[64:67]
    v_mfma_f32_16x16x32_bf16 v[68:71], v[128:131], v[48:51], v[68:71]
    v_mfma_f32_16x16x32_bf16 v[72:75], v[132:135], v[48:51], v[72:75]
    v_mfma_f32_16x16x32_bf16 v[76:79], v[136:139], v[48:51], v[76:79]
    s_waitcnt vmcnt(1)
    v_max3_u32 v16, v52, v53, v54
    v_max_u32 v16, v16, v55
    v_cmp_eq_u32 vcc, -1, v16
    s_cbranch_vccnz L_oslow_8
L_oback_8:
    s_waitcnt lgkmcnt(10)
    v_mfma_f32_16x16x32_bf16 v[60:63], v[140:143], v[52:55], v[60:63]
    v_mfma_f32_16x16x32_bf16 v[64:67], v[144:147], v[52:55], v[64:67]
    v_mfma_f32_16x16x32_bf16 v[68:71], v[148:151], v[52:55], v[68:71]
    v_mfma_f32_16x16x32_bf16 v[72:75], v[152:155], v[52:55], v[72:75]
    v_mfma_f32_16x16x32_bf16 v[76:79], v[156:159], v[52:55], v[76:79]
    s_waitcnt vmcnt(0)
    v_max3_u32 v16, v56, v57, v58
    v_max_u32 v16, v16, v59
    v_cmp_eq_u32 vcc, -1, v16
    s_cbranch_vccnz L_oslow_9
L_oback_9:
    s_waitcnt lgkmcnt(0)
    v_mfma_f32_16x16x32_bf16 v[60:63], v[100:103], v[56:59], v[60:63]
    v_mfma_f32_16x16x32_bf16 v[64:67], v[104:107], v[56:59], v[64:67]
    v_mfma_f32_16x16x32_bf16 v[68:71], v[108:111], v[56:59], v[68:71]
    v_mfma_f32_16x16x32_bf16 v[72:75], v[112:115], v[56:59], v[72:75]
    v_mfma_f32_16x16x32_bf16 v[76:79], v[116:119], v[56:59], v[76:79]
    s_nop 5
    s_cmp_eq_u32 s68, 0
    s_cbranch_scc1 L_c_red0w
    ds_write_b128 v218, v[60:63] offset:0
    ds_write_b128 v218, v[64:67] offset:1024
    ds_write_b128 v218, v[68:71] offset:2048
    s_branch L_c_redw_done
L_c_red0w:
    ds_write_b128 v218, v[72:75] offset:3072
    ds_write_b128 v218, v[76:79] offset:4096
L_c_redw_done:
    s_waitcnt lgkmcnt(0)
    s_barrier
    s_cmp_eq_u32 s68, 1
    s_cbranch_scc1 L_c_fin1
    ds_read_b128 v[100:103], v218 offset:0
    ds_read_b128 v[104:107], v218 offset:1024
    ds_read_b128 v[108:111], v218 offset:2048
    s_waitcnt lgkmcnt(2)
    v_pk_add_f32 v[100:101], v[100:101], v[60:61]
    v_pk_add_f32 v[102:103], v[102:103], v[62:63]
    v_cvt_pk_bf16_f32 v200, v100, v101
    v_cvt_pk_bf16_f32 v201, v102, v103
    v_lshlrev_b32 v100, 16, v200
    v_and_b32 v101, 0xffff0000, v200
    v_lshlrev_b32 v102, 16, v201
    v_and_b32 v103, 0xffff0000, v201
    v_pk_mul_f32 v[100:101], v[100:101], v[206:207] op_sel_hi:[1,0]
    v_pk_mul_f32 v[102:103], v[102:103], v[206:207] op_sel_hi:[1,0]
    v_cvt_pk_bf16_f32 v200, v100, v101
    v_cvt_pk_bf16_f32 v201, v102, v103
    v_lshlrev_b32 v100, 16, v200
    v_and_b32 v101, 0xffff0000, v200
    v_lshlrev_b32 v102, 16, v201
    v_and_b32 v103, 0xffff0000, v201
    v_pk_add_f32 v[100:101], v[100:101], v[160:161]
    v_pk_add_f32 v[102:103], v[102:103], v[162:163]
    v_cvt_pk_bf16_f32 v202, v100, v101
    v_cvt_pk_bf16_f32 v203, v102, v103
    buffer_store_dwordx2 v[202:203], v204, s[48:51], 0 offen offset:0
    s_waitcnt lgkmcnt(1)
    v_pk_add_f32 v[104:105], v[104:105], v[64:65]
    v_pk_add_f32 v[106:107], v[106:107], v[66:67]
    v_cvt_pk_bf16_f32 v200, v104, v105
    v_cvt_pk_bf16_f32 v201, v106, v107
    v_lshlrev_b32 v104, 16, v200
    v_and_b32 v105, 0xffff0000, v200
    v_lshlrev_b32 v106, 16, v201
    v_and_b32 v107, 0xffff0000, v201
    v_pk_mul_f32 v[104:105], v[104:105], v[206:207] op_sel_hi:[1,0]
    v_pk_mul_f32 v[106:107], v[106:107], v[206:207] op_sel_hi:[1,0]
    v_cvt_pk_bf16_f32 v200, v104, v105
    v_cvt_pk_bf16_f32 v201, v106, v107
    v_lshlrev_b32 v104, 16, v200
    v_and_b32 v105, 0xffff0000, v200
    v_lshlrev_b32 v106, 16, v201
    v_and_b32 v107, 0xffff0000, v201
    v_pk_add_f32 v[104:105], v[104:105], v[164:165]
    v_pk_add_f32 v[106:107], v[106:107], v[166:167]
    v_cvt_pk_bf16_f32 v202, v104, v105
    v_cvt_pk_bf16_f32 v203, v106, v107
    buffer_store_dwordx2 v[202:203], v204, s[48:51], 0 offen offset:32
    s_waitcnt lgkmcnt(0)
    v_pk_add_f32 v[108:109], v[108:109], v[68:69]
    v_pk_add_f32 v[110:111], v[110:111], v[70:71]
    v_cvt_pk_bf16_f32 v200, v108, v109
    v_cvt_pk_bf16_f32 v201, v110, v111
    v_lshlrev_b32 v108, 16, v200
    v_and_b32 v109, 0xffff0000, v200
    v_lshlrev_b32 v110, 16, v201
    v_and_b32 v111, 0xffff0000, v201
    v_pk_mul_f32 v[108:109], v[108:109], v[206:207] op_sel_hi:[1,0]
    v_pk_mul_f32 v[110:111], v[110:111], v[206:207] op_sel_hi:[1,0]
    v_cvt_pk_bf16_f32 v200, v108, v109
    v_cvt_pk_bf16_f32 v201, v110, v111
    v_lshlrev_b32 v108, 16, v200
    v_and_b32 v109, 0xffff0000, v200
    v_lshlrev_b32 v110, 16, v201
    v_and_b32 v111, 0xffff0000, v201
    v_pk_add_f32 v[108:109], v[108:109], v[168:169]
    v_pk_add_f32 v[110:111], v[110:111], v[170:171]
    v_cvt_pk_bf16_f32 v202, v108, v109
    v_cvt_pk_bf16_f32 v203, v110, v111
    buffer_store_dwordx2 v[202:203], v204, s[48:51], 0 offen offset:64
    s_branch L_fin
L_c_fin1:
    ds_read_b128 v[100:103], v218 offset:3072
    ds_read_b128 v[104:107], v218 offset:4096
    s_waitcnt lgkmcnt(1)
    v_pk_add_f32 v[100:101], v[100:101], v[72:73]
    v_pk_add_f32 v[102:103], v[102:103], v[74:75]
    v_cvt_pk_bf16_f32 v200, v100, v101
    v_cvt_pk_bf16_f32 v201, v102, v103
    v_lshlrev_b32 v100, 16, v200
    v_and_b32 v101, 0xffff0000, v200
    v_lshlrev_b32 v102, 16, v201
    v_and_b32 v103, 0xffff0000, v201
    v_pk_mul_f32 v[100:101], v[100:101], v[206:207] op_sel_hi:[1,0]
    v_pk_mul_f32 v[102:103], v[102:103], v[206:207] op_sel_hi:[1,0]
    v_cvt_pk_bf16_f32 v200, v100, v101
    v_cvt_pk_bf16_f32 v201, v102, v103
    v_lshlrev_b32 v100, 16, v200
    v_and_b32 v101, 0xffff0000, v200
    v_lshlrev_b32 v102, 16, v201
    v_and_b32 v103, 0xffff0000, v201
    v_pk_add_f32 v[100:101], v[100:101], v[160:161]
    v_pk_add_f32 v[102:103], v[102:103], v[162:163]
    v_cvt_pk_bf16_f32 v202, v100, v101
    v_cvt_pk_bf16_f32 v203, v102, v103
    buffer_store_dwordx2 v[202:203], v204, s[48:51], 0 offen offset:0
    s_waitcnt lgkmcnt(0)
    v_pk_add_f32 v[104:105], v[104:105], v[76:77]
    v_pk_add_f32 v[106:107], v[106:107], v[78:79]
    v_cvt_pk_bf16_f32 v200, v104, v105
    v_cvt_pk_bf16_f32 v201, v106, v107
    v_lshlrev_b32 v104, 16, v200
    v_and_b32 v105, 0xffff0000, v200
    v_lshlrev_b32 v106, 16, v201
    v_and_b32 v107, 0xffff0000, v201
    v_pk_mul_f32 v[104:105], v[104:105], v[206:207] op_sel_hi:[1,0]
    v_pk_mul_f32 v[106:107], v[106:107], v[206:207] op_sel_hi:[1,0]
    v_cvt_pk_bf16_f32 v200, v104, v105
    v_cvt_pk_bf16_f32 v201, v106, v107
    v_lshlrev_b32 v104, 16, v200
    v_and_b32 v105, 0xffff0000, v200
    v_lshlrev_b32 v106, 16, v201
    v_and_b32 v107, 0xffff0000, v201
    v_pk_add_f32 v[104:105], v[104:105], v[164:165]
    v_pk_add_f32 v[106:107], v[106:107], v[166:167]
    v_cvt_pk_bf16_f32 v202, v104, v105
    v_cvt_pk_bf16_f32 v203, v106, v107
    buffer_store_dwordx2 v[202:203], v204, s[48:51], 0 offen offset:32
L_fin:
    s_branch L_end
L_fallback:
    s_mov_b32 s89, 1
    v_cmp_eq_u32 vcc, 0, v11
    s_nop 1
    v_cndmask_b32 v32, 0, v32, vcc
    v_cndmask_b32 v33, 0, v33, vcc
    v_lshlrev_b32 v12, 3, v10
    v_add_u32 v12, 1024, v12
    v_mov_b32 v13, 1280
    v_cndmask_b32 v18, v13, v12, vcc
    v_min_u32 v13, 20, v10
    v_mul_u32_u24 v12, 336, v11
    v_lshl_add_u32 v12, v13, 4, v12
    v_add_u32 v19, 1344, v12
    v_mov_b32 v39, 0xff7fffff
    s_mov_b32 s74, 13631488
    s_mov_b32 s85, 0
L_fbloop:
    buffer_load_dwordx4 v[112:115], v9, s[52:55], s74 offen sc1
    buffer_load_dwordx2 v[116:117], v18, s[52:55], s74 offen sc1
    s_waitcnt vmcnt(0)
    v_mfma_f32_32x32x16_bf16 v[40:55], v[112:115], v[28:31], 0
    v_mfma_f32_32x32x8bf16_1k v[40:55], v[116:117], v[32:33], v[40:55]
    s_nop 11
    v_max3_f32 v39, v40, v41, v39
    v_max3_f32 v39, v42, v43, v39
    v_max3_f32 v39, v44, v45, v39
    v_max3_f32 v39, v46, v47, v39
    v_max3_f32 v39, v48, v49, v39
    v_max3_f32 v39, v50, v51, v39
    v_max3_f32 v39, v52, v53, v39
    v_max3_f32 v39, v54, v55, v39
    s_add_u32 s74, s74, 2688
    s_add_u32 s85, s85, 1
    s_cmp_lt_u32 s85, 64
    s_cbranch_scc1 L_fbloop
    v_mov_b32 v12, v39
    s_nop 1
    v_permlane32_swap_b32 v39, v12
    v_max_f32 v39, v39, v12
    v_xor_b32 v12, 0x80000000, v39
    v_and_b32 v13, 0xffff0000, v12
    v_sub_f32 v12, v12, v13
    v_and_b32 v14, 0xffff0000, v12
    v_sub_f32 v12, v12, v14
    v_lshrrev_b32 v13, 16, v13
    v_or_b32 v13, v13, v14
    v_lshrrev_b32 v12, 16, v12
    v_cmp_eq_u32 vcc, 0, v11
    s_nop 1
    v_cndmask_b32 v32, v13, v32, vcc
    v_cndmask_b32 v33, v12, v33, vcc
    v_mov_b32 v80, 0
    v_mov_b32 v81, 0
    v_mov_b32 v82, 0
    v_mov_b32 v83, 0
    v_mov_b32 v84, 0
    v_mov_b32 v85, 0
    v_mov_b32 v86, 0
    v_mov_b32 v87, 0
    v_mov_b32 v88, 0
    v_mov_b32 v89, 0
    v_mov_b32 v90, 0
    v_mov_b32 v91, 0
    v_mov_b32 v92, 0
    v_mov_b32 v93, 0
    v_mov_b32 v94, 0
    v_mov_b32 v95, 0
    s_mov_b32 s74, 13631488
    s_mov_b32 s85, 0
L_fbloop2:
    buffer_load_dwordx4 v[112:115], v9, s[52:55], s74 offen sc1
    buffer_load_dwordx2 v[116:117], v18, s[52:55], s74 offen sc1
    buffer_load_dwordx4 v[128:131], v19, s[52:55], s74 offen sc1
    buffer_load_dwordx4 v[132:135], v19, s[52:55], s74 offen offset:672 sc1
    s_waitcnt vmcnt(0)
    v_mfma_f32_32x32x16_bf16 v[40:55], v[112:115], v[28:31], 0
    v_mfma_f32_32x32x8bf16_1k v[40:55], v[116:117], v[32:33], v[40:55]
    s_nop 11
    v_exp_f32 v40, v40
    v_exp_f32 v41, v41
    v_exp_f32 v42, v42
    v_exp_f32 v43, v43
    v_exp_f32 v44, v44
    v_exp_f32 v45, v45
    v_exp_f32 v46, v46
    v_exp_f32 v47, v47
    v_exp_f32 v48, v48
    v_exp_f32 v49, v49
    v_exp_f32 v50, v50
    v_exp_f32 v51, v51
    v_exp_f32 v52, v52
    v_exp_f32 v53, v53
    v_exp_f32 v54, v54
    v_exp_f32 v55, v55
    v_cvt_pk_bf16_f32 v72, v40, v41
    v_cvt_pk_bf16_f32 v73, v42, v43
    v_cvt_pk_bf16_f32 v74, v44, v45
    v_cvt_pk_bf16_f32 v75, v46, v47
    v_cvt_pk_bf16_f32 v76, v48, v49
    v_cvt_pk_bf16_f32 v77, v50, v51
    v_cvt_pk_bf16_f32 v78, v52, v53
    v_cvt_pk_bf16_f32 v79, v54, v55
    v_mfma_f32_32x32x16_bf16 v[80:95], v[128:131], v[72:75], v[80:95]
    s_nop 0
    v_mfma_f32_32x32x16_bf16 v[80:95], v[132:135], v[76:79], v[80:95]
    s_add_u32 s74, s74, 2688
    s_add_u32 s85, s85, 1
    s_cmp_lt_u32 s85, 64
    s_nop 7
    s_nop 7
    s_cbranch_scc1 L_fbloop2
    s_branch L_oepi
L_yre0:
    s_mov_b32 s99, 0
L_yre0l:
    buffer_load_dwordx4 v[208:211], v236, s[52:55], s86 offen sc1
    s_waitcnt vmcnt(0)
    v_max3_u32 v16, v208, v209, v210
    v_max_u32 v16, v16, v211
    v_cmp_eq_u32 vcc, -1, v16
    s_cbranch_vccz L_yok0
    s_add_u32 s99, s99, 1
    s_cmp_lt_u32 s99, 262144
    s_cbranch_scc1 L_yre0l
    s_branch L_yok0
L_yre1:
    s_mov_b32 s99, 0
L_yre1l:
    buffer_load_dwordx4 v[212:215], v236, s[52:55], s87 offen sc1
    s_waitcnt vmcnt(0)
    v_max3_u32 v16, v212, v213, v214
    v_max_u32 v16, v16, v215
    v_cmp_eq_u32 vcc, -1, v16
    s_cbranch_vccz L_yok1
    s_add_u32 s99, s99, 1
    s_cmp_lt_u32 s99, 262144
    s_cbranch_scc1 L_yre1l
    s_branch L_yok1
L_oslow_0:
    s_mov_b32 s94, 0
    s_branch L_oslow
L_oslow_1:
    s_mov_b32 s94, 1
    s_branch L_oslow
L_oslow_2:
    s_mov_b32 s94, 2
    s_branch L_oslow
L_oslow_3:
    s_mov_b32 s94, 3
    s_branch L_oslow
L_oslow_4:
    s_mov_b32 s94, 4
    s_branch L_oslow
L_oslow_5:
    s_mov_b32 s94, 5
    s_branch L_oslow
L_oslow_6:
    s_mov_b32 s94, 6
    s_branch L_oslow
L_oslow_7:
    s_mov_b32 s94, 7
    s_branch L_oslow
L_oslow_8:
    s_mov_b32 s94, 8
    s_branch L_oslow
L_oslow_9:
    s_mov_b32 s94, 9
L_oslow:
    s_mov_b32 s99, 0
L_ochk:
    s_waitcnt vmcnt(0)
    s_mov_b32 s92, 0
    v_max3_u32 v16, v20, v21, v22
    v_max_u32 v16, v16, v23
    v_cmp_eq_u32 vcc, -1, v16
    s_cbranch_vccz L_ook_0
    buffer_load_dwordx4 v[20:23], v9, s[52:55], s82 offen offset:0 sc1
    s_mov_b32 s92, 1
L_ook_0:
    v_max3_u32 v16, v24, v25, v26
    v_max_u32 v16, v16, v27
    v_cmp_eq_u32 vcc, -1, v16
    s_cbranch_vccz L_ook_1
    buffer_load_dwordx4 v[24:27], v9, s[52:55], s82 offen offset:1024 sc1
    s_mov_b32 s92, 1
L_ook_1:
    v_max3_u32 v16, v28, v29, v30
    v_max_u32 v16, v16, v31
    v_cmp_eq_u32 vcc, -1, v16
    s_cbranch_vccz L_ook_2
    buffer_load_dwordx4 v[28:31], v9, s[52:55], s82 offen offset:2048 sc1
    s_mov_b32 s92, 1
L_ook_2:
    v_max3_u32 v16, v32, v33, v34
    v_max_u32 v16, v16, v35
    v_cmp_eq_u32 vcc, -1, v16
    s_cbranch_vccz L_ook_3
    buffer_load_dwordx4 v[32:35], v9, s[52:55], s82 offen offset:3072 sc1
    s_mov_b32 s92, 1
L_ook_3:
    v_max3_u32 v16, v36, v37, v38
    v_max_u32 v16, v16, v39
    v_cmp_eq_u32 vcc, -1, v16
    s_cbranch_vccz L_ook_4
    buffer_load_dwordx4 v[36:39], v9, s[52:55], s83 offen offset:0 sc1
    s_mov_b32 s92, 1
L_ook_4:
    v_max3_u32 v16, v40, v41, v42
    v_max_u32 v16, v16, v43
    v_cmp_eq_u32 vcc, -1, v16
    s_cbranch_vccz L_ook_5
    buffer_load_dwordx4 v[40:43], v9, s[52:55], s83 offen offset:1024 sc1
    s_mov_b32 s92, 1
L_ook_5:
    v_max3_u32 v16, v44, v45, v46
    v_max_u32 v16, v16, v47
    v_cmp_eq_u32 vcc, -1, v16
    s_cbranch_vccz L_ook_6
    buffer_load_dwordx4 v[44:47], v9, s[52:55], s83 offen offset:2048 sc1
    s_mov_b32 s92, 1
L_ook_6:
    v_max3_u32 v16, v48, v49, v50
    v_max_u32 v16, v16, v51
    v_cmp_eq_u32 vcc, -1, v16
    s_cbranch_vccz L_ook_7
    buffer_load_dwordx4 v[48:51], v9, s[52:55], s83 offen offset:3072 sc1
    s_mov_b32 s92, 1
L_ook_7:
    v_max3_u32 v16, v52, v53, v54
    v_max_u32 v16, v16, v55
    v_cmp_eq_u32 vcc, -1, v16
    s_cbranch_vccz L_ook_8
    buffer_load_dwordx4 v[52:55], v9, s[52:55], s84 offen offset:0 sc1
    s_mov_b32 s92, 1
L_ook_8:
    v_max3_u32 v16, v56, v57, v58
    v_max_u32 v16, v16, v59
    v_cmp_eq_u32 vcc, -1, v16
    s_cbranch_vccz L_ook_9
    buffer_load_dwordx4 v[56:59], v9, s[52:55], s84 offen offset:1024 sc1
    s_mov_b32 s92, 1
L_ook_9:
    s_cmp_eq_u32 s92, 0
    s_cbranch_scc1 L_ochkd
    s_add_u32 s99, s99, 1
    s_cmp_lt_u32 s99, 262144
    s_cbranch_scc1 L_ochk
    s_waitcnt vmcnt(0)
L_ochkd:
    s_cmp_eq_u32 s94, 0
    s_cbranch_scc1 L_oback_0
    s_cmp_eq_u32 s94, 1
    s_cbranch_scc1 L_oback_1
    s_cmp_eq_u32 s94, 2
    s_cbranch_scc1 L_oback_2
    s_cmp_eq_u32 s94, 3
    s_cbranch_scc1 L_oback_3
    s_cmp_eq_u32 s94, 4
    s_cbranch_scc1 L_oback_4
    s_cmp_eq_u32 s94, 5
    s_cbranch_scc1 L_oback_5
    s_cmp_eq_u32 s94, 6
    s_cbranch_scc1 L_oback_6
    s_cmp_eq_u32 s94, 7
    s_cbranch_scc1 L_oback_7
    s_cmp_eq_u32 s94, 8
    s_cbranch_scc1 L_oback_8
    s_branch L_oback_9
L_zslow:
    s_mov_b32 s99, 0
    v_mov_b32 v22, 0
L_zs1:
    buffer_load_dword v20, v22, s[56:59], 0 offen sc1
    s_waitcnt vmcnt(0)
    v_cmp_gt_u32 vcc, 64, v20
    s_cbranch_vccz L_zok
    s_add_u32 s99, s99, 1
    s_cmp_lt_u32 s99, 262144
    s_cbranch_scc1 L_zs1
    s_branch L_zok
L_f2wait:
    s_mov_b32 s99, 0
L_f2w1:
    v_min_u32 v237, 7, v1
    v_lshlrev_b32 v237, 7, v237
    s_mov_b32 s74, 14049280
    buffer_load_dword v237, v237, s[52:55], s74 offen sc1
    s_waitcnt vmcnt(0)
    v_cmp_ne_u32 vcc, 32, v237
    s_cbranch_vccz L_f2w2
    s_add_u32 s99, s99, 1
    s_cmp_lt_u32 s99, 262144
    s_cbranch_scc1 L_f2w1
L_f2w2:
    s_branch L_f2ok
L_fcwait:
    s_mov_b32 s99, 0
L_fcw1:
    v_min_u32 v237, 7, v1
    v_lshlrev_b32 v237, 7, v237
    s_mov_b32 s74, 14050304
    buffer_load_dword v237, v237, s[52:55], s74 offen sc1
    s_waitcnt vmcnt(0)
    v_cmp_ne_u32 vcc, 32, v237
    s_cbranch_vccz L_fcw2
    s_add_u32 s99, s99, 1
    s_cmp_lt_u32 s99, 262144
    s_cbranch_scc1 L_fcw1
    s_branch L_fcok
L_fcw2:
    s_branch L_fcok
L_end:
    s_endpgm

.section .rodata,"a"
.p2align 6
.amdhsa_kernel gated_mix__ssm_conv_s4__grouped_kv_mqa__prompt_kernel
  .amdhsa_next_free_vgpr 256
  .amdhsa_next_free_sgpr 102
  .amdhsa_accum_offset 256
  .amdhsa_group_segment_fixed_size 0
  .amdhsa_kernarg_size 144
  .amdhsa_user_sgpr_count 2
  .amdhsa_user_sgpr_kernarg_segment_ptr 1
  .amdhsa_system_sgpr_workgroup_id_x 1
.end_amdhsa_kernel
```
